```python
import torch

def _softmax(x, axis=-1):
    return torch.softmax(x, dim=axis)
def _gelu(x):
    return torch.nn.functional.gelu(x, approximate="tanh")
def _silu(x):
    return torch.nn.functional.silu(x)
def _sigmoid(x):
    return torch.sigmoid(x)
def _layernorm(x, axis=-1, eps=1e-5):
    m = x.mean(dim=axis, keepdim=True)
    v = x.var(dim=axis, keepdim=True, unbiased=False)
    return (x - m) / torch.sqrt(v + eps)
def _scatter_add(tgt, idx, src, axis=0):
    return tgt.clone().index_add_(axis, idx, src)
def _segment_sum(src, seg, n):
    out = torch.zeros((n,) + src.shape[1:], dtype=src.dtype)
    return out.index_add_(0, seg, src)
def _pad(x, pw):
    flat = tuple(v for pair in reversed(pw) for v in pair)
    return torch.nn.functional.pad(x, flat)

kernel_name = 'sequential_preLN__grouped_kv_mqa__glu_gated_bilinear__prompt'

def setup_inputs():

    _w = (lambda a: (lambda t: t.to(torch.bfloat16) if t.is_floating_point() else t)(torch.as_tensor(a)))
    def _A_setup():
        B, S, D, H = 1, 2048, 576, 32
        Dh = D // H
        return {
            "x": _w((lambda *s: torch.randn(*s, dtype=torch.bfloat16) * 0.05)(B, S, D)),
            "wq": _w((lambda *s: torch.randn(*s, dtype=torch.bfloat16) * 0.05)(D, H * Dh)),
            "wk": _w((lambda *s: torch.randn(*s, dtype=torch.bfloat16) * 0.05)(D, Dh)),
            "wv": _w((lambda *s: torch.randn(*s, dtype=torch.bfloat16) * 0.05)(D, Dh)),
            "wo": _w((lambda *s: torch.randn(*s, dtype=torch.bfloat16) * 0.05)(H * Dh, D)),
        }
    _A_in = _A_setup()

    def _B_setup():
        B, S, D, F = 1, 2048, 576, 4608
        return {
            "x": _w((lambda *s: torch.randn(*s, dtype=torch.bfloat16) * 0.05)(B, S, D)),
            "w_gate": _w((lambda *s: torch.randn(*s, dtype=torch.bfloat16) * 0.4)(D, F) * (D ** -0.5)),
            "w_up": _w((lambda *s: torch.randn(*s, dtype=torch.bfloat16) * 0.4)(D, F) * (D ** -0.5)),
            "w_down": _w((lambda *s: torch.randn(*s, dtype=torch.bfloat16) * 0.4)(F, D) * (F ** -0.5)),
        }
    _B_in = _B_setup()

    return {
        "A_x": _A_in["x"],
        "A_wq": _A_in["wq"],
        "A_wk": _A_in["wk"],
        "A_wv": _A_in["wv"],
        "A_wo": _A_in["wo"],
        "B_x": _B_in["x"],
        "B_w_gate": _B_in["w_gate"],
        "B_w_up": _B_in["w_up"],
        "B_w_down": _B_in["w_down"],
    }

def reference(A_x, A_wq, A_wk, A_wv, A_wo, B_x, B_w_gate, B_w_up, B_w_down):
    def _A_ref(x, wq, wk, wv, wo):
        B, S, D = x.shape
        H = 32
        Dh = D // H
        q = (lambda x, *d: x.permute(*d))((x @ wq).reshape(B, S, H, Dh), 0, 2, 1, 3)
        k = x @ wk
        v = x @ wv
        scores = torch.einsum("bhqd,bkd->bhqk", q, k) * (Dh ** -0.5)
        p = _softmax(scores, axis=-1)
        o = torch.einsum("bhqk,bkd->bhqd", p, v)
        return (lambda x, *d: x.permute(*d))(o, 0, 2, 1, 3).reshape(B, S, H * Dh) @ wo

    def _B_ref(x, w_gate, w_up, w_down):
        g = torch.einsum("bsd,df->bsf", x, w_gate)
        u = torch.einsum("bsd,df->bsf", x, w_up)
        h = g * u
        return torch.einsum("bsf,fd->bsd", h, w_down)

    x = A_x
    h = x + _A_ref(_layernorm(x, axis=-1), A_wq, A_wk, A_wv, A_wo)
    h2 = h + _B_ref(_layernorm(h, axis=-1), B_w_gate, B_w_up, B_w_down)
    return h2
```

```asm
; @launch kernel=k1_kernel grid=(256,1,1) block=(512,1,1) lds=156800
; @launch kernel=m_kernel grid=(256,1,1) block=(512,1,1) lds=163840
.amdgcn_target "amdgcn-amd-amdhsa--gfx950"
.text
.globl k1_kernel
.p2align 8
.type k1_kernel,@function
k1_kernel:
  s_load_dwordx4 s[4:7], s[0:1], 0
  s_load_dwordx4 s[8:11], s[0:1], 16
  s_load_dwordx2 s[12:13], s[0:1], 88
  s_load_dwordx2 s[48:49], s[0:1], 32
  s_cmp_ge_u32 s2, 256
  s_cbranch_scc1 K1_END
  v_and_b32 v1, 63, v0
  v_lshrrev_b32 v10, 6, v0
  s_nop 0
  v_readfirstlane_b32 s16, v10
  s_and_b32 s19, s16, 3
  s_lshr_b32 s20, s16, 2
  s_and_b32 s21, s2, 7
  s_lshr_b32 s22, s2, 3
  s_and_b32 s22, s22, 3
  s_lshl_b32 s22, s22, 3
  s_add_u32 s17, s21, s22
  s_lshr_b32 s18, s2, 5
  v_and_b32 v3, 15, v1
  v_lshrrev_b32 v2, 4, v1
  s_lshl_b32 s23, s17, 6
  s_lshl_b32 s33, s19, 4
  s_add_u32 s23, s23, s33
  v_add_u32 v27, s23, v3
  v_mul_u32_u24 v4, 1152, v27
  v_lshl_add_u32 v4, v2, 4, v4
  s_mul_i32 s35, s20, 640
  s_lshl_b32 s58, s20, 6
  v_mul_u32_u24 v10, 6554, v1
  v_lshrrev_b32 v10, 16, v10
  v_mul_u32_u24 v11, 10, v10
  v_sub_u32 v11, v1, v11
  s_mul_i32 s33, s16, 4
  v_add_u32 v10, s33, v10
  v_and_b32 v12, 0x33, v10
  v_and_b32 v13, 4, v10
  v_lshl_or_b32 v12, v13, 1, v12
  v_and_b32 v13, 8, v10
  v_lshrrev_b32 v13, 1, v13
  v_or_b32 v12, v12, v13
  v_lshrrev_b32 v168, 3, v1
  v_and_b32 v169, 7, v1
  v_lshrrev_b32 v170, 1, v168
  v_xor_b32 v169, v169, v170
  v_add_u32 v168, s23, v168
  v_mul_u32_u24 v168, 1152, v168
  v_lshl_add_u32 v164, v169, 4, v168
  v_xor_b32 v169, 4, v169
  v_lshl_add_u32 v165, v169, 4, v168
  v_add_u32 v165, 9216, v165
  v_and_b32 v168, 7, v3
  v_lshrrev_b32 v169, 3, v3
  v_lshrrev_b32 v170, 1, v168
  v_lshl_or_b32 v170, v169, 2, v170
  v_xor_b32 v170, v170, v2
  v_lshlrev_b32 v170, 4, v170
  v_lshl_add_u32 v170, v168, 7, v170
  v_lshl_add_u32 v170, v169, 10, v170
  s_lshl_b32 s62, s16, 11
  s_add_u32 s62, s62, 124032
  v_add_u32 v166, s62, v170
  v_xor_b32 v167, 64, v166
  s_waitcnt lgkmcnt(0)
  s_mov_b32 s24, s4
  s_mov_b32 s25, s5
  s_mov_b32 s26, 0x240000
  s_mov_b32 s27, 0x00020000
  s_mov_b32 s28, s12
  s_mov_b32 s29, s13
  s_mov_b32 s30, 0x280000
  s_mov_b32 s31, 0x00020000
  s_add_u32 s59, s35, 0
  s_add_u32 m0, s62, 0
  s_nop 0
  buffer_load_dwordx4 v164, s[24:27], s59 offen lds
  s_add_u32 m0, s62, 1024
  s_nop 0
  buffer_load_dwordx4 v165, s[24:27], s59 offen lds
  s_mul_i32 s33, s18, 160
  v_mul_u32_u24 v13, 1152, v12
  v_lshl_add_u32 v13, v11, 4, v13
  v_add_u32 v13, s33, v13
  v_mov_b32 v6, s6
  v_mov_b32 v7, s7
  v_mov_b32 v8, 36864
  s_cmp_lg_u32 s18, 7
  s_cbranch_scc1 K1_NOKV
  v_lshrrev_b32 v14, 1, v11
  v_and_b32 v15, 1, v11
  v_lshlrev_b32 v15, 4, v15
  v_and_b32 v10, 1, v14
  v_cmp_eq_u32 vcc, 1, v10
  s_nop 1
  v_cndmask_b32 v15, 20, v15, vcc
  v_mul_u32_u24 v10, 36, v12
  v_add_u32 v15, v15, v10
  v_cmp_le_u32 vcc, 1, v14
  s_nop 1
  v_cndmask_b32 v13, v13, v15, vcc
  v_mov_b32 v10, 1152
  v_cndmask_b32 v8, v8, v10, vcc
  v_mov_b32 v10, s8
  v_cndmask_b32 v6, v6, v10, vcc
  v_mov_b32 v10, s9
  v_cndmask_b32 v7, v7, v10, vcc
  v_cmp_le_u32 vcc, 3, v14
  v_mov_b32 v10, s10
  s_nop 0
  v_cndmask_b32 v6, v6, v10, vcc
  v_mov_b32 v10, s11
  v_cndmask_b32 v7, v7, v10, vcc
K1_NOKV:
  v_add_co_u32 v6, vcc, v6, v13
  s_nop 1
  v_addc_co_u32 v7, vcc, 0, v7, vcc
  v_mul_u32_u24 v10, 10, v8
  v_add_co_u32 v30, vcc, v6, v10
  s_nop 1
  v_addc_co_u32 v31, vcc, 0, v7, vcc
  s_mul_i32 s34, s16, 640
  v_mul_u32_u24 v29, 9, v8
  s_add_u32 m0, s34, 0
  s_mov_b32 exec_hi, 0xff
  global_load_lds_dwordx4 v[6:7], off
  s_mov_b32 exec_hi, -1
  v_add_co_u32 v6, vcc, v6, v8
  s_nop 1
  v_addc_co_u32 v7, vcc, 0, v7, vcc
  s_add_u32 m0, s34, 46080
  s_mov_b32 exec_hi, 0xff
  global_load_lds_dwordx4 v[30:31], off
  s_mov_b32 exec_hi, -1
  v_add_co_u32 v30, vcc, v30, v8
  s_nop 1
  v_addc_co_u32 v31, vcc, 0, v31, vcc
  v_mov_b32 v68, 0x3f803f80
  v_mov_b32 v69, 0x3f803f80
  v_mov_b32 v70, 0x3f803f80
  v_mov_b32 v71, 0x3f803f80
  v_lshrrev_b32 v10, 1, v2
  v_lshlrev_b32 v10, 4, v10
  v_and_b32 v11, 1, v2
  v_lshl_add_u32 v10, v11, 2, v10
  v_lshrrev_b32 v11, 2, v3
  v_add_u32 v10, v10, v11
  v_mul_u32_u24 v10, 160, v10
  v_and_b32 v11, 3, v3
  v_lshl_add_u32 v24, v11, 3, v10
  s_mul_i32 s33, s20, 46080
  v_add_u32 v24, s33, v24
  s_lshl_b32 s33, s19, 5
  v_add_u32 v25, s33, v24
  s_mul_i32 s33, s19, 5120
  s_add_u32 s33, s33, 92160
  v_lshlrev_b32 v28, 4, v1
  v_add_u32 v28, s33, v28
  s_mul_i32 s33, s18, 160
  v_mul_u32_u24 v26, 1152, v27
  v_lshl_add_u32 v26, v2, 3, v26
  v_add_u32 v26, s33, v26
  v_mov_b32 v20, 0
  v_mov_b32 v21, 0
  v_mov_b32 v22, 0
  v_mov_b32 v23, 0
  s_add_u32 m0, s34, 5120
  s_mov_b32 exec_hi, 0xff
  global_load_lds_dwordx4 v[6:7], off
  s_mov_b32 exec_hi, -1
  v_add_co_u32 v6, vcc, v6, v8
  s_nop 1
  v_addc_co_u32 v7, vcc, 0, v7, vcc
  s_add_u32 m0, s34, 51200
  s_mov_b32 exec_hi, 0xff
  global_load_lds_dwordx4 v[30:31], off
  s_mov_b32 exec_hi, -1
  v_add_co_u32 v30, vcc, v30, v8
  s_nop 1
  v_addc_co_u32 v31, vcc, 0, v31, vcc
  s_add_u32 s59, s35, 128
  s_add_u32 m0, s62, 16384
  s_nop 0
  buffer_load_dwordx4 v164, s[24:27], s59 offen lds
  s_add_u32 m0, s62, 17408
  s_nop 0
  buffer_load_dwordx4 v165, s[24:27], s59 offen lds
  s_add_u32 m0, s34, 10240
  s_mov_b32 exec_hi, 0xff
  global_load_lds_dwordx4 v[6:7], off
  s_mov_b32 exec_hi, -1
  v_add_co_u32 v6, vcc, v6, v8
  s_nop 1
  v_addc_co_u32 v7, vcc, 0, v7, vcc
  s_add_u32 m0, s34, 56320
  s_mov_b32 exec_hi, 0xff
  global_load_lds_dwordx4 v[30:31], off
  s_mov_b32 exec_hi, -1
  v_add_co_u32 v30, vcc, v30, v8
  s_nop 1
  v_addc_co_u32 v31, vcc, 0, v31, vcc
  s_lshl_b32 s36, s2, 3
  s_add_u32 s36, s36, s16
  s_cmp_lt_u32 s36, 192
  s_cselect_b32 s37, -1, 0
  v_mov_b32 v184, s37
  v_mov_b32 v185, s37
  v_mov_b32 v186, s37
  v_mov_b32 v187, s37
  s_lshl_b32 s37, s36, 10
  v_lshlrev_b32 v188, 4, v1
  v_add_u32 v189, s37, v188
  s_add_u32 s40, s12, 0x700000
  s_addc_u32 s41, s13, 0
  s_mov_b32 s42, 0x50400
  s_mov_b32 s43, 0x00020000
  buffer_store_dwordx4 v[184:187], v189, s[40:43], 0 offen sc1
  s_lshr_b32 s37, s36, 3
  s_and_b32 s38, s36, 7
  s_mul_hi_u32 s39, s37, 0x1c71c71d
  s_mul_i32 s52, s39, 9
  s_sub_u32 s52, s37, s52
  s_mul_i32 s53, s39, 73728
  s_lshl_b32 s54, s52, 7
  s_add_u32 s53, s53, s54
  s_mul_i32 s54, s38, 9216
  s_add_u32 s53, s53, s54
  s_mul_i32 s55, s52, 73728
  s_lshl_b32 s54, s39, 11
  s_add_u32 s55, s55, s54
  s_lshr_b32 s54, s38, 2
  s_lshl_b32 s54, s54, 10
  s_add_u32 s55, s55, s54
  s_and_b32 s54, s38, 3
  s_lshl_b32 s54, s54, 8
  s_add_u32 s55, s55, s54
  s_cmp_lt_u32 s36, 648
  s_cselect_b32 s50, 663552, 0
  s_cselect_b32 s56, 663552, 0
  s_mov_b32 s51, 0x00020000
  s_add_u32 s44, s12, 0x5040000
  s_addc_u32 s45, s13, 0
  s_mov_b32 s46, s56
  s_mov_b32 s47, 0x00020000
  s_mul_i32 s57, s16, 1168
  s_add_u32 s57, s57, 114688
  v_lshrrev_b32 v180, 3, v1
  v_and_b32 v181, 7, v1
  v_lshlrev_b32 v181, 4, v181
  v_mul_u32_u24 v180, 1152, v180
  v_add_u32 v180, v180, v181
  s_mov_b32 m0, s57
  v_lshrrev_b32 v182, 2, v3
  buffer_load_dwordx4 v180, s[48:51], s53 offen lds
  v_lshlrev_b32 v182, 7, v182
  v_lshl_add_u32 v182, v2, 5, v182
  v_and_b32 v181, 3, v3
  v_lshl_add_u32 v182, v181, 3, v182
  v_add_u32 v182, s57, v182
  v_mul_u32_u24 v181, 18432, v2
  v_lshl_add_u32 v181, v3, 4, v181
  s_cmp_eq_u32 s18, 7
  s_cbranch_scc1 K1_KV
  s_waitcnt vmcnt(8)
  s_barrier
  ds_read_b128 v[32:35], v166 offset:0
  ds_read_b128 v[36:39], v167 offset:0
  s_add_u32 m0, s34, 15360
  s_mov_b32 exec_hi, 0xff
  global_load_lds_dwordx4 v[6:7], off
  s_mov_b32 exec_hi, -1
  v_add_co_u32 v6, vcc, v6, v8
  s_nop 1
  v_addc_co_u32 v7, vcc, 0, v7, vcc
  s_add_u32 m0, s34, 61440
  s_mov_b32 exec_hi, 0xff
  global_load_lds_dwordx4 v[30:31], off
  s_mov_b32 exec_hi, -1
  v_add_co_u32 v30, vcc, v30, v8
  s_nop 1
  v_addc_co_u32 v31, vcc, 0, v31, vcc
  s_waitcnt lgkmcnt(1)
  v_mfma_f32_16x16x32_bf16 v[132:135], v[68:71], v[32:35], 0
  v_dot2_f32_bf16 v20, v32, v32, v20
  v_dot2_f32_bf16 v21, v33, v33, v21
  v_dot2_f32_bf16 v22, v34, v34, v22
  v_dot2_f32_bf16 v23, v35, v35, v23
  ds_read_b64_tr_b16 v[72:73], v24 offset:0
  ds_read_b64_tr_b16 v[74:75], v24 offset:1280
  ds_read_b64_tr_b16 v[76:77], v24 offset:32
  ds_read_b64_tr_b16 v[78:79], v24 offset:1312
  ds_read_b64_tr_b16 v[80:81], v24 offset:64
  ds_read_b64_tr_b16 v[82:83], v24 offset:1344
  ds_read_b64_tr_b16 v[84:85], v24 offset:96
  ds_read_b64_tr_b16 v[86:87], v24 offset:1376
  ds_read_b64_tr_b16 v[88:89], v24 offset:128
  ds_read_b64_tr_b16 v[90:91], v24 offset:1408
  ds_read_b64_tr_b16 v[92:93], v25 offset:0
  ds_read_b64_tr_b16 v[94:95], v25 offset:1280
  s_waitcnt lgkmcnt(10)
  v_mfma_f32_16x16x32_bf16 v[104:107], v[72:75], v[32:35], 0
  s_waitcnt lgkmcnt(8)
  v_mfma_f32_16x16x32_bf16 v[108:111], v[76:79], v[32:35], 0
  s_waitcnt lgkmcnt(6)
  v_mfma_f32_16x16x32_bf16 v[112:115], v[80:83], v[32:35], 0
  s_waitcnt lgkmcnt(4)
  v_mfma_f32_16x16x32_bf16 v[116:119], v[84:87], v[32:35], 0
  s_waitcnt lgkmcnt(2)
  v_mfma_f32_16x16x32_bf16 v[120:123], v[88:91], v[32:35], 0
  v_mfma_f32_16x16x32_bf16 v[128:131], v[88:91], v[68:71], 0
  s_waitcnt lgkmcnt(0)
  v_mfma_f32_16x16x32_bf16 v[124:127], v[92:95], v[68:71], 0
  s_waitcnt vmcnt(8)
  s_barrier
  s_add_u32 s59, s35, 256
  s_add_u32 m0, s62, 0
  s_nop 0
  buffer_load_dwordx4 v164, s[24:27], s59 offen lds
  s_add_u32 m0, s62, 1024
  s_nop 0
  buffer_load_dwordx4 v165, s[24:27], s59 offen lds
  s_add_u32 m0, s34, 20480
  s_mov_b32 exec_hi, 0xff
  global_load_lds_dwordx4 v[6:7], off
  s_mov_b32 exec_hi, -1
  v_add_co_u32 v6, vcc, v6, v8
  s_nop 1
  v_addc_co_u32 v7, vcc, 0, v7, vcc
  s_add_u32 m0, s34, 66560
  s_mov_b32 exec_hi, 0xff
  global_load_lds_dwordx4 v[30:31], off
  s_mov_b32 exec_hi, -1
  v_add_co_u32 v30, vcc, v30, v8
  s_nop 1
  v_addc_co_u32 v31, vcc, 0, v31, vcc
  v_mfma_f32_16x16x32_bf16 v[132:135], v[68:71], v[36:39], v[132:135]
  v_dot2_f32_bf16 v20, v36, v36, v20
  v_dot2_f32_bf16 v21, v37, v37, v21
  v_dot2_f32_bf16 v22, v38, v38, v22
  v_dot2_f32_bf16 v23, v39, v39, v23
  ds_read_b64_tr_b16 v[72:73], v24 offset:5120
  ds_read_b64_tr_b16 v[74:75], v24 offset:6400
  ds_read_b64_tr_b16 v[76:77], v24 offset:5152
  ds_read_b64_tr_b16 v[78:79], v24 offset:6432
  ds_read_b64_tr_b16 v[80:81], v24 offset:5184
  ds_read_b64_tr_b16 v[82:83], v24 offset:6464
  ds_read_b64_tr_b16 v[84:85], v24 offset:5216
  ds_read_b64_tr_b16 v[86:87], v24 offset:6496
  ds_read_b64_tr_b16 v[88:89], v24 offset:5248
  ds_read_b64_tr_b16 v[90:91], v24 offset:6528
  ds_read_b64_tr_b16 v[92:93], v25 offset:5120
  ds_read_b64_tr_b16 v[94:95], v25 offset:6400
  s_waitcnt lgkmcnt(10)
  v_mfma_f32_16x16x32_bf16 v[104:107], v[72:75], v[36:39], v[104:107]
  s_waitcnt lgkmcnt(8)
  v_mfma_f32_16x16x32_bf16 v[108:111], v[76:79], v[36:39], v[108:111]
  s_waitcnt lgkmcnt(6)
  v_mfma_f32_16x16x32_bf16 v[112:115], v[80:83], v[36:39], v[112:115]
  s_waitcnt lgkmcnt(4)
  v_mfma_f32_16x16x32_bf16 v[116:119], v[84:87], v[36:39], v[116:119]
  s_waitcnt lgkmcnt(2)
  v_mfma_f32_16x16x32_bf16 v[120:123], v[88:91], v[36:39], v[120:123]
  v_mfma_f32_16x16x32_bf16 v[128:131], v[88:91], v[68:71], v[128:131]
  s_waitcnt lgkmcnt(0)
  v_mfma_f32_16x16x32_bf16 v[124:127], v[92:95], v[68:71], v[124:127]
  s_waitcnt vmcnt(8)
  s_barrier
  ds_read_b128 v[40:43], v166 offset:16384
  ds_read_b128 v[44:47], v167 offset:16384
  s_add_u32 m0, s34, 25600
  s_mov_b32 exec_hi, 0xff
  global_load_lds_dwordx4 v[6:7], off
  s_mov_b32 exec_hi, -1
  v_add_co_u32 v6, vcc, v6, v8
  s_nop 1
  v_addc_co_u32 v7, vcc, 0, v7, vcc
  s_add_u32 m0, s34, 71680
  s_mov_b32 exec_hi, 0xff
  global_load_lds_dwordx4 v[30:31], off
  s_mov_b32 exec_hi, -1
  v_add_co_u32 v30, vcc, v30, v8
  s_nop 1
  v_addc_co_u32 v31, vcc, 0, v31, vcc
  s_waitcnt lgkmcnt(1)
  v_mfma_f32_16x16x32_bf16 v[132:135], v[68:71], v[40:43], v[132:135]
  v_dot2_f32_bf16 v20, v40, v40, v20
  v_dot2_f32_bf16 v21, v41, v41, v21
  v_dot2_f32_bf16 v22, v42, v42, v22
  v_dot2_f32_bf16 v23, v43, v43, v23
  ds_read_b64_tr_b16 v[72:73], v24 offset:10240
  ds_read_b64_tr_b16 v[74:75], v24 offset:11520
  ds_read_b64_tr_b16 v[76:77], v24 offset:10272
  ds_read_b64_tr_b16 v[78:79], v24 offset:11552
  ds_read_b64_tr_b16 v[80:81], v24 offset:10304
  ds_read_b64_tr_b16 v[82:83], v24 offset:11584
  ds_read_b64_tr_b16 v[84:85], v24 offset:10336
  ds_read_b64_tr_b16 v[86:87], v24 offset:11616
  ds_read_b64_tr_b16 v[88:89], v24 offset:10368
  ds_read_b64_tr_b16 v[90:91], v24 offset:11648
  ds_read_b64_tr_b16 v[92:93], v25 offset:10240
  ds_read_b64_tr_b16 v[94:95], v25 offset:11520
  s_waitcnt lgkmcnt(10)
  v_mfma_f32_16x16x32_bf16 v[104:107], v[72:75], v[40:43], v[104:107]
  s_waitcnt lgkmcnt(8)
  v_mfma_f32_16x16x32_bf16 v[108:111], v[76:79], v[40:43], v[108:111]
  s_waitcnt lgkmcnt(6)
  v_mfma_f32_16x16x32_bf16 v[112:115], v[80:83], v[40:43], v[112:115]
  s_waitcnt lgkmcnt(4)
  v_mfma_f32_16x16x32_bf16 v[116:119], v[84:87], v[40:43], v[116:119]
  s_waitcnt lgkmcnt(2)
  v_mfma_f32_16x16x32_bf16 v[120:123], v[88:91], v[40:43], v[120:123]
  v_mfma_f32_16x16x32_bf16 v[128:131], v[88:91], v[68:71], v[128:131]
  s_waitcnt lgkmcnt(0)
  v_mfma_f32_16x16x32_bf16 v[124:127], v[92:95], v[68:71], v[124:127]
  s_waitcnt vmcnt(6)
  s_barrier
  s_add_u32 s59, s35, 384
  s_add_u32 m0, s62, 16384
  s_nop 0
  buffer_load_dwordx4 v164, s[24:27], s59 offen lds
  s_add_u32 m0, s62, 17408
  s_nop 0
  buffer_load_dwordx4 v165, s[24:27], s59 offen lds
  s_add_u32 m0, s34, 30720
  s_mov_b32 exec_hi, 0xff
  global_load_lds_dwordx4 v[6:7], off
  s_mov_b32 exec_hi, -1
  v_add_co_u32 v6, vcc, v6, v8
  s_nop 1
  v_addc_co_u32 v7, vcc, 0, v7, vcc
  s_add_u32 m0, s34, 76800
  s_mov_b32 exec_hi, 0xff
  global_load_lds_dwordx4 v[30:31], off
  s_mov_b32 exec_hi, -1
  v_add_co_u32 v30, vcc, v30, v8
  s_nop 1
  v_addc_co_u32 v31, vcc, 0, v31, vcc
  v_mfma_f32_16x16x32_bf16 v[132:135], v[68:71], v[44:47], v[132:135]
  v_dot2_f32_bf16 v20, v44, v44, v20
  v_dot2_f32_bf16 v21, v45, v45, v21
  v_dot2_f32_bf16 v22, v46, v46, v22
  v_dot2_f32_bf16 v23, v47, v47, v23
  ds_read_b64_tr_b16 v[72:73], v24 offset:15360
  ds_read_b64_tr_b16 v[74:75], v24 offset:16640
  ds_read_b64_tr_b16 v[76:77], v24 offset:15392
  ds_read_b64_tr_b16 v[78:79], v24 offset:16672
  ds_read_b64_tr_b16 v[80:81], v24 offset:15424
  ds_read_b64_tr_b16 v[82:83], v24 offset:16704
  ds_read_b64_tr_b16 v[84:85], v24 offset:15456
  ds_read_b64_tr_b16 v[86:87], v24 offset:16736
  ds_read_b64_tr_b16 v[88:89], v24 offset:15488
  ds_read_b64_tr_b16 v[90:91], v24 offset:16768
  ds_read_b64_tr_b16 v[92:93], v25 offset:15360
  ds_read_b64_tr_b16 v[94:95], v25 offset:16640
  s_waitcnt lgkmcnt(10)
  v_mfma_f32_16x16x32_bf16 v[104:107], v[72:75], v[44:47], v[104:107]
  s_waitcnt lgkmcnt(8)
  v_mfma_f32_16x16x32_bf16 v[108:111], v[76:79], v[44:47], v[108:111]
  s_waitcnt lgkmcnt(6)
  v_mfma_f32_16x16x32_bf16 v[112:115], v[80:83], v[44:47], v[112:115]
  s_waitcnt lgkmcnt(4)
  v_mfma_f32_16x16x32_bf16 v[116:119], v[84:87], v[44:47], v[116:119]
  s_waitcnt lgkmcnt(2)
  v_mfma_f32_16x16x32_bf16 v[120:123], v[88:91], v[44:47], v[120:123]
  v_mfma_f32_16x16x32_bf16 v[128:131], v[88:91], v[68:71], v[128:131]
  s_waitcnt lgkmcnt(0)
  v_mfma_f32_16x16x32_bf16 v[124:127], v[92:95], v[68:71], v[124:127]
  s_waitcnt vmcnt(6)
  s_barrier
  ds_read_b128 v[48:51], v166 offset:0
  ds_read_b128 v[52:55], v167 offset:0
  s_add_u32 m0, s34, 35840
  s_mov_b32 exec_hi, 0xff
  global_load_lds_dwordx4 v[6:7], off
  s_mov_b32 exec_hi, -1
  v_add_co_u32 v6, vcc, v6, v8
  s_nop 1
  v_addc_co_u32 v7, vcc, 0, v7, vcc
  s_add_u32 m0, s34, 81920
  s_mov_b32 exec_hi, 0xff
  global_load_lds_dwordx4 v[30:31], off
  s_mov_b32 exec_hi, -1
  v_add_co_u32 v30, vcc, v30, v8
  s_nop 1
  v_addc_co_u32 v31, vcc, 0, v31, vcc
  s_waitcnt lgkmcnt(1)
  v_mfma_f32_16x16x32_bf16 v[132:135], v[68:71], v[48:51], v[132:135]
  v_dot2_f32_bf16 v20, v48, v48, v20
  v_dot2_f32_bf16 v21, v49, v49, v21
  v_dot2_f32_bf16 v22, v50, v50, v22
  v_dot2_f32_bf16 v23, v51, v51, v23
  ds_read_b64_tr_b16 v[72:73], v24 offset:20480
  ds_read_b64_tr_b16 v[74:75], v24 offset:21760
  ds_read_b64_tr_b16 v[76:77], v24 offset:20512
  ds_read_b64_tr_b16 v[78:79], v24 offset:21792
  ds_read_b64_tr_b16 v[80:81], v24 offset:20544
  ds_read_b64_tr_b16 v[82:83], v24 offset:21824
  ds_read_b64_tr_b16 v[84:85], v24 offset:20576
  ds_read_b64_tr_b16 v[86:87], v24 offset:21856
  ds_read_b64_tr_b16 v[88:89], v24 offset:20608
  ds_read_b64_tr_b16 v[90:91], v24 offset:21888
  ds_read_b64_tr_b16 v[92:93], v25 offset:20480
  ds_read_b64_tr_b16 v[94:95], v25 offset:21760
  s_waitcnt lgkmcnt(10)
  v_mfma_f32_16x16x32_bf16 v[104:107], v[72:75], v[48:51], v[104:107]
  s_waitcnt lgkmcnt(8)
  v_mfma_f32_16x16x32_bf16 v[108:111], v[76:79], v[48:51], v[108:111]
  s_waitcnt lgkmcnt(6)
  v_mfma_f32_16x16x32_bf16 v[112:115], v[80:83], v[48:51], v[112:115]
  s_waitcnt lgkmcnt(4)
  v_mfma_f32_16x16x32_bf16 v[116:119], v[84:87], v[48:51], v[116:119]
  s_waitcnt lgkmcnt(2)
  v_mfma_f32_16x16x32_bf16 v[120:123], v[88:91], v[48:51], v[120:123]
  v_mfma_f32_16x16x32_bf16 v[128:131], v[88:91], v[68:71], v[128:131]
  s_waitcnt lgkmcnt(0)
  v_mfma_f32_16x16x32_bf16 v[124:127], v[92:95], v[68:71], v[124:127]
  s_waitcnt vmcnt(6)
  s_barrier
  buffer_load_dwordx4 v[64:67], v4, s[24:27], s58 offen offset:512
  s_add_u32 m0, s34, 40960
  s_mov_b32 exec_hi, 0xff
  global_load_lds_dwordx4 v[6:7], off
  s_mov_b32 exec_hi, -1
  v_sub_co_u32 v30, vcc, v30, v29
  s_nop 1
  v_subbrev_co_u32 v31, vcc, 0, v31, vcc
  s_add_u32 m0, s34, 87040
  s_mov_b32 exec_hi, 0xff
  global_load_lds_dwordx4 v[30:31], off
  s_mov_b32 exec_hi, -1
  v_mfma_f32_16x16x32_bf16 v[132:135], v[68:71], v[52:55], v[132:135]
  v_dot2_f32_bf16 v20, v52, v52, v20
  v_dot2_f32_bf16 v21, v53, v53, v21
  v_dot2_f32_bf16 v22, v54, v54, v22
  v_dot2_f32_bf16 v23, v55, v55, v23
  ds_read_b64_tr_b16 v[72:73], v24 offset:25600
  ds_read_b64_tr_b16 v[74:75], v24 offset:26880
  ds_read_b64_tr_b16 v[76:77], v24 offset:25632
  ds_read_b64_tr_b16 v[78:79], v24 offset:26912
  ds_read_b64_tr_b16 v[80:81], v24 offset:25664
  ds_read_b64_tr_b16 v[82:83], v24 offset:26944
  ds_read_b64_tr_b16 v[84:85], v24 offset:25696
  ds_read_b64_tr_b16 v[86:87], v24 offset:26976
  ds_read_b64_tr_b16 v[88:89], v24 offset:25728
  ds_read_b64_tr_b16 v[90:91], v24 offset:27008
  ds_read_b64_tr_b16 v[92:93], v25 offset:25600
  ds_read_b64_tr_b16 v[94:95], v25 offset:26880
  s_waitcnt lgkmcnt(10)
  v_mfma_f32_16x16x32_bf16 v[104:107], v[72:75], v[52:55], v[104:107]
  s_waitcnt lgkmcnt(8)
  v_mfma_f32_16x16x32_bf16 v[108:111], v[76:79], v[52:55], v[108:111]
  s_waitcnt lgkmcnt(6)
  v_mfma_f32_16x16x32_bf16 v[112:115], v[80:83], v[52:55], v[112:115]
  s_waitcnt lgkmcnt(4)
  v_mfma_f32_16x16x32_bf16 v[116:119], v[84:87], v[52:55], v[116:119]
  s_waitcnt lgkmcnt(2)
  v_mfma_f32_16x16x32_bf16 v[120:123], v[88:91], v[52:55], v[120:123]
  v_mfma_f32_16x16x32_bf16 v[128:131], v[88:91], v[68:71], v[128:131]
  s_waitcnt lgkmcnt(0)
  v_mfma_f32_16x16x32_bf16 v[124:127], v[92:95], v[68:71], v[124:127]
  s_waitcnt vmcnt(5)
  s_barrier
  ds_read_b128 v[56:59], v166 offset:16384
  ds_read_b128 v[60:63], v167 offset:16384
  s_waitcnt lgkmcnt(1)
  v_mfma_f32_16x16x32_bf16 v[132:135], v[68:71], v[56:59], v[132:135]
  v_dot2_f32_bf16 v20, v56, v56, v20
  v_dot2_f32_bf16 v21, v57, v57, v21
  v_dot2_f32_bf16 v22, v58, v58, v22
  v_dot2_f32_bf16 v23, v59, v59, v23
  ds_read_b64_tr_b16 v[72:73], v24 offset:30720
  ds_read_b64_tr_b16 v[74:75], v24 offset:32000
  ds_read_b64_tr_b16 v[76:77], v24 offset:30752
  ds_read_b64_tr_b16 v[78:79], v24 offset:32032
  ds_read_b64_tr_b16 v[80:81], v24 offset:30784
  ds_read_b64_tr_b16 v[82:83], v24 offset:32064
  ds_read_b64_tr_b16 v[84:85], v24 offset:30816
  ds_read_b64_tr_b16 v[86:87], v24 offset:32096
  ds_read_b64_tr_b16 v[88:89], v24 offset:30848
  ds_read_b64_tr_b16 v[90:91], v24 offset:32128
  ds_read_b64_tr_b16 v[92:93], v25 offset:30720
  ds_read_b64_tr_b16 v[94:95], v25 offset:32000
  s_waitcnt lgkmcnt(10)
  v_mfma_f32_16x16x32_bf16 v[104:107], v[72:75], v[56:59], v[104:107]
  s_waitcnt lgkmcnt(8)
  v_mfma_f32_16x16x32_bf16 v[108:111], v[76:79], v[56:59], v[108:111]
  s_waitcnt lgkmcnt(6)
  v_mfma_f32_16x16x32_bf16 v[112:115], v[80:83], v[56:59], v[112:115]
  s_waitcnt lgkmcnt(4)
  v_mfma_f32_16x16x32_bf16 v[116:119], v[84:87], v[56:59], v[116:119]
  s_waitcnt lgkmcnt(2)
  v_mfma_f32_16x16x32_bf16 v[120:123], v[88:91], v[56:59], v[120:123]
  v_mfma_f32_16x16x32_bf16 v[128:131], v[88:91], v[68:71], v[128:131]
  s_waitcnt lgkmcnt(0)
  v_mfma_f32_16x16x32_bf16 v[124:127], v[92:95], v[68:71], v[124:127]
  s_waitcnt vmcnt(3)
  s_barrier
  v_mfma_f32_16x16x32_bf16 v[132:135], v[68:71], v[60:63], v[132:135]
  v_dot2_f32_bf16 v20, v60, v60, v20
  v_dot2_f32_bf16 v21, v61, v61, v21
  v_dot2_f32_bf16 v22, v62, v62, v22
  v_dot2_f32_bf16 v23, v63, v63, v23
  ds_read_b64_tr_b16 v[72:73], v24 offset:35840
  ds_read_b64_tr_b16 v[74:75], v24 offset:37120
  ds_read_b64_tr_b16 v[76:77], v24 offset:35872
  ds_read_b64_tr_b16 v[78:79], v24 offset:37152
  ds_read_b64_tr_b16 v[80:81], v24 offset:35904
  ds_read_b64_tr_b16 v[82:83], v24 offset:37184
  ds_read_b64_tr_b16 v[84:85], v24 offset:35936
  ds_read_b64_tr_b16 v[86:87], v24 offset:37216
  ds_read_b64_tr_b16 v[88:89], v24 offset:35968
  ds_read_b64_tr_b16 v[90:91], v24 offset:37248
  ds_read_b64_tr_b16 v[92:93], v25 offset:35840
  ds_read_b64_tr_b16 v[94:95], v25 offset:37120
  s_waitcnt lgkmcnt(10)
  v_mfma_f32_16x16x32_bf16 v[104:107], v[72:75], v[60:63], v[104:107]
  s_waitcnt lgkmcnt(8)
  v_mfma_f32_16x16x32_bf16 v[108:111], v[76:79], v[60:63], v[108:111]
  s_waitcnt lgkmcnt(6)
  v_mfma_f32_16x16x32_bf16 v[112:115], v[80:83], v[60:63], v[112:115]
  s_waitcnt lgkmcnt(4)
  v_mfma_f32_16x16x32_bf16 v[116:119], v[84:87], v[60:63], v[116:119]
  s_waitcnt lgkmcnt(2)
  v_mfma_f32_16x16x32_bf16 v[120:123], v[88:91], v[60:63], v[120:123]
  v_mfma_f32_16x16x32_bf16 v[128:131], v[88:91], v[68:71], v[128:131]
  s_waitcnt lgkmcnt(0)
  v_mfma_f32_16x16x32_bf16 v[124:127], v[92:95], v[68:71], v[124:127]
  s_waitcnt vmcnt(0)
  s_barrier
  ds_read_b64_tr_b16 v[176:177], v182
  ds_read_b64_tr_b16 v[178:179], v182 offset:512
  v_mfma_f32_16x16x32_bf16 v[132:135], v[68:71], v[64:67], v[132:135]
  v_dot2_f32_bf16 v20, v64, v64, v20
  v_dot2_f32_bf16 v21, v65, v65, v21
  v_dot2_f32_bf16 v22, v66, v66, v22
  v_dot2_f32_bf16 v23, v67, v67, v23
  ds_read_b64_tr_b16 v[72:73], v24 offset:40960
  ds_read_b64_tr_b16 v[74:75], v24 offset:42240
  ds_read_b64_tr_b16 v[76:77], v24 offset:40992
  ds_read_b64_tr_b16 v[78:79], v24 offset:42272
  ds_read_b64_tr_b16 v[80:81], v24 offset:41024
  ds_read_b64_tr_b16 v[82:83], v24 offset:42304
  ds_read_b64_tr_b16 v[84:85], v24 offset:41056
  ds_read_b64_tr_b16 v[86:87], v24 offset:42336
  ds_read_b64_tr_b16 v[88:89], v24 offset:41088
  ds_read_b64_tr_b16 v[90:91], v24 offset:42368
  ds_read_b64_tr_b16 v[92:93], v25 offset:40960
  ds_read_b64_tr_b16 v[94:95], v25 offset:42240
  s_waitcnt lgkmcnt(10)
  v_mfma_f32_16x16x32_bf16 v[104:107], v[72:75], v[64:67], v[104:107]
  s_waitcnt lgkmcnt(8)
  v_mfma_f32_16x16x32_bf16 v[108:111], v[76:79], v[64:67], v[108:111]
  s_waitcnt lgkmcnt(6)
  v_mfma_f32_16x16x32_bf16 v[112:115], v[80:83], v[64:67], v[112:115]
  s_waitcnt lgkmcnt(4)
  v_mfma_f32_16x16x32_bf16 v[116:119], v[84:87], v[64:67], v[116:119]
  s_waitcnt lgkmcnt(2)
  v_mfma_f32_16x16x32_bf16 v[120:123], v[88:91], v[64:67], v[120:123]
  v_mfma_f32_16x16x32_bf16 v[128:131], v[88:91], v[68:71], v[128:131]
  s_waitcnt lgkmcnt(0)
  v_mfma_f32_16x16x32_bf16 v[124:127], v[92:95], v[68:71], v[124:127]
  buffer_store_dwordx4 v[176:179], v181, s[44:47], s55 offen sc1
  v_add_f32 v20, v20, v21
  v_add_f32 v22, v22, v23
  v_add_f32 v20, v20, v22
  v_mov_b32 v10, v20
  s_nop 1
  v_permlane16_swap_b32 v20, v10
  v_add_f32 v20, v20, v10
  v_mov_b32 v10, v20
  s_nop 1
  v_permlane32_swap_b32 v20, v10
  v_add_f32 v20, v20, v10
  v_mov_b32 v10, v132
  v_mov_b32 v11, v20
  s_lshl_b32 s33, s20, 9
  s_lshl_b32 s36, s19, 7
  s_add_u32 s33, s33, s36
  s_add_u32 s33, s33, 113664
  v_lshlrev_b32 v12, 3, v3
  v_add_u32 v12, s33, v12
  s_mov_b64 exec, 0xffff
  ds_write_b64 v12, v[10:11]
  s_mov_b32 exec_lo, 0x00010001
  s_mov_b32 exec_hi, 0x00010001
  s_mul_i32 s33, s20, 320
  s_add_u32 s33, s33, 112640
  v_lshlrev_b32 v13, 4, v2
  v_add_u32 v13, s33, v13
  s_lshl_b32 s36, s19, 6
  v_add_u32 v14, s36, v13
  ds_write_b128 v14, v[124:127]
  ds_write_b128 v13, v[128:131] offset:256
  s_mov_b64 exec, -1
  s_cmp_lg_u32 s20, 0
  s_cbranch_scc1 K1_X10
  ds_write_b128 v28, v[116:119] offset:3072
  ds_write_b128 v28, v[120:123] offset:4096
  s_waitcnt lgkmcnt(0)
  s_barrier
  s_lshl_b32 s33, s19, 7
  s_add_u32 s33, s33, 113664
  v_lshlrev_b32 v12, 3, v3
  v_add_u32 v12, s33, v12
  ds_read_b64 v[20:21], v12
  ds_read_b64 v[22:23], v12 offset:512
  s_waitcnt lgkmcnt(0)
  v_add_f32 v16, v20, v22
  v_add_f32 v20, v21, v23
  v_mul_f32 v16, 0x3ae38e39, v16
  v_mul_f32 v20, 0x3ae38e39, v20
  v_fma_f32 v20, -v16, v16, v20
  v_max_f32 v20, 0, v20
  v_add_f32 v20, 0x3727c5ac, v20
  v_rsq_f32 v17, v20
  s_nop 0
  v_mul_f32 v18, 0x3eae1a93, v17
  v_lshlrev_b32 v29, 4, v2
  v_add_u32 v29, 112640, v29
  ds_read_b128 v[140:143], v28 offset:0
  ds_read_b128 v[136:139], v29 offset:0
  ds_read_b128 v[12:15], v29 offset:320
  s_waitcnt lgkmcnt(0)
  v_add_f32 v136, v136, v12
  v_add_f32 v137, v137, v13
  v_add_f32 v138, v138, v14
  v_add_f32 v139, v139, v15
  v_add_f32 v104, v104, v140
  v_add_f32 v105, v105, v141
  v_add_f32 v106, v106, v142
  v_add_f32 v107, v107, v143
  v_fma_f32 v12, -v16, v136, v104
  v_fma_f32 v13, -v16, v137, v105
  v_fma_f32 v14, -v16, v138, v106
  v_fma_f32 v15, -v16, v139, v107
  v_mul_f32 v12, v12, v18
  v_mul_f32 v13, v13, v18
  v_mul_f32 v14, v14, v18
  v_mul_f32 v15, v15, v18
  v_cvt_pk_bf16_f32 v72, v12, v13
  v_cvt_pk_bf16_f32 v73, v14, v15
  ds_read_b128 v[140:143], v28 offset:1024
  ds_read_b128 v[136:139], v29 offset:64
  ds_read_b128 v[12:15], v29 offset:384
  s_waitcnt lgkmcnt(0)
  v_add_f32 v136, v136, v12
  v_add_f32 v137, v137, v13
  v_add_f32 v138, v138, v14
  v_add_f32 v139, v139, v15
  v_add_f32 v108, v108, v140
  v_add_f32 v109, v109, v141
  v_add_f32 v110, v110, v142
  v_add_f32 v111, v111, v143
  v_fma_f32 v12, -v16, v136, v108
  v_fma_f32 v13, -v16, v137, v109
  v_fma_f32 v14, -v16, v138, v110
  v_fma_f32 v15, -v16, v139, v111
  v_mul_f32 v12, v12, v18
  v_mul_f32 v13, v13, v18
  v_mul_f32 v14, v14, v18
  v_mul_f32 v15, v15, v18
  v_cvt_pk_bf16_f32 v74, v12, v13
  v_cvt_pk_bf16_f32 v75, v14, v15
  v_and_b32 v76, 1, v2
  v_lshrrev_b32 v77, 1, v2
  v_lshlrev_b32 v76, 5, v76
  v_lshl_add_u32 v76, v77, 4, v76
  v_lshlrev_b32 v77, 3, v2
  v_sub_u32 v76, v76, v77
  v_add_u32 v76, v76, v26
  v_permlane16_swap_b32 v72, v74
  v_permlane16_swap_b32 v73, v75
  buffer_store_dwordx4 v[72:75], v76, s[28:31], 0 offen offset:0
  ds_read_b128 v[140:143], v28 offset:2048
  ds_read_b128 v[136:139], v29 offset:128
  ds_read_b128 v[12:15], v29 offset:448
  s_waitcnt lgkmcnt(0)
  v_add_f32 v136, v136, v12
  v_add_f32 v137, v137, v13
  v_add_f32 v138, v138, v14
  v_add_f32 v139, v139, v15
  v_add_f32 v112, v112, v140
  v_add_f32 v113, v113, v141
  v_add_f32 v114, v114, v142
  v_add_f32 v115, v115, v143
  v_fma_f32 v12, -v16, v136, v112
  v_fma_f32 v13, -v16, v137, v113
  v_fma_f32 v14, -v16, v138, v114
  v_fma_f32 v15, -v16, v139, v115
  v_mul_f32 v12, v12, v18
  v_mul_f32 v13, v13, v18
  v_mul_f32 v14, v14, v18
  v_mul_f32 v15, v15, v18
  v_cvt_pk_bf16_f32 v10, v12, v13
  v_cvt_pk_bf16_f32 v11, v14, v15
  buffer_store_dwordx2 v[10:11], v26, s[28:31], 0 offen offset:64
  s_endpgm
K1_X10:
  ds_write_b128 v28, v[104:107] offset:0
  ds_write_b128 v28, v[108:111] offset:1024
  ds_write_b128 v28, v[112:115] offset:2048
  s_waitcnt lgkmcnt(0)
  s_barrier
  s_lshl_b32 s33, s19, 7
  s_add_u32 s33, s33, 113664
  v_lshlrev_b32 v12, 3, v3
  v_add_u32 v12, s33, v12
  ds_read_b64 v[20:21], v12
  ds_read_b64 v[22:23], v12 offset:512
  s_waitcnt lgkmcnt(0)
  v_add_f32 v16, v20, v22
  v_add_f32 v20, v21, v23
  v_mul_f32 v16, 0x3ae38e39, v16
  v_mul_f32 v20, 0x3ae38e39, v20
  v_fma_f32 v20, -v16, v16, v20
  v_max_f32 v20, 0, v20
  v_add_f32 v20, 0x3727c5ac, v20
  v_rsq_f32 v17, v20
  s_nop 0
  v_mul_f32 v18, 0x3eae1a93, v17
  v_lshlrev_b32 v29, 4, v2
  v_add_u32 v29, 112640, v29
  ds_read_b128 v[140:143], v28 offset:3072
  ds_read_b128 v[136:139], v29 offset:192
  ds_read_b128 v[12:15], v29 offset:512
  s_waitcnt lgkmcnt(0)
  v_add_f32 v136, v136, v12
  v_add_f32 v137, v137, v13
  v_add_f32 v138, v138, v14
  v_add_f32 v139, v139, v15
  v_add_f32 v116, v116, v140
  v_add_f32 v117, v117, v141
  v_add_f32 v118, v118, v142
  v_add_f32 v119, v119, v143
  v_fma_f32 v12, -v16, v136, v116
  v_fma_f32 v13, -v16, v137, v117
  v_fma_f32 v14, -v16, v138, v118
  v_fma_f32 v15, -v16, v139, v119
  v_mul_f32 v12, v12, v18
  v_mul_f32 v13, v13, v18
  v_mul_f32 v14, v14, v18
  v_mul_f32 v15, v15, v18
  v_cvt_pk_bf16_f32 v72, v12, v13
  v_cvt_pk_bf16_f32 v73, v14, v15
  ds_read_b128 v[140:143], v28 offset:4096
  ds_read_b128 v[136:139], v29 offset:256
  ds_read_b128 v[12:15], v29 offset:576
  s_waitcnt lgkmcnt(0)
  v_add_f32 v136, v136, v12
  v_add_f32 v137, v137, v13
  v_add_f32 v138, v138, v14
  v_add_f32 v139, v139, v15
  v_add_f32 v120, v120, v140
  v_add_f32 v121, v121, v141
  v_add_f32 v122, v122, v142
  v_add_f32 v123, v123, v143
  v_fma_f32 v12, -v16, v136, v120
  v_fma_f32 v13, -v16, v137, v121
  v_fma_f32 v14, -v16, v138, v122
  v_fma_f32 v15, -v16, v139, v123
  v_mul_f32 v12, v12, v18
  v_mul_f32 v13, v13, v18
  v_mul_f32 v14, v14, v18
  v_mul_f32 v15, v15, v18
  v_cvt_pk_bf16_f32 v74, v12, v13
  v_cvt_pk_bf16_f32 v75, v14, v15
  v_and_b32 v76, 1, v2
  v_lshrrev_b32 v77, 1, v2
  v_lshlrev_b32 v76, 5, v76
  v_lshl_add_u32 v76, v77, 4, v76
  v_lshlrev_b32 v77, 3, v2
  v_sub_u32 v76, v76, v77
  v_add_u32 v76, v76, v26
  v_permlane16_swap_b32 v72, v74
  v_permlane16_swap_b32 v73, v75
  buffer_store_dwordx4 v[72:75], v76, s[28:31], 0 offen offset:96
  s_mov_b64 exec, -1
  s_endpgm
K1_KV:
  s_waitcnt vmcnt(8)
  s_barrier
  ds_read_b128 v[32:35], v166 offset:0
  ds_read_b128 v[36:39], v167 offset:0
  s_add_u32 m0, s34, 15360
  s_mov_b32 exec_hi, 0xff
  global_load_lds_dwordx4 v[6:7], off
  s_mov_b32 exec_hi, -1
  v_add_co_u32 v6, vcc, v6, v8
  s_nop 1
  v_addc_co_u32 v7, vcc, 0, v7, vcc
  s_add_u32 m0, s34, 61440
  s_mov_b32 exec_hi, 0xff
  global_load_lds_dwordx4 v[30:31], off
  s_mov_b32 exec_hi, -1
  v_add_co_u32 v30, vcc, v30, v8
  s_nop 1
  v_addc_co_u32 v31, vcc, 0, v31, vcc
  s_waitcnt lgkmcnt(1)
  v_mfma_f32_16x16x32_bf16 v[132:135], v[68:71], v[32:35], 0
  v_dot2_f32_bf16 v20, v32, v32, v20
  v_dot2_f32_bf16 v21, v33, v33, v21
  v_dot2_f32_bf16 v22, v34, v34, v22
  v_dot2_f32_bf16 v23, v35, v35, v23
  ds_read_b64_tr_b16 v[72:73], v24 offset:0
  ds_read_b64_tr_b16 v[74:75], v24 offset:1280
  ds_read_b64_tr_b16 v[76:77], v24 offset:32
  ds_read_b64_tr_b16 v[78:79], v24 offset:1312
  ds_read_b64_tr_b16 v[80:81], v24 offset:64
  ds_read_b64_tr_b16 v[82:83], v24 offset:1344
  ds_read_b64_tr_b16 v[84:85], v24 offset:96
  ds_read_b64_tr_b16 v[86:87], v24 offset:1376
  ds_read_b64_tr_b16 v[88:89], v24 offset:128
  ds_read_b64_tr_b16 v[90:91], v24 offset:1408
  ds_read_b64_tr_b16 v[92:93], v25 offset:0
  ds_read_b64_tr_b16 v[94:95], v25 offset:1280
  s_waitcnt lgkmcnt(10)
  v_mfma_f32_16x16x32_bf16 v[104:107], v[72:75], v[32:35], 0
  s_waitcnt lgkmcnt(8)
  v_mfma_f32_16x16x32_bf16 v[108:111], v[76:79], v[32:35], 0
  s_waitcnt lgkmcnt(6)
  v_mfma_f32_16x16x32_bf16 v[112:115], v[80:83], v[32:35], 0
  s_waitcnt lgkmcnt(4)
  v_mfma_f32_16x16x32_bf16 v[116:119], v[32:35], v[84:87], 0
  s_waitcnt lgkmcnt(2)
  v_mfma_f32_16x16x32_bf16 v[120:123], v[32:35], v[88:91], 0
  v_mfma_f32_16x16x32_bf16 v[128:131], v[88:91], v[68:71], 0
  s_waitcnt lgkmcnt(0)
  v_mfma_f32_16x16x32_bf16 v[124:127], v[92:95], v[68:71], 0
  s_waitcnt vmcnt(8)
  s_barrier
  s_add_u32 s59, s35, 256
  s_add_u32 m0, s62, 0
  s_nop 0
  buffer_load_dwordx4 v164, s[24:27], s59 offen lds
  s_add_u32 m0, s62, 1024
  s_nop 0
  buffer_load_dwordx4 v165, s[24:27], s59 offen lds
  s_add_u32 m0, s34, 20480
  s_mov_b32 exec_hi, 0xff
  global_load_lds_dwordx4 v[6:7], off
  s_mov_b32 exec_hi, -1
  v_add_co_u32 v6, vcc, v6, v8
  s_nop 1
  v_addc_co_u32 v7, vcc, 0, v7, vcc
  s_add_u32 m0, s34, 66560
  s_mov_b32 exec_hi, 0xff
  global_load_lds_dwordx4 v[30:31], off
  s_mov_b32 exec_hi, -1
  v_add_co_u32 v30, vcc, v30, v8
  s_nop 1
  v_addc_co_u32 v31, vcc, 0, v31, vcc
  v_mfma_f32_16x16x32_bf16 v[132:135], v[68:71], v[36:39], v[132:135]
  v_dot2_f32_bf16 v20, v36, v36, v20
  v_dot2_f32_bf16 v21, v37, v37, v21
  v_dot2_f32_bf16 v22, v38, v38, v22
  v_dot2_f32_bf16 v23, v39, v39, v23
  ds_read_b64_tr_b16 v[72:73], v24 offset:5120
  ds_read_b64_tr_b16 v[74:75], v24 offset:6400
  ds_read_b64_tr_b16 v[76:77], v24 offset:5152
  ds_read_b64_tr_b16 v[78:79], v24 offset:6432
  ds_read_b64_tr_b16 v[80:81], v24 offset:5184
  ds_read_b64_tr_b16 v[82:83], v24 offset:6464
  ds_read_b64_tr_b16 v[84:85], v24 offset:5216
  ds_read_b64_tr_b16 v[86:87], v24 offset:6496
  ds_read_b64_tr_b16 v[88:89], v24 offset:5248
  ds_read_b64_tr_b16 v[90:91], v24 offset:6528
  ds_read_b64_tr_b16 v[92:93], v25 offset:5120
  ds_read_b64_tr_b16 v[94:95], v25 offset:6400
  s_waitcnt lgkmcnt(10)
  v_mfma_f32_16x16x32_bf16 v[104:107], v[72:75], v[36:39], v[104:107]
  s_waitcnt lgkmcnt(8)
  v_mfma_f32_16x16x32_bf16 v[108:111], v[76:79], v[36:39], v[108:111]
  s_waitcnt lgkmcnt(6)
  v_mfma_f32_16x16x32_bf16 v[112:115], v[80:83], v[36:39], v[112:115]
  s_waitcnt lgkmcnt(4)
  v_mfma_f32_16x16x32_bf16 v[116:119], v[36:39], v[84:87], v[116:119]
  s_waitcnt lgkmcnt(2)
  v_mfma_f32_16x16x32_bf16 v[120:123], v[36:39], v[88:91], v[120:123]
  v_mfma_f32_16x16x32_bf16 v[128:131], v[88:91], v[68:71], v[128:131]
  s_waitcnt lgkmcnt(0)
  v_mfma_f32_16x16x32_bf16 v[124:127], v[92:95], v[68:71], v[124:127]
  s_waitcnt vmcnt(8)
  s_barrier
  ds_read_b128 v[40:43], v166 offset:16384
  ds_read_b128 v[44:47], v167 offset:16384
  s_add_u32 m0, s34, 25600
  s_mov_b32 exec_hi, 0xff
  global_load_lds_dwordx4 v[6:7], off
  s_mov_b32 exec_hi, -1
  v_add_co_u32 v6, vcc, v6, v8
  s_nop 1
  v_addc_co_u32 v7, vcc, 0, v7, vcc
  s_add_u32 m0, s34, 71680
  s_mov_b32 exec_hi, 0xff
  global_load_lds_dwordx4 v[30:31], off
  s_mov_b32 exec_hi, -1
  v_add_co_u32 v30, vcc, v30, v8
  s_nop 1
  v_addc_co_u32 v31, vcc, 0, v31, vcc
  s_waitcnt lgkmcnt(1)
  v_mfma_f32_16x16x32_bf16 v[132:135], v[68:71], v[40:43], v[132:135]
  v_dot2_f32_bf16 v20, v40, v40, v20
  v_dot2_f32_bf16 v21, v41, v41, v21
  v_dot2_f32_bf16 v22, v42, v42, v22
  v_dot2_f32_bf16 v23, v43, v43, v23
  ds_read_b64_tr_b16 v[72:73], v24 offset:10240
  ds_read_b64_tr_b16 v[74:75], v24 offset:11520
  ds_read_b64_tr_b16 v[76:77], v24 offset:10272
  ds_read_b64_tr_b16 v[78:79], v24 offset:11552
  ds_read_b64_tr_b16 v[80:81], v24 offset:10304
  ds_read_b64_tr_b16 v[82:83], v24 offset:11584
  ds_read_b64_tr_b16 v[84:85], v24 offset:10336
  ds_read_b64_tr_b16 v[86:87], v24 offset:11616
  ds_read_b64_tr_b16 v[88:89], v24 offset:10368
  ds_read_b64_tr_b16 v[90:91], v24 offset:11648
  ds_read_b64_tr_b16 v[92:93], v25 offset:10240
  ds_read_b64_tr_b16 v[94:95], v25 offset:11520
  s_waitcnt lgkmcnt(10)
  v_mfma_f32_16x16x32_bf16 v[104:107], v[72:75], v[40:43], v[104:107]
  s_waitcnt lgkmcnt(8)
  v_mfma_f32_16x16x32_bf16 v[108:111], v[76:79], v[40:43], v[108:111]
  s_waitcnt lgkmcnt(6)
  v_mfma_f32_16x16x32_bf16 v[112:115], v[80:83], v[40:43], v[112:115]
  s_waitcnt lgkmcnt(4)
  v_mfma_f32_16x16x32_bf16 v[116:119], v[40:43], v[84:87], v[116:119]
  s_waitcnt lgkmcnt(2)
  v_mfma_f32_16x16x32_bf16 v[120:123], v[40:43], v[88:91], v[120:123]
  v_mfma_f32_16x16x32_bf16 v[128:131], v[88:91], v[68:71], v[128:131]
  s_waitcnt lgkmcnt(0)
  v_mfma_f32_16x16x32_bf16 v[124:127], v[92:95], v[68:71], v[124:127]
  s_waitcnt vmcnt(6)
  s_barrier
  s_add_u32 s59, s35, 384
  s_add_u32 m0, s62, 16384
  s_nop 0
  buffer_load_dwordx4 v164, s[24:27], s59 offen lds
  s_add_u32 m0, s62, 17408
  s_nop 0
  buffer_load_dwordx4 v165, s[24:27], s59 offen lds
  s_add_u32 m0, s34, 30720
  s_mov_b32 exec_hi, 0xff
  global_load_lds_dwordx4 v[6:7], off
  s_mov_b32 exec_hi, -1
  v_add_co_u32 v6, vcc, v6, v8
  s_nop 1
  v_addc_co_u32 v7, vcc, 0, v7, vcc
  s_add_u32 m0, s34, 76800
  s_mov_b32 exec_hi, 0xff
  global_load_lds_dwordx4 v[30:31], off
  s_mov_b32 exec_hi, -1
  v_add_co_u32 v30, vcc, v30, v8
  s_nop 1
  v_addc_co_u32 v31, vcc, 0, v31, vcc
  v_mfma_f32_16x16x32_bf16 v[132:135], v[68:71], v[44:47], v[132:135]
  v_dot2_f32_bf16 v20, v44, v44, v20
  v_dot2_f32_bf16 v21, v45, v45, v21
  v_dot2_f32_bf16 v22, v46, v46, v22
  v_dot2_f32_bf16 v23, v47, v47, v23
  ds_read_b64_tr_b16 v[72:73], v24 offset:15360
  ds_read_b64_tr_b16 v[74:75], v24 offset:16640
  ds_read_b64_tr_b16 v[76:77], v24 offset:15392
  ds_read_b64_tr_b16 v[78:79], v24 offset:16672
  ds_read_b64_tr_b16 v[80:81], v24 offset:15424
  ds_read_b64_tr_b16 v[82:83], v24 offset:16704
  ds_read_b64_tr_b16 v[84:85], v24 offset:15456
  ds_read_b64_tr_b16 v[86:87], v24 offset:16736
  ds_read_b64_tr_b16 v[88:89], v24 offset:15488
  ds_read_b64_tr_b16 v[90:91], v24 offset:16768
  ds_read_b64_tr_b16 v[92:93], v25 offset:15360
  ds_read_b64_tr_b16 v[94:95], v25 offset:16640
  s_waitcnt lgkmcnt(10)
  v_mfma_f32_16x16x32_bf16 v[104:107], v[72:75], v[44:47], v[104:107]
  s_waitcnt lgkmcnt(8)
  v_mfma_f32_16x16x32_bf16 v[108:111], v[76:79], v[44:47], v[108:111]
  s_waitcnt lgkmcnt(6)
  v_mfma_f32_16x16x32_bf16 v[112:115], v[80:83], v[44:47], v[112:115]
  s_waitcnt lgkmcnt(4)
  v_mfma_f32_16x16x32_bf16 v[116:119], v[44:47], v[84:87], v[116:119]
  s_waitcnt lgkmcnt(2)
  v_mfma_f32_16x16x32_bf16 v[120:123], v[44:47], v[88:91], v[120:123]
  v_mfma_f32_16x16x32_bf16 v[128:131], v[88:91], v[68:71], v[128:131]
  s_waitcnt lgkmcnt(0)
  v_mfma_f32_16x16x32_bf16 v[124:127], v[92:95], v[68:71], v[124:127]
  s_waitcnt vmcnt(6)
  s_barrier
  ds_read_b128 v[48:51], v166 offset:0
  ds_read_b128 v[52:55], v167 offset:0
  s_add_u32 m0, s34, 35840
  s_mov_b32 exec_hi, 0xff
  global_load_lds_dwordx4 v[6:7], off
  s_mov_b32 exec_hi, -1
  v_add_co_u32 v6, vcc, v6, v8
  s_nop 1
  v_addc_co_u32 v7, vcc, 0, v7, vcc
  s_add_u32 m0, s34, 81920
  s_mov_b32 exec_hi, 0xff
  global_load_lds_dwordx4 v[30:31], off
  s_mov_b32 exec_hi, -1
  v_add_co_u32 v30, vcc, v30, v8
  s_nop 1
  v_addc_co_u32 v31, vcc, 0, v31, vcc
  s_waitcnt lgkmcnt(1)
  v_mfma_f32_16x16x32_bf16 v[132:135], v[68:71], v[48:51], v[132:135]
  v_dot2_f32_bf16 v20, v48, v48, v20
  v_dot2_f32_bf16 v21, v49, v49, v21
  v_dot2_f32_bf16 v22, v50, v50, v22
  v_dot2_f32_bf16 v23, v51, v51, v23
  ds_read_b64_tr_b16 v[72:73], v24 offset:20480
  ds_read_b64_tr_b16 v[74:75], v24 offset:21760
  ds_read_b64_tr_b16 v[76:77], v24 offset:20512
  ds_read_b64_tr_b16 v[78:79], v24 offset:21792
  ds_read_b64_tr_b16 v[80:81], v24 offset:20544
  ds_read_b64_tr_b16 v[82:83], v24 offset:21824
  ds_read_b64_tr_b16 v[84:85], v24 offset:20576
  ds_read_b64_tr_b16 v[86:87], v24 offset:21856
  ds_read_b64_tr_b16 v[88:89], v24 offset:20608
  ds_read_b64_tr_b16 v[90:91], v24 offset:21888
  ds_read_b64_tr_b16 v[92:93], v25 offset:20480
  ds_read_b64_tr_b16 v[94:95], v25 offset:21760
  s_waitcnt lgkmcnt(10)
  v_mfma_f32_16x16x32_bf16 v[104:107], v[72:75], v[48:51], v[104:107]
  s_waitcnt lgkmcnt(8)
  v_mfma_f32_16x16x32_bf16 v[108:111], v[76:79], v[48:51], v[108:111]
  s_waitcnt lgkmcnt(6)
  v_mfma_f32_16x16x32_bf16 v[112:115], v[80:83], v[48:51], v[112:115]
  s_waitcnt lgkmcnt(4)
  v_mfma_f32_16x16x32_bf16 v[116:119], v[48:51], v[84:87], v[116:119]
  s_waitcnt lgkmcnt(2)
  v_mfma_f32_16x16x32_bf16 v[120:123], v[48:51], v[88:91], v[120:123]
  v_mfma_f32_16x16x32_bf16 v[128:131], v[88:91], v[68:71], v[128:131]
  s_waitcnt lgkmcnt(0)
  v_mfma_f32_16x16x32_bf16 v[124:127], v[92:95], v[68:71], v[124:127]
  s_waitcnt vmcnt(6)
  s_barrier
  buffer_load_dwordx4 v[64:67], v4, s[24:27], s58 offen offset:512
  s_add_u32 m0, s34, 40960
  s_mov_b32 exec_hi, 0xff
  global_load_lds_dwordx4 v[6:7], off
  s_mov_b32 exec_hi, -1
  v_sub_co_u32 v30, vcc, v30, v29
  s_nop 1
  v_subbrev_co_u32 v31, vcc, 0, v31, vcc
  s_add_u32 m0, s34, 87040
  s_mov_b32 exec_hi, 0xff
  global_load_lds_dwordx4 v[30:31], off
  s_mov_b32 exec_hi, -1
  v_mfma_f32_16x16x32_bf16 v[132:135], v[68:71], v[52:55], v[132:135]
  v_dot2_f32_bf16 v20, v52, v52, v20
  v_dot2_f32_bf16 v21, v53, v53, v21
  v_dot2_f32_bf16 v22, v54, v54, v22
  v_dot2_f32_bf16 v23, v55, v55, v23
  ds_read_b64_tr_b16 v[72:73], v24 offset:25600
  ds_read_b64_tr_b16 v[74:75], v24 offset:26880
  ds_read_b64_tr_b16 v[76:77], v24 offset:25632
  ds_read_b64_tr_b16 v[78:79], v24 offset:26912
  ds_read_b64_tr_b16 v[80:81], v24 offset:25664
  ds_read_b64_tr_b16 v[82:83], v24 offset:26944
  ds_read_b64_tr_b16 v[84:85], v24 offset:25696
  ds_read_b64_tr_b16 v[86:87], v24 offset:26976
  ds_read_b64_tr_b16 v[88:89], v24 offset:25728
  ds_read_b64_tr_b16 v[90:91], v24 offset:27008
  ds_read_b64_tr_b16 v[92:93], v25 offset:25600
  ds_read_b64_tr_b16 v[94:95], v25 offset:26880
  s_waitcnt lgkmcnt(10)
  v_mfma_f32_16x16x32_bf16 v[104:107], v[72:75], v[52:55], v[104:107]
  s_waitcnt lgkmcnt(8)
  v_mfma_f32_16x16x32_bf16 v[108:111], v[76:79], v[52:55], v[108:111]
  s_waitcnt lgkmcnt(6)
  v_mfma_f32_16x16x32_bf16 v[112:115], v[80:83], v[52:55], v[112:115]
  s_waitcnt lgkmcnt(4)
  v_mfma_f32_16x16x32_bf16 v[116:119], v[52:55], v[84:87], v[116:119]
  s_waitcnt lgkmcnt(2)
  v_mfma_f32_16x16x32_bf16 v[120:123], v[52:55], v[88:91], v[120:123]
  v_mfma_f32_16x16x32_bf16 v[128:131], v[88:91], v[68:71], v[128:131]
  s_waitcnt lgkmcnt(0)
  v_mfma_f32_16x16x32_bf16 v[124:127], v[92:95], v[68:71], v[124:127]
  s_waitcnt vmcnt(5)
  s_barrier
  ds_read_b128 v[56:59], v166 offset:16384
  ds_read_b128 v[60:63], v167 offset:16384
  s_waitcnt lgkmcnt(1)
  v_mfma_f32_16x16x32_bf16 v[132:135], v[68:71], v[56:59], v[132:135]
  v_dot2_f32_bf16 v20, v56, v56, v20
  v_dot2_f32_bf16 v21, v57, v57, v21
  v_dot2_f32_bf16 v22, v58, v58, v22
  v_dot2_f32_bf16 v23, v59, v59, v23
  ds_read_b64_tr_b16 v[72:73], v24 offset:30720
  ds_read_b64_tr_b16 v[74:75], v24 offset:32000
  ds_read_b64_tr_b16 v[76:77], v24 offset:30752
  ds_read_b64_tr_b16 v[78:79], v24 offset:32032
  ds_read_b64_tr_b16 v[80:81], v24 offset:30784
  ds_read_b64_tr_b16 v[82:83], v24 offset:32064
  ds_read_b64_tr_b16 v[84:85], v24 offset:30816
  ds_read_b64_tr_b16 v[86:87], v24 offset:32096
  ds_read_b64_tr_b16 v[88:89], v24 offset:30848
  ds_read_b64_tr_b16 v[90:91], v24 offset:32128
  ds_read_b64_tr_b16 v[92:93], v25 offset:30720
  ds_read_b64_tr_b16 v[94:95], v25 offset:32000
  s_waitcnt lgkmcnt(10)
  v_mfma_f32_16x16x32_bf16 v[104:107], v[72:75], v[56:59], v[104:107]
  s_waitcnt lgkmcnt(8)
  v_mfma_f32_16x16x32_bf16 v[108:111], v[76:79], v[56:59], v[108:111]
  s_waitcnt lgkmcnt(6)
  v_mfma_f32_16x16x32_bf16 v[112:115], v[80:83], v[56:59], v[112:115]
  s_waitcnt lgkmcnt(4)
  v_mfma_f32_16x16x32_bf16 v[116:119], v[56:59], v[84:87], v[116:119]
  s_waitcnt lgkmcnt(2)
  v_mfma_f32_16x16x32_bf16 v[120:123], v[56:59], v[88:91], v[120:123]
  v_mfma_f32_16x16x32_bf16 v[128:131], v[88:91], v[68:71], v[128:131]
  s_waitcnt lgkmcnt(0)
  v_mfma_f32_16x16x32_bf16 v[124:127], v[92:95], v[68:71], v[124:127]
  s_waitcnt vmcnt(3)
  s_barrier
  v_mfma_f32_16x16x32_bf16 v[132:135], v[68:71], v[60:63], v[132:135]
  v_dot2_f32_bf16 v20, v60, v60, v20
  v_dot2_f32_bf16 v21, v61, v61, v21
  v_dot2_f32_bf16 v22, v62, v62, v22
  v_dot2_f32_bf16 v23, v63, v63, v23
  ds_read_b64_tr_b16 v[72:73], v24 offset:35840
  ds_read_b64_tr_b16 v[74:75], v24 offset:37120
  ds_read_b64_tr_b16 v[76:77], v24 offset:35872
  ds_read_b64_tr_b16 v[78:79], v24 offset:37152
  ds_read_b64_tr_b16 v[80:81], v24 offset:35904
  ds_read_b64_tr_b16 v[82:83], v24 offset:37184
  ds_read_b64_tr_b16 v[84:85], v24 offset:35936
  ds_read_b64_tr_b16 v[86:87], v24 offset:37216
  ds_read_b64_tr_b16 v[88:89], v24 offset:35968
  ds_read_b64_tr_b16 v[90:91], v24 offset:37248
  ds_read_b64_tr_b16 v[92:93], v25 offset:35840
  ds_read_b64_tr_b16 v[94:95], v25 offset:37120
  s_waitcnt lgkmcnt(10)
  v_mfma_f32_16x16x32_bf16 v[104:107], v[72:75], v[60:63], v[104:107]
  s_waitcnt lgkmcnt(8)
  v_mfma_f32_16x16x32_bf16 v[108:111], v[76:79], v[60:63], v[108:111]
  s_waitcnt lgkmcnt(6)
  v_mfma_f32_16x16x32_bf16 v[112:115], v[80:83], v[60:63], v[112:115]
  s_waitcnt lgkmcnt(4)
  v_mfma_f32_16x16x32_bf16 v[116:119], v[60:63], v[84:87], v[116:119]
  s_waitcnt lgkmcnt(2)
  v_mfma_f32_16x16x32_bf16 v[120:123], v[60:63], v[88:91], v[120:123]
  v_mfma_f32_16x16x32_bf16 v[128:131], v[88:91], v[68:71], v[128:131]
  s_waitcnt lgkmcnt(0)
  v_mfma_f32_16x16x32_bf16 v[124:127], v[92:95], v[68:71], v[124:127]
  s_waitcnt vmcnt(0)
  s_barrier
  ds_read_b64_tr_b16 v[176:177], v182
  ds_read_b64_tr_b16 v[178:179], v182 offset:512
  v_mfma_f32_16x16x32_bf16 v[132:135], v[68:71], v[64:67], v[132:135]
  v_dot2_f32_bf16 v20, v64, v64, v20
  v_dot2_f32_bf16 v21, v65, v65, v21
  v_dot2_f32_bf16 v22, v66, v66, v22
  v_dot2_f32_bf16 v23, v67, v67, v23
  ds_read_b64_tr_b16 v[72:73], v24 offset:40960
  ds_read_b64_tr_b16 v[74:75], v24 offset:42240
  ds_read_b64_tr_b16 v[76:77], v24 offset:40992
  ds_read_b64_tr_b16 v[78:79], v24 offset:42272
  ds_read_b64_tr_b16 v[80:81], v24 offset:41024
  ds_read_b64_tr_b16 v[82:83], v24 offset:42304
  ds_read_b64_tr_b16 v[84:85], v24 offset:41056
  ds_read_b64_tr_b16 v[86:87], v24 offset:42336
  ds_read_b64_tr_b16 v[88:89], v24 offset:41088
  ds_read_b64_tr_b16 v[90:91], v24 offset:42368
  ds_read_b64_tr_b16 v[92:93], v25 offset:40960
  ds_read_b64_tr_b16 v[94:95], v25 offset:42240
  s_waitcnt lgkmcnt(10)
  v_mfma_f32_16x16x32_bf16 v[104:107], v[72:75], v[64:67], v[104:107]
  s_waitcnt lgkmcnt(8)
  v_mfma_f32_16x16x32_bf16 v[108:111], v[76:79], v[64:67], v[108:111]
  s_waitcnt lgkmcnt(6)
  v_mfma_f32_16x16x32_bf16 v[112:115], v[80:83], v[64:67], v[112:115]
  s_waitcnt lgkmcnt(4)
  v_mfma_f32_16x16x32_bf16 v[116:119], v[64:67], v[84:87], v[116:119]
  s_waitcnt lgkmcnt(2)
  v_mfma_f32_16x16x32_bf16 v[120:123], v[64:67], v[88:91], v[120:123]
  v_mfma_f32_16x16x32_bf16 v[128:131], v[88:91], v[68:71], v[128:131]
  s_waitcnt lgkmcnt(0)
  v_mfma_f32_16x16x32_bf16 v[124:127], v[92:95], v[68:71], v[124:127]
  buffer_store_dwordx4 v[176:179], v181, s[44:47], s55 offen sc1
  v_add_f32 v20, v20, v21
  v_add_f32 v22, v22, v23
  v_add_f32 v20, v20, v22
  v_mov_b32 v10, v20
  s_nop 1
  v_permlane16_swap_b32 v20, v10
  v_add_f32 v20, v20, v10
  v_mov_b32 v10, v20
  s_nop 1
  v_permlane32_swap_b32 v20, v10
  v_add_f32 v20, v20, v10
  v_mov_b32 v10, v132
  v_mov_b32 v11, v20
  s_lshl_b32 s33, s20, 9
  s_lshl_b32 s36, s19, 7
  s_add_u32 s33, s33, s36
  s_add_u32 s33, s33, 113664
  v_lshlrev_b32 v12, 3, v3
  v_add_u32 v12, s33, v12
  s_mov_b64 exec, 0xffff
  ds_write_b64 v12, v[10:11]
  s_mov_b32 exec_lo, 0x00010001
  s_mov_b32 exec_hi, 0x00010001
  s_mul_i32 s33, s20, 320
  s_add_u32 s33, s33, 112640
  v_lshlrev_b32 v13, 4, v2
  v_add_u32 v13, s33, v13
  s_lshl_b32 s36, s19, 6
  v_add_u32 v14, s36, v13
  ds_write_b128 v14, v[124:127]
  ds_write_b128 v13, v[128:131] offset:256
  s_mov_b64 exec, -1
  s_cmp_lg_u32 s20, 0
  s_cbranch_scc1 K1_X11
  ds_write_b128 v28, v[116:119] offset:3072
  ds_write_b128 v28, v[120:123] offset:4096
  s_waitcnt lgkmcnt(0)
  s_barrier
  s_lshl_b32 s33, s19, 7
  s_add_u32 s33, s33, 113664
  v_lshlrev_b32 v12, 3, v3
  v_add_u32 v12, s33, v12
  ds_read_b64 v[20:21], v12
  ds_read_b64 v[22:23], v12 offset:512
  s_waitcnt lgkmcnt(0)
  v_add_f32 v16, v20, v22
  v_add_f32 v20, v21, v23
  v_mul_f32 v16, 0x3ae38e39, v16
  v_mul_f32 v20, 0x3ae38e39, v20
  v_fma_f32 v20, -v16, v16, v20
  v_max_f32 v20, 0, v20
  v_add_f32 v20, 0x3727c5ac, v20
  v_rsq_f32 v17, v20
  s_nop 0
  v_mul_f32 v18, 0x3eae1a93, v17
  v_lshlrev_b32 v29, 4, v2
  v_add_u32 v29, 112640, v29
  ds_read_b128 v[140:143], v28 offset:0
  ds_read_b128 v[136:139], v29 offset:0
  ds_read_b128 v[12:15], v29 offset:320
  s_waitcnt lgkmcnt(0)
  v_add_f32 v136, v136, v12
  v_add_f32 v137, v137, v13
  v_add_f32 v138, v138, v14
  v_add_f32 v139, v139, v15
  v_add_f32 v104, v104, v140
  v_add_f32 v105, v105, v141
  v_add_f32 v106, v106, v142
  v_add_f32 v107, v107, v143
  v_fma_f32 v12, -v16, v136, v104
  v_fma_f32 v13, -v16, v137, v105
  v_fma_f32 v14, -v16, v138, v106
  v_fma_f32 v15, -v16, v139, v107
  v_mul_f32 v12, v12, v18
  v_mul_f32 v13, v13, v18
  v_mul_f32 v14, v14, v18
  v_mul_f32 v15, v15, v18
  v_cvt_pk_bf16_f32 v10, v12, v13
  v_cvt_pk_bf16_f32 v11, v14, v15
  buffer_store_dwordx2 v[10:11], v26, s[28:31], 0 offen
  v_lshrrev_b32 v152, 9, v27
  v_mul_u32_u24 v152, 40960, v152
  v_bfe_u32 v153, v27, 5, 4
  v_mul_u32_u24 v153, 1152, v153
  v_add_u32 v152, v152, v153
  v_add_u32 v152, 0x240000, v152
  v_and_b32 v153, 31, v27
  v_lshrrev_b32 v154, 1, v2
  v_lshl_add_u32 v154, v154, 5, v153
  v_lshl_add_u32 v154, v154, 4, v152
  v_and_b32 v155, 1, v2
  v_lshl_add_u32 v154, v155, 3, v154
  ds_read_b128 v[140:143], v28 offset:1024
  ds_read_b128 v[136:139], v29 offset:64
  ds_read_b128 v[12:15], v29 offset:384
  s_waitcnt lgkmcnt(0)
  v_add_f32 v136, v136, v12
  v_add_f32 v137, v137, v13
  v_add_f32 v138, v138, v14
  v_add_f32 v139, v139, v15
  v_add_f32 v108, v108, v140
  v_add_f32 v109, v109, v141
  v_add_f32 v110, v110, v142
  v_add_f32 v111, v111, v143
  v_fma_f32 v12, -v16, v136, v108
  v_fma_f32 v13, -v16, v137, v109
  v_fma_f32 v14, -v16, v138, v110
  v_fma_f32 v15, -v16, v139, v111
  v_mul_f32 v12, v12, v17
  v_mul_f32 v13, v13, v17
  v_mul_f32 v14, v14, v17
  v_mul_f32 v15, v15, v17
  v_cvt_pk_bf16_f32 v10, v12, v13
  v_cvt_pk_bf16_f32 v11, v14, v15
  buffer_store_dwordx2 v[10:11], v154, s[28:31], 0 offen
  s_nop 0
  ds_read_b128 v[140:143], v28 offset:2048
  ds_read_b128 v[136:139], v29 offset:128
  ds_read_b128 v[12:15], v29 offset:448
  s_waitcnt lgkmcnt(0)
  v_add_f32 v136, v136, v12
  v_add_f32 v137, v137, v13
  v_add_f32 v138, v138, v14
  v_add_f32 v139, v139, v15
  v_add_f32 v112, v112, v140
  v_add_f32 v113, v113, v141
  v_add_f32 v114, v114, v142
  v_add_f32 v115, v115, v143
  v_fma_f32 v12, -v16, v136, v112
  v_fma_f32 v13, -v16, v137, v113
  v_fma_f32 v14, -v16, v138, v114
  v_fma_f32 v15, -v16, v139, v115
  v_mul_f32 v12, v12, v17
  v_mul_f32 v13, v13, v17
  v_mul_f32 v14, v14, v17
  v_mul_f32 v15, v15, v17
  v_cvt_pk_bf16_f32 v10, v12, v13
  v_cvt_pk_bf16_f32 v11, v14, v15
  v_lshl_add_u32 v154, v153, 2, v152
  v_cmp_eq_u32 vcc, 1, v2
  s_and_saveexec_b64 s[36:37], vcc
  buffer_store_dword v11, v154, s[28:31], 0 offen offset:1024
  s_mov_b64 exec, -1
  s_endpgm
K1_X11:
  ds_write_b128 v28, v[104:107] offset:0
  ds_write_b128 v28, v[108:111] offset:1024
  ds_write_b128 v28, v[112:115] offset:2048
  s_waitcnt lgkmcnt(0)
  s_barrier
  s_lshl_b32 s33, s19, 7
  s_add_u32 s33, s33, 113664
  v_lshlrev_b32 v12, 3, v3
  v_add_u32 v12, s33, v12
  ds_read_b64 v[20:21], v12
  ds_read_b64 v[22:23], v12 offset:512
  s_waitcnt lgkmcnt(0)
  v_add_f32 v16, v20, v22
  v_add_f32 v20, v21, v23
  v_mul_f32 v16, 0x3ae38e39, v16
  v_mul_f32 v20, 0x3ae38e39, v20
  v_fma_f32 v20, -v16, v16, v20
  v_max_f32 v20, 0, v20
  v_add_f32 v20, 0x3727c5ac, v20
  v_rsq_f32 v17, v20
  s_nop 0
  v_mul_f32 v18, 0x3eae1a93, v17
  s_lshl_b32 s33, s19, 7
  s_add_u32 s33, s33, 113664
  v_lshlrev_b32 v152, 5, v2
  v_add_u32 v152, s33, v152
  ds_read_b128 v[156:159], v152 offset:0
  ds_read_b128 v[160:163], v152 offset:16
  ds_read_b128 v[164:167], v152 offset:512
  ds_read_b128 v[168:171], v152 offset:528
  s_waitcnt lgkmcnt(1)
  v_add_f32 v144, v156, v164
  v_add_f32 v148, v157, v165
  v_mul_f32 v144, 0x3ae38e39, v144
  v_mul_f32 v148, 0x3ae38e39, v148
  v_fma_f32 v148, -v144, v144, v148
  v_max_f32 v148, 0, v148
  v_add_f32 v148, 0x3727c5ac, v148
  v_rsq_f32 v148, v148
  v_add_f32 v145, v158, v166
  v_add_f32 v149, v159, v167
  v_mul_f32 v145, 0x3ae38e39, v145
  v_mul_f32 v149, 0x3ae38e39, v149
  v_fma_f32 v149, -v145, v145, v149
  v_max_f32 v149, 0, v149
  v_add_f32 v149, 0x3727c5ac, v149
  v_rsq_f32 v149, v149
  s_waitcnt lgkmcnt(0)
  v_add_f32 v146, v160, v168
  v_add_f32 v150, v161, v169
  v_mul_f32 v146, 0x3ae38e39, v146
  v_mul_f32 v150, 0x3ae38e39, v150
  v_fma_f32 v150, -v146, v146, v150
  v_max_f32 v150, 0, v150
  v_add_f32 v150, 0x3727c5ac, v150
  v_rsq_f32 v150, v150
  v_add_f32 v147, v162, v170
  v_add_f32 v151, v163, v171
  v_mul_f32 v147, 0x3ae38e39, v147
  v_mul_f32 v151, 0x3ae38e39, v151
  v_fma_f32 v151, -v147, v147, v151
  v_max_f32 v151, 0, v151
  v_add_f32 v151, 0x3727c5ac, v151
  v_rsq_f32 v151, v151
  s_lshr_b32 s33, s23, 4
  s_lshr_b32 s34, s33, 5
  s_mul_i32 s34, s34, 40960
  s_and_b32 s33, s33, 31
  s_mul_i32 s33, s33, 608
  s_add_u32 s33, s33, s34
  s_add_u32 s33, s33, 0x244800
  v_and_b32 v172, 1, v2
  v_mul_u32_u24 v172, 19, v172
  v_add_u32 v172, v172, v3
  v_lshlrev_b32 v172, 4, v172
  v_lshrrev_b32 v173, 1, v2
  v_lshl_add_u32 v172, v173, 3, v172
  v_add_u32 v172, s33, v172
  v_lshlrev_b32 v29, 2, v3
  v_add_u32 v29, 112640, v29
  ds_read_b128 v[140:143], v28 offset:3072
  ds_read_b32 v136, v29 offset:192
  ds_read_b32 v137, v29 offset:512
  s_waitcnt lgkmcnt(0)
  v_add_f32 v136, v136, v137
  v_add_f32 v116, v116, v140
  v_add_f32 v117, v117, v141
  v_add_f32 v118, v118, v142
  v_add_f32 v119, v119, v143
  v_fma_f32 v12, -v144, v136, v116
  v_fma_f32 v13, -v145, v136, v117
  v_fma_f32 v14, -v146, v136, v118
  v_fma_f32 v15, -v147, v136, v119
  v_mul_f32 v12, v12, v148
  v_mul_f32 v13, v13, v149
  v_mul_f32 v14, v14, v150
  v_mul_f32 v15, v15, v151
  v_cvt_pk_bf16_f32 v10, v12, v13
  v_cvt_pk_bf16_f32 v11, v14, v15
  buffer_store_dwordx2 v[10:11], v172, s[28:31], 0 offen
  s_nop 0
  ds_read_b128 v[140:143], v28 offset:4096
  ds_read_b32 v136, v29 offset:256
  ds_read_b32 v137, v29 offset:576
  s_waitcnt lgkmcnt(0)
  v_add_f32 v136, v136, v137
  v_add_f32 v120, v120, v140
  v_add_f32 v121, v121, v141
  v_add_f32 v122, v122, v142
  v_add_f32 v123, v123, v143
  v_fma_f32 v12, -v144, v136, v120
  v_fma_f32 v13, -v145, v136, v121
  v_fma_f32 v14, -v146, v136, v122
  v_fma_f32 v15, -v147, v136, v123
  v_mul_f32 v12, v12, v148
  v_mul_f32 v13, v13, v149
  v_mul_f32 v14, v14, v150
  v_mul_f32 v15, v15, v151
  v_cvt_pk_bf16_f32 v10, v12, v13
  v_cvt_pk_bf16_f32 v11, v14, v15
  v_cmp_eq_u32 vcc, 8, v3
  v_mov_b32 v12, 0x3f803f80
  s_nop 0
  v_cndmask_b32 v10, v10, v12, vcc
  v_cndmask_b32 v11, v11, v12, vcc
  v_add_u32 v172, 160, v172
  v_add_u32 v12, -6, v3
  v_cmp_gt_u32 vcc, 3, v12
  s_and_saveexec_b64 s[36:37], vcc
  buffer_store_dwordx2 v[10:11], v172, s[28:31], 0 offen
  s_mov_b64 exec, -1
  s_endpgm
K1_END:
  s_endpgm
.globl m_kernel
.p2align 8
.type m_kernel,@function
m_kernel:
  s_load_dwordx2 s[12:13], s[0:1], 88
  s_cmp_ge_u32 s2, 256
  s_cbranch_scc1 M_END
  v_and_b32 v1, 63, v0
  v_lshrrev_b32 v104, 6, v0
  s_nop 0
  v_readfirstlane_b32 s16, v104
  s_lshl_b32 s50, s2, 3
  s_add_u32 s50, s50, s16
  s_mov_b32 s51, 32
  s_cmp_lt_u32 s50, 1944
  s_cselect_b32 s51, 64, s51
  s_cmp_lt_u32 s50, 1296
  s_cselect_b32 s51, 56, s51
  s_cmp_lt_u32 s50, 648
  s_cselect_b32 s51, 48, s51
  s_load_dwordx2 s[56:57], s[0:1], s51
  v_and_b32 v3, 31, v1
  v_lshrrev_b32 v2, 5, v1
  s_lshr_b32 s17, s2, 6
  s_lshl_b32 s17, s17, 3
  s_and_b32 s18, s2, 7
  s_add_u32 s17, s17, s18
  s_lshl_b32 s17, s17, 3
  s_bfe_u32 s18, s2, 0x30003
  s_add_u32 s3, s17, s18
  s_lshl_b32 s17, s3, 3
  s_add_u32 s17, s17, s16
  s_mul_i32 s18, s17, 1152
  v_mul_u32_u24 v4, 36, v3
  v_add_u32 v4, s18, v4
  v_lshl_add_u32 v104, v2, 4, v4
  v_lshlrev_b32 v105, 4, v0
  s_waitcnt lgkmcnt(0)
  s_mov_b32 s24, s12
  s_mov_b32 s25, s13
  s_mov_b32 s26, 0x240000
  s_mov_b32 s27, 0x00020000
  s_add_u32 s28, s12, 0x240000
  s_addc_u32 s29, s13, 0
  s_mov_b32 s30, 0x28000
  s_mov_b32 s31, 0x00020000
  s_add_u32 s32, s12, 0x280000
  s_addc_u32 s33, s13, 0
  s_mov_b32 s34, 0x240000
  s_mov_b32 s35, 0x00020000
  buffer_load_dwordx4 v[8:11], v104, s[24:27], 0 offen
  buffer_load_dword v12, v4, s[24:27], 0 offen offset:32
  s_lshl_b32 s19, s16, 10
  s_cmp_lt_u32 s16, 5
  s_cselect_b32 s43, 8, 6
  s_lshl_b32 s43, s43, 12
  v_mov_b32 v117, v105
  s_add_u32 m0, s19, 0
  s_mov_b32 s20, 0
  buffer_load_dwordx4 v117, s[28:31], s20 offen lds
  s_add_u32 m0, s19, 8192
  s_mov_b32 s20, 8192
  buffer_load_dwordx4 v117, s[28:31], s20 offen lds
  s_add_u32 m0, s19, 16384
  s_mov_b32 s20, 16384
  buffer_load_dwordx4 v117, s[28:31], s20 offen lds
  s_add_u32 m0, s19, 24576
  s_mov_b32 s20, 24576
  buffer_load_dwordx4 v117, s[28:31], s20 offen lds
  s_add_u32 s20, s43, 0
  s_add_u32 m0, s19, s20
  s_nop 0
  buffer_load_dwordx4 v117, s[28:31], s20 offen lds
  s_lshr_b32 s52, s16, 1
  s_mul_i32 s52, s52, 40960
  s_and_b32 s53, s16, 1
  s_mul_i32 s53, s53, 1168
  s_add_u32 s52, s52, s53
  s_add_u32 s52, s52, 37888
  v_lshrrev_b32 v108, 3, v1
  v_and_b32 v109, 7, v1
  v_lshlrev_b32 v109, 4, v109
  v_lshrrev_b32 v110, 4, v1
  v_and_b32 v111, 15, v1
  v_lshrrev_b32 v120, 2, v111
  v_lshlrev_b32 v120, 7, v120
  v_lshl_add_u32 v120, v110, 5, v120
  v_and_b32 v121, 3, v111
  v_lshl_add_u32 v120, v121, 3, v120
  v_add_u32 v120, s52, v120
  v_lshlrev_b32 v111, 4, v111
  v_mov_b32 v122, 0x3f803f80
  v_lshlrev_b32 v123, 4, v1
  v_add_u32 v123, s52, v123
  s_add_u32 s60, s12, 0x4000000
  s_addc_u32 s61, s13, 0
  s_mov_b32 s62, 0x1200000
  s_mov_b32 s63, 0x00020000
  s_add_u32 s4, s12, 0x4000000
  s_addc_u32 s5, s13, 0
  s_mov_b32 s6, 0x1200000
  s_mov_b32 s7, 0x00020000
  s_mov_b32 s59, 0x00020000
  s_mov_b32 s96, s56
  s_mov_b32 s97, s57
  s_mov_b32 s98, 0
  s_mov_b32 s99, 0x00020000
  s_cmp_lt_u32 s50, 1296
  s_cbranch_scc0 PK_NOT1
  s_cmp_ge_u32 s50, 648
  s_cselect_b32 s51, 1, 0
  s_mul_i32 s53, s51, 648
  s_sub_u32 s53, s50, s53
  s_mul_hi_u32 s54, s53, 0x38e38e4
  s_mul_i32 s55, s54, 72
  s_sub_u32 s55, s53, s55
  s_mul_i32 s8, s54, 589824
  s_lshl_b32 s48, s55, 7
  s_add_u32 s8, s8, s48
  s_mul_i32 s9, s55, 147456
  s_lshl_b32 s48, s54, 12
  s_add_u32 s9, s9, s48
  s_lshl_b32 s48, s51, 10
  s_add_u32 s9, s9, s48
  s_mov_b32 s10, 73728
  s_mov_b32 s11, 73728
  s_mov_b32 s14, 1280
  s_mul_i32 s48, s51, 9
  s_add_u32 s48, s48, s54
  s_mul_i32 s15, s48, 18432
  s_lshl_b32 s48, s55, 8
  s_add_u32 s15, s15, s48
  s_add_u32 s15, s15, 0x1100000
  s_mov_b32 s58, 5308416
  v_mul_u32_u24 v118, 9216, v108
  v_add_u32 v118, v118, v109
  v_mul_u32_u24 v119, 36864, v110
  v_add_u32 v119, v119, v111
  v_mov_b32 v116, 0x40000000
  s_branch PK_SET
PK_NOT1:
  s_mov_b32 s6, 0
  s_mov_b32 s15, 0
  s_cmp_lt_u32 s50, 1944
  s_cbranch_scc0 PK_NOT2
  s_sub_u32 s53, s50, 1296
  s_mul_hi_u32 s54, s53, 0x1c71c71d
  s_mul_i32 s55, s54, 9
  s_sub_u32 s55, s53, s55
  s_mul_i32 s8, s54, 73728
  s_lshl_b32 s48, s55, 7
  s_add_u32 s8, s8, s48
  s_mul_hi_u32 s51, s54, 0xe38e38f
  s_mul_i32 s48, s51, 18
  s_sub_u32 s48, s54, s48
  s_mul_i32 s51, s51, 144
  s_lshl_b32 s48, s48, 1
  s_mul_i32 s49, s48, 57
  s_lshr_b32 s49, s49, 9
  s_mul_i32 s53, s49, 9
  s_sub_u32 s48, s48, s53
  s_cmp_eq_u32 s48, 8
  s_mov_b32 s14, 36096
  s_cselect_b32 s14, 0xfffba100, s14
  s_lshl_b32 s48, s48, 2
  s_add_u32 s48, s48, s49
  s_add_u32 s51, s51, s48
  s_mul_i32 s9, s51, 9216
  s_add_u32 s9, s9, 0xb00000
  s_mov_b32 s10, 4608
  s_mov_b32 s11, 23040
  s_mov_b32 s58, 5308416
  v_lshrrev_b32 v118, 2, v108
  v_and_b32 v119, 3, v108
  v_lshl_add_u32 v118, v118, 4, v119
  v_mul_u32_u24 v118, 1152, v118
  v_add_u32 v118, v118, v109
  s_lshl_b32 s55, s55, 2
  v_add_u32 v110, s55, v110
  v_mul_u32_u24 v108, 7282, v110
  v_lshrrev_b32 v108, 16, v108
  v_mul_u32_u24 v109, 9, v108
  v_sub_u32 v110, v110, v109
  v_mul_u32_u24 v119, 331776, v108
  v_lshl_add_u32 v119, v110, 10, v119
  v_add_u32 v119, v119, v111
  v_mov_b32 v116, 0x40000000
  s_branch PK_SET
PK_NOT2:
  s_sub_u32 s53, s50, 1944
  s_mul_hi_u32 s54, s53, 0x1c71c71d
  s_mul_i32 s55, s54, 9
  s_sub_u32 s55, s53, s55
  s_mul_i32 s8, s54, 73728
  s_lshl_b32 s48, s55, 7
  s_add_u32 s8, s8, s48
  s_mul_i32 s9, s55, 73728
  s_lshl_b32 s48, s54, 11
  s_add_u32 s9, s9, s48
  s_add_u32 s9, s9, 0x1040000
  s_mov_b32 s10, 9216
  s_mov_b32 s11, 9216
  s_mov_b32 s14, 256
  s_mov_b32 s58, 663552
  v_mul_u32_u24 v118, 1152, v108
  v_add_u32 v118, v118, v109
  v_mul_u32_u24 v119, 18432, v110
  v_add_u32 v119, v119, v111
  v_mov_b32 v116, 0x40000000
  s_cmp_lt_u32 s53, 0
  s_cbranch_scc1 PK_SET
  s_mov_b32 s58, 0
  s_mov_b32 s62, 0
  s_mov_b32 s8, 0
  s_mov_b32 s9, 0
  s_mov_b32 s10, 0
  s_mov_b32 s11, 0
  s_mov_b32 s14, 0
PK_SET:
  v_mov_b32 v121, 0
  v_lshlrev_b32 v100, 4, v1
  v_lshlrev_b32 v101, 2, v3
  v_add_u32 v101, 1024, v101
  v_mov_b32 v106, v3
  v_cmp_lt_u32 vcc, 18, v3
  s_nop 1
  v_cndmask_b32 v106, v106, 4, vcc
  v_add_u32 v107, -20, v3
  v_cmp_gt_u32 vcc, 8, v107
  s_nop 1
  v_cndmask_b32 v106, v106, 0, vcc
  v_mul_u32_u24 v107, 19, v2
  v_add_u32 v106, v106, v107
  v_lshlrev_b32 v102, 4, v106
  v_add_u32 v102, 18432, v102
  v_mov_b32 v81, 0
  v_mov_b32 v83, 0
  v_mov_b32 v56, 0
  v_mov_b32 v57, 0
  v_mov_b32 v58, 0
  v_mov_b32 v59, 0
  v_mov_b32 v60, 0
  v_mov_b32 v61, 0
  v_mov_b32 v62, 0
  v_mov_b32 v63, 0
  v_mov_b32 v64, 0
  v_mov_b32 v65, 0
  v_mov_b32 v66, 0
  v_mov_b32 v67, 0
  v_mov_b32 v68, 0
  v_mov_b32 v69, 0
  v_mov_b32 v70, 0
  v_mov_b32 v71, 0
  v_mov_b32 v52, 0
  v_mov_b32 v96, 0
  v_mov_b32 v53, 0
  v_mov_b32 v97, 0
  v_mov_b32 v54, 0
  v_mov_b32 v98, 0
  v_mov_b32 v55, 0
  v_mov_b32 v99, 0
  v_mov_b32 v13, 0
  v_cmp_eq_u32 vcc, 0, v2
  s_waitcnt vmcnt(5)
  s_nop 0
  v_cndmask_b32 v12, 0, v12, vcc
  v_mov_b32 v106, 163824
  v_mov_b32 v136, 0
  v_mov_b32 v137, 0
  v_mov_b32 v138, 0
  v_mov_b32 v139, 0
  ds_write_b128 v106, v[136:139]
  s_mov_b32 s88, 0
  s_waitcnt lgkmcnt(0)
  s_waitcnt vmcnt(0)
  s_barrier
  s_cmp_lt_u32 s16, 4
  s_cbranch_scc1 K2_KVY
  s_sub_u32 s20, s16, 4
  s_mul_i32 s20, s20, 10
  s_min_u32 s20, s20, 27
  s_lshl_b32 s20, s20, 10
  v_lshlrev_b32 v117, 4, v1
  s_add_u32 s19, s20, 40960
  s_mov_b32 m0, s19
  s_nop 0
  buffer_load_dwordx4 v117, s[28:31], s19 offen offset:0 lds
  buffer_load_dwordx4 v117, s[28:31], s19 offen offset:1024 lds
  buffer_load_dwordx4 v117, s[28:31], s19 offen offset:2048 lds
  buffer_load_dwordx4 v117, s[28:31], s19 offen offset:3072 lds
  s_add_u32 s19, s20, 45056
  s_mov_b32 m0, s19
  s_nop 0
  buffer_load_dwordx4 v117, s[28:31], s19 offen offset:0 lds
  buffer_load_dwordx4 v117, s[28:31], s19 offen offset:1024 lds
  buffer_load_dwordx4 v117, s[28:31], s19 offen offset:2048 lds
  buffer_load_dwordx4 v117, s[28:31], s19 offen offset:3072 lds
  s_add_u32 s19, s20, 49152
  s_mov_b32 m0, s19
  s_nop 0
  buffer_load_dwordx4 v117, s[28:31], s19 offen offset:0 lds
  buffer_load_dwordx4 v117, s[28:31], s19 offen offset:1024 lds
  s_add_u32 s19, s20, 81920
  s_mov_b32 m0, s19
  s_nop 0
  buffer_load_dwordx4 v117, s[28:31], s19 offen offset:0 lds
  buffer_load_dwordx4 v117, s[28:31], s19 offen offset:1024 lds
  buffer_load_dwordx4 v117, s[28:31], s19 offen offset:2048 lds
  buffer_load_dwordx4 v117, s[28:31], s19 offen offset:3072 lds
  s_add_u32 s19, s20, 86016
  s_mov_b32 m0, s19
  s_nop 0
  buffer_load_dwordx4 v117, s[28:31], s19 offen offset:0 lds
  buffer_load_dwordx4 v117, s[28:31], s19 offen offset:1024 lds
  buffer_load_dwordx4 v117, s[28:31], s19 offen offset:2048 lds
  buffer_load_dwordx4 v117, s[28:31], s19 offen offset:3072 lds
  s_add_u32 s19, s20, 90112
  s_mov_b32 m0, s19
  s_nop 0
  buffer_load_dwordx4 v117, s[28:31], s19 offen offset:0 lds
  buffer_load_dwordx4 v117, s[28:31], s19 offen offset:1024 lds
  s_add_u32 s19, s20, 122880
  s_mov_b32 m0, s19
  s_nop 0
  buffer_load_dwordx4 v117, s[28:31], s19 offen offset:0 lds
  buffer_load_dwordx4 v117, s[28:31], s19 offen offset:1024 lds
  buffer_load_dwordx4 v117, s[28:31], s19 offen offset:2048 lds
  buffer_load_dwordx4 v117, s[28:31], s19 offen offset:3072 lds
  s_add_u32 s19, s20, 126976
  s_mov_b32 m0, s19
  s_nop 0
  buffer_load_dwordx4 v117, s[28:31], s19 offen offset:0 lds
  buffer_load_dwordx4 v117, s[28:31], s19 offen offset:1024 lds
  buffer_load_dwordx4 v117, s[28:31], s19 offen offset:2048 lds
  buffer_load_dwordx4 v117, s[28:31], s19 offen offset:3072 lds
  s_add_u32 s19, s20, 131072
  s_mov_b32 m0, s19
  s_nop 0
  buffer_load_dwordx4 v117, s[28:31], s19 offen offset:0 lds
  buffer_load_dwordx4 v117, s[28:31], s19 offen offset:1024 lds
  s_setprio 1
K2_KVY:
  s_mov_b32 m0, s52
  s_cmp_eq_u32 s16, 99
  buffer_load_dwordx4 v118, s[56:59], s8 offen nt lds
  s_cselect_b32 s51, s11, s10
  s_add_u32 s8, s8, s51
  buffer_load_dword v123, v116, s[96:99], 0 offen
  ds_read_b128 v[72:75], v100 offset:0
  ds_read_b32 v80, v101 offset:0
  ds_read_b128 v[76:79], v100 offset:1152
  ds_read_b32 v82, v101 offset:1152
  ds_read_b128 v[84:87], v102 offset:0
  ds_read_b128 v[88:91], v102 offset:608
  s_waitcnt lgkmcnt(4)
  v_mfma_f32_32x32x8_bf16 v[16:31], v[80:81], v[12:13], 0
  v_mfma_f32_32x32x16_bf16 v[16:31], v[72:75], v[8:11], v[16:31]
  s_mov_b32 s21, 0
  s_mov_b32 s23, -122880
  s_mov_b32 s42, 40960
  s_nop 9
K2_LOOP:
  s_cmp_eq_u32 s21, 3
  s_cselect_b32 s22, s23, s42
  s_cmp_lt_u32 s21, 3
  s_cbranch_scc1 K2_PR
  s_setprio 0
K2_PR:
  v_exp_f32 v16, v16
  v_exp_f32 v17, v17
  v_exp_f32 v18, v18
  v_exp_f32 v19, v19
  s_waitcnt lgkmcnt(2)
  v_mfma_f32_32x32x8_bf16 v[32:47], v[82:83], v[12:13], 0
  v_exp_f32 v20, v20
  v_exp_f32 v21, v21
  v_cvt_pk_bf16_f32 v48, v16, v17
  v_exp_f32 v22, v22
  v_cvt_pk_bf16_f32 v49, v18, v19
  v_mfma_f32_32x32x16_bf16 v[56:71], v[96:99], v[52:55], v[56:71]
  v_exp_f32 v23, v23
  v_exp_f32 v24, v24
  v_cvt_pk_bf16_f32 v50, v20, v21
  v_exp_f32 v25, v25
  v_cvt_pk_bf16_f32 v51, v22, v23
  v_mfma_f32_32x32x16_bf16 v[32:47], v[76:79], v[8:11], v[32:47]
  ds_read_b128 v[72:75], v100 offset:2304
  ds_read_b32 v80, v101 offset:2304
  v_exp_f32 v26, v26
  v_exp_f32 v27, v27
  v_exp_f32 v28, v28
  v_exp_f32 v29, v29
  s_waitcnt lgkmcnt(3)
  v_mfma_f32_32x32x16_bf16 v[56:71], v[84:87], v[48:51], v[56:71]
  ds_read_b128 v[92:95], v102 offset:1216
  ds_read_b128 v[96:99], v102 offset:1824
  v_exp_f32 v30, v30
  v_exp_f32 v31, v31
  v_cvt_pk_bf16_f32 v52, v24, v25
  v_cvt_pk_bf16_f32 v53, v26, v27
  v_cvt_pk_bf16_f32 v54, v28, v29
  v_cvt_pk_bf16_f32 v55, v30, v31
  v_exp_f32 v32, v32
  v_exp_f32 v33, v33
  v_exp_f32 v34, v34
  v_exp_f32 v35, v35
  s_waitcnt lgkmcnt(2)
  v_mfma_f32_32x32x8_bf16 v[16:31], v[80:81], v[12:13], 0
  v_exp_f32 v36, v36
  v_exp_f32 v37, v37
  v_cvt_pk_bf16_f32 v48, v32, v33
  v_exp_f32 v38, v38
  v_cvt_pk_bf16_f32 v49, v34, v35
  v_mfma_f32_32x32x16_bf16 v[56:71], v[88:91], v[52:55], v[56:71]
  v_exp_f32 v39, v39
  v_exp_f32 v40, v40
  v_cvt_pk_bf16_f32 v50, v36, v37
  v_exp_f32 v41, v41
  v_cvt_pk_bf16_f32 v51, v38, v39
  v_mfma_f32_32x32x16_bf16 v[16:31], v[72:75], v[8:11], v[16:31]
  ds_read_b128 v[76:79], v100 offset:3456
  ds_read_b32 v82, v101 offset:3456
  v_exp_f32 v42, v42
  v_exp_f32 v43, v43
  v_exp_f32 v44, v44
  v_exp_f32 v45, v45
  s_waitcnt lgkmcnt(3)
  v_mfma_f32_32x32x16_bf16 v[56:71], v[92:95], v[48:51], v[56:71]
  ds_read_b128 v[84:87], v102 offset:2432
  ds_read_b128 v[88:91], v102 offset:3040
  v_exp_f32 v46, v46
  v_exp_f32 v47, v47
  v_cvt_pk_bf16_f32 v52, v40, v41
  v_cvt_pk_bf16_f32 v53, v42, v43
  v_cvt_pk_bf16_f32 v54, v44, v45
  v_cvt_pk_bf16_f32 v55, v46, v47
  v_exp_f32 v16, v16
  v_exp_f32 v17, v17
  v_exp_f32 v18, v18
  v_exp_f32 v19, v19
  s_waitcnt lgkmcnt(2)
  v_mfma_f32_32x32x8_bf16 v[32:47], v[82:83], v[12:13], 0
  v_exp_f32 v20, v20
  v_exp_f32 v21, v21
  v_cvt_pk_bf16_f32 v48, v16, v17
  v_exp_f32 v22, v22
  v_cvt_pk_bf16_f32 v49, v18, v19
  v_mfma_f32_32x32x16_bf16 v[56:71], v[96:99], v[52:55], v[56:71]
  v_exp_f32 v23, v23
  v_exp_f32 v24, v24
  v_cvt_pk_bf16_f32 v50, v20, v21
  v_exp_f32 v25, v25
  v_cvt_pk_bf16_f32 v51, v22, v23
  v_mfma_f32_32x32x16_bf16 v[32:47], v[76:79], v[8:11], v[32:47]
  ds_read_b128 v[72:75], v100 offset:4608
  ds_read_b32 v80, v101 offset:4608
  v_exp_f32 v26, v26
  v_exp_f32 v27, v27
  v_exp_f32 v28, v28
  v_exp_f32 v29, v29
  s_waitcnt lgkmcnt(3)
  v_mfma_f32_32x32x16_bf16 v[56:71], v[84:87], v[48:51], v[56:71]
  ds_read_b128 v[92:95], v102 offset:3648
  ds_read_b128 v[96:99], v102 offset:4256
  v_exp_f32 v30, v30
  v_exp_f32 v31, v31
  v_cvt_pk_bf16_f32 v52, v24, v25
  v_cvt_pk_bf16_f32 v53, v26, v27
  v_cvt_pk_bf16_f32 v54, v28, v29
  v_cvt_pk_bf16_f32 v55, v30, v31
  v_exp_f32 v32, v32
  v_exp_f32 v33, v33
  v_exp_f32 v34, v34
  v_exp_f32 v35, v35
  s_waitcnt lgkmcnt(2)
  v_mfma_f32_32x32x8_bf16 v[16:31], v[80:81], v[12:13], 0
  v_exp_f32 v36, v36
  v_exp_f32 v37, v37
  v_cvt_pk_bf16_f32 v48, v32, v33
  v_exp_f32 v38, v38
  v_cvt_pk_bf16_f32 v49, v34, v35
  v_mfma_f32_32x32x16_bf16 v[56:71], v[88:91], v[52:55], v[56:71]
  v_exp_f32 v39, v39
  v_exp_f32 v40, v40
  v_cvt_pk_bf16_f32 v50, v36, v37
  v_exp_f32 v41, v41
  v_cvt_pk_bf16_f32 v51, v38, v39
  v_mfma_f32_32x32x16_bf16 v[16:31], v[72:75], v[8:11], v[16:31]
  ds_read_b128 v[76:79], v100 offset:5760
  ds_read_b32 v82, v101 offset:5760
  v_exp_f32 v42, v42
  v_exp_f32 v43, v43
  v_exp_f32 v44, v44
  v_exp_f32 v45, v45
  s_waitcnt lgkmcnt(3)
  v_mfma_f32_32x32x16_bf16 v[56:71], v[92:95], v[48:51], v[56:71]
  ds_read_b128 v[84:87], v102 offset:4864
  ds_read_b128 v[88:91], v102 offset:5472
  v_exp_f32 v46, v46
  v_exp_f32 v47, v47
  v_cvt_pk_bf16_f32 v52, v40, v41
  v_cvt_pk_bf16_f32 v53, v42, v43
  v_cvt_pk_bf16_f32 v54, v44, v45
  v_cvt_pk_bf16_f32 v55, v46, v47
  v_exp_f32 v16, v16
  v_exp_f32 v17, v17
  v_exp_f32 v18, v18
  v_exp_f32 v19, v19
  s_waitcnt lgkmcnt(2)
  v_mfma_f32_32x32x8_bf16 v[32:47], v[82:83], v[12:13], 0
  v_exp_f32 v20, v20
  v_exp_f32 v21, v21
  v_cvt_pk_bf16_f32 v48, v16, v17
  v_exp_f32 v22, v22
  v_cvt_pk_bf16_f32 v49, v18, v19
  v_mfma_f32_32x32x16_bf16 v[56:71], v[96:99], v[52:55], v[56:71]
  v_exp_f32 v23, v23
  v_exp_f32 v24, v24
  v_cvt_pk_bf16_f32 v50, v20, v21
  v_exp_f32 v25, v25
  v_cvt_pk_bf16_f32 v51, v22, v23
  v_mfma_f32_32x32x16_bf16 v[32:47], v[76:79], v[8:11], v[32:47]
  ds_read_b128 v[72:75], v100 offset:6912
  ds_read_b32 v80, v101 offset:6912
  v_exp_f32 v26, v26
  v_exp_f32 v27, v27
  v_exp_f32 v28, v28
  v_exp_f32 v29, v29
  s_waitcnt lgkmcnt(3)
  v_mfma_f32_32x32x16_bf16 v[56:71], v[84:87], v[48:51], v[56:71]
  ds_read_b128 v[92:95], v102 offset:6080
  ds_read_b128 v[96:99], v102 offset:6688
  v_exp_f32 v30, v30
  v_exp_f32 v31, v31
  v_cvt_pk_bf16_f32 v52, v24, v25
  v_cvt_pk_bf16_f32 v53, v26, v27
  v_cvt_pk_bf16_f32 v54, v28, v29
  v_cvt_pk_bf16_f32 v55, v30, v31
  v_exp_f32 v32, v32
  v_exp_f32 v33, v33
  v_exp_f32 v34, v34
  v_exp_f32 v35, v35
  s_waitcnt lgkmcnt(2)
  v_mfma_f32_32x32x8_bf16 v[16:31], v[80:81], v[12:13], 0
  v_exp_f32 v36, v36
  v_exp_f32 v37, v37
  v_cvt_pk_bf16_f32 v48, v32, v33
  v_exp_f32 v38, v38
  v_cvt_pk_bf16_f32 v49, v34, v35
  v_mfma_f32_32x32x16_bf16 v[56:71], v[88:91], v[52:55], v[56:71]
  v_exp_f32 v39, v39
  v_exp_f32 v40, v40
  v_cvt_pk_bf16_f32 v50, v36, v37
  v_exp_f32 v41, v41
  v_cvt_pk_bf16_f32 v51, v38, v39
  v_mfma_f32_32x32x16_bf16 v[16:31], v[72:75], v[8:11], v[16:31]
  ds_read_b128 v[76:79], v100 offset:8064
  ds_read_b32 v82, v101 offset:8064
  v_exp_f32 v42, v42
  v_exp_f32 v43, v43
  v_exp_f32 v44, v44
  v_exp_f32 v45, v45
  s_waitcnt lgkmcnt(3)
  v_mfma_f32_32x32x16_bf16 v[56:71], v[92:95], v[48:51], v[56:71]
  ds_read_b128 v[84:87], v102 offset:7296
  ds_read_b128 v[88:91], v102 offset:7904
  v_exp_f32 v46, v46
  v_exp_f32 v47, v47
  v_cvt_pk_bf16_f32 v52, v40, v41
  v_cvt_pk_bf16_f32 v53, v42, v43
  v_cvt_pk_bf16_f32 v54, v44, v45
  v_cvt_pk_bf16_f32 v55, v46, v47
  s_waitcnt vmcnt(1)
  ds_read_b64_tr_b16 v[124:125], v120
  ds_read_b64_tr_b16 v[126:127], v120 offset:512
  v_exp_f32 v16, v16
  v_exp_f32 v17, v17
  v_exp_f32 v18, v18
  v_exp_f32 v19, v19
  s_waitcnt lgkmcnt(4)
  v_mfma_f32_32x32x8_bf16 v[32:47], v[82:83], v[12:13], 0
  v_exp_f32 v20, v20
  v_exp_f32 v21, v21
  v_cvt_pk_bf16_f32 v48, v16, v17
  v_exp_f32 v22, v22
  v_cvt_pk_bf16_f32 v49, v18, v19
  v_mfma_f32_32x32x16_bf16 v[56:71], v[96:99], v[52:55], v[56:71]
  v_exp_f32 v23, v23
  v_exp_f32 v24, v24
  v_cvt_pk_bf16_f32 v50, v20, v21
  v_exp_f32 v25, v25
  v_cvt_pk_bf16_f32 v51, v22, v23
  v_mfma_f32_32x32x16_bf16 v[32:47], v[76:79], v[8:11], v[32:47]
  ds_read_b128 v[72:75], v100 offset:9216
  ds_read_b32 v80, v101 offset:9216
  v_exp_f32 v26, v26
  v_exp_f32 v27, v27
  v_exp_f32 v28, v28
  v_exp_f32 v29, v29
  s_waitcnt lgkmcnt(5)
  v_mfma_f32_32x32x16_bf16 v[56:71], v[84:87], v[48:51], v[56:71]
  ds_read_b128 v[92:95], v102 offset:8512
  ds_read_b128 v[96:99], v102 offset:9120
  v_exp_f32 v30, v30
  v_exp_f32 v31, v31
  v_cvt_pk_bf16_f32 v52, v24, v25
  v_cvt_pk_bf16_f32 v53, v26, v27
  v_cvt_pk_bf16_f32 v54, v28, v29
  v_cvt_pk_bf16_f32 v55, v30, v31
  s_waitcnt lgkmcnt(5)
  v_dot2_f32_bf16 v121, v124, v122, v121
  v_dot2_f32_bf16 v121, v125, v122, v121
  s_waitcnt lgkmcnt(4)
  v_dot2_f32_bf16 v121, v126, v122, v121
  v_dot2_f32_bf16 v121, v127, v122, v121
  s_mov_b32 m0, s52
  s_bitcmp1_b32 s21, 0
  buffer_load_dwordx4 v118, s[56:59], s8 offen nt lds
  s_cselect_b32 s51, s11, s10
  s_add_u32 s8, s8, s51
  buffer_store_dwordx4 v[124:127], v119, s[60:63], s9 offen sc1
  s_cmp_eq_u32 s21, 99
  s_cselect_b32 s53, s14, 256
  s_add_u32 s9, s9, s53
  v_exp_f32 v32, v32
  v_exp_f32 v33, v33
  v_exp_f32 v34, v34
  v_exp_f32 v35, v35
  s_waitcnt lgkmcnt(2)
  v_mfma_f32_32x32x8_bf16 v[16:31], v[80:81], v[12:13], 0
  v_exp_f32 v36, v36
  v_exp_f32 v37, v37
  v_cvt_pk_bf16_f32 v48, v32, v33
  v_exp_f32 v38, v38
  v_cvt_pk_bf16_f32 v49, v34, v35
  v_mfma_f32_32x32x16_bf16 v[56:71], v[88:91], v[52:55], v[56:71]
  v_exp_f32 v39, v39
  v_exp_f32 v40, v40
  v_cvt_pk_bf16_f32 v50, v36, v37
  v_exp_f32 v41, v41
  v_cvt_pk_bf16_f32 v51, v38, v39
  v_mfma_f32_32x32x16_bf16 v[16:31], v[72:75], v[8:11], v[16:31]
  ds_read_b128 v[76:79], v100 offset:10368
  ds_read_b32 v82, v101 offset:10368
  v_exp_f32 v42, v42
  v_exp_f32 v43, v43
  v_exp_f32 v44, v44
  v_exp_f32 v45, v45
  s_waitcnt lgkmcnt(3)
  v_mfma_f32_32x32x16_bf16 v[56:71], v[92:95], v[48:51], v[56:71]
  ds_read_b128 v[84:87], v102 offset:9728
  ds_read_b128 v[88:91], v102 offset:10336
  v_exp_f32 v46, v46
  v_exp_f32 v47, v47
  v_cvt_pk_bf16_f32 v52, v40, v41
  v_cvt_pk_bf16_f32 v53, v42, v43
  v_cvt_pk_bf16_f32 v54, v44, v45
  v_cvt_pk_bf16_f32 v55, v46, v47
  s_cmp_eq_u32 s21, 2
  s_cbranch_scc1 M_WOT
M_WOT_B:
  s_cmp_eq_u32 s21, 1
  s_cbranch_scc1 K2_FILL
K2_FILL_B:
  v_exp_f32 v16, v16
  v_exp_f32 v17, v17
  v_exp_f32 v18, v18
  v_exp_f32 v19, v19
  s_waitcnt lgkmcnt(2)
  v_mfma_f32_32x32x8_bf16 v[32:47], v[82:83], v[12:13], 0
  v_exp_f32 v20, v20
  v_exp_f32 v21, v21
  v_cvt_pk_bf16_f32 v48, v16, v17
  v_exp_f32 v22, v22
  v_cvt_pk_bf16_f32 v49, v18, v19
  v_mfma_f32_32x32x16_bf16 v[56:71], v[96:99], v[52:55], v[56:71]
  v_exp_f32 v23, v23
  v_exp_f32 v24, v24
  v_cvt_pk_bf16_f32 v50, v20, v21
  v_exp_f32 v25, v25
  v_cvt_pk_bf16_f32 v51, v22, v23
  v_mfma_f32_32x32x16_bf16 v[32:47], v[76:79], v[8:11], v[32:47]
  ds_read_b128 v[72:75], v100 offset:11520
  ds_read_b32 v80, v101 offset:11520
  v_exp_f32 v26, v26
  v_exp_f32 v27, v27
  v_exp_f32 v28, v28
  v_exp_f32 v29, v29
  s_waitcnt lgkmcnt(3)
  v_mfma_f32_32x32x16_bf16 v[56:71], v[84:87], v[48:51], v[56:71]
  ds_read_b128 v[92:95], v102 offset:10944
  ds_read_b128 v[96:99], v102 offset:11552
  v_exp_f32 v30, v30
  v_exp_f32 v31, v31
  v_cvt_pk_bf16_f32 v52, v24, v25
  v_cvt_pk_bf16_f32 v53, v26, v27
  v_cvt_pk_bf16_f32 v54, v28, v29
  v_cvt_pk_bf16_f32 v55, v30, v31
  v_exp_f32 v32, v32
  v_exp_f32 v33, v33
  v_exp_f32 v34, v34
  v_exp_f32 v35, v35
  s_waitcnt lgkmcnt(2)
  v_mfma_f32_32x32x8_bf16 v[16:31], v[80:81], v[12:13], 0
  v_exp_f32 v36, v36
  v_exp_f32 v37, v37
  v_cvt_pk_bf16_f32 v48, v32, v33
  v_exp_f32 v38, v38
  v_cvt_pk_bf16_f32 v49, v34, v35
  v_mfma_f32_32x32x16_bf16 v[56:71], v[88:91], v[52:55], v[56:71]
  v_exp_f32 v39, v39
  v_exp_f32 v40, v40
  v_cvt_pk_bf16_f32 v50, v36, v37
  v_exp_f32 v41, v41
  v_cvt_pk_bf16_f32 v51, v38, v39
  v_mfma_f32_32x32x16_bf16 v[16:31], v[72:75], v[8:11], v[16:31]
  ds_read_b128 v[76:79], v100 offset:12672
  ds_read_b32 v82, v101 offset:12672
  v_exp_f32 v42, v42
  v_exp_f32 v43, v43
  v_exp_f32 v44, v44
  v_exp_f32 v45, v45
  s_waitcnt lgkmcnt(3)
  v_mfma_f32_32x32x16_bf16 v[56:71], v[92:95], v[48:51], v[56:71]
  ds_read_b128 v[84:87], v102 offset:12160
  ds_read_b128 v[88:91], v102 offset:12768
  v_exp_f32 v46, v46
  v_exp_f32 v47, v47
  v_cvt_pk_bf16_f32 v52, v40, v41
  v_cvt_pk_bf16_f32 v53, v42, v43
  v_cvt_pk_bf16_f32 v54, v44, v45
  v_cvt_pk_bf16_f32 v55, v46, v47
  v_exp_f32 v16, v16
  v_exp_f32 v17, v17
  v_exp_f32 v18, v18
  v_exp_f32 v19, v19
  s_waitcnt lgkmcnt(2)
  v_mfma_f32_32x32x8_bf16 v[32:47], v[82:83], v[12:13], 0
  v_exp_f32 v20, v20
  v_exp_f32 v21, v21
  v_cvt_pk_bf16_f32 v48, v16, v17
  v_exp_f32 v22, v22
  v_cvt_pk_bf16_f32 v49, v18, v19
  v_mfma_f32_32x32x16_bf16 v[56:71], v[96:99], v[52:55], v[56:71]
  v_exp_f32 v23, v23
  v_exp_f32 v24, v24
  v_cvt_pk_bf16_f32 v50, v20, v21
  v_exp_f32 v25, v25
  v_cvt_pk_bf16_f32 v51, v22, v23
  v_mfma_f32_32x32x16_bf16 v[32:47], v[76:79], v[8:11], v[32:47]
  ds_read_b128 v[72:75], v100 offset:13824
  ds_read_b32 v80, v101 offset:13824
  v_exp_f32 v26, v26
  v_exp_f32 v27, v27
  v_exp_f32 v28, v28
  v_exp_f32 v29, v29
  s_waitcnt lgkmcnt(3)
  v_mfma_f32_32x32x16_bf16 v[56:71], v[84:87], v[48:51], v[56:71]
  ds_read_b128 v[92:95], v102 offset:13376
  ds_read_b128 v[96:99], v102 offset:13984
  v_exp_f32 v30, v30
  v_exp_f32 v31, v31
  v_cvt_pk_bf16_f32 v52, v24, v25
  v_cvt_pk_bf16_f32 v53, v26, v27
  v_cvt_pk_bf16_f32 v54, v28, v29
  v_cvt_pk_bf16_f32 v55, v30, v31
  v_exp_f32 v32, v32
  v_exp_f32 v33, v33
  v_exp_f32 v34, v34
  v_exp_f32 v35, v35
  s_waitcnt lgkmcnt(2)
  v_mfma_f32_32x32x8_bf16 v[16:31], v[80:81], v[12:13], 0
  v_exp_f32 v36, v36
  v_exp_f32 v37, v37
  v_cvt_pk_bf16_f32 v48, v32, v33
  v_exp_f32 v38, v38
  v_cvt_pk_bf16_f32 v49, v34, v35
  v_mfma_f32_32x32x16_bf16 v[56:71], v[88:91], v[52:55], v[56:71]
  v_exp_f32 v39, v39
  v_exp_f32 v40, v40
  v_cvt_pk_bf16_f32 v50, v36, v37
  v_exp_f32 v41, v41
  v_cvt_pk_bf16_f32 v51, v38, v39
  v_mfma_f32_32x32x16_bf16 v[16:31], v[72:75], v[8:11], v[16:31]
  ds_read_b128 v[76:79], v100 offset:14976
  ds_read_b32 v82, v101 offset:14976
  v_exp_f32 v42, v42
  v_exp_f32 v43, v43
  v_exp_f32 v44, v44
  v_exp_f32 v45, v45
  s_waitcnt lgkmcnt(3)
  v_mfma_f32_32x32x16_bf16 v[56:71], v[92:95], v[48:51], v[56:71]
  ds_read_b128 v[84:87], v102 offset:14592
  ds_read_b128 v[88:91], v102 offset:15200
  v_exp_f32 v46, v46
  v_exp_f32 v47, v47
  v_cvt_pk_bf16_f32 v52, v40, v41
  v_cvt_pk_bf16_f32 v53, v42, v43
  v_cvt_pk_bf16_f32 v54, v44, v45
  v_cvt_pk_bf16_f32 v55, v46, v47
  v_exp_f32 v16, v16
  v_exp_f32 v17, v17
  v_exp_f32 v18, v18
  v_exp_f32 v19, v19
  s_waitcnt lgkmcnt(2)
  v_mfma_f32_32x32x8_bf16 v[32:47], v[82:83], v[12:13], 0
  v_exp_f32 v20, v20
  v_exp_f32 v21, v21
  v_cvt_pk_bf16_f32 v48, v16, v17
  v_exp_f32 v22, v22
  v_cvt_pk_bf16_f32 v49, v18, v19
  v_mfma_f32_32x32x16_bf16 v[56:71], v[96:99], v[52:55], v[56:71]
  v_exp_f32 v23, v23
  v_exp_f32 v24, v24
  v_cvt_pk_bf16_f32 v50, v20, v21
  v_exp_f32 v25, v25
  v_cvt_pk_bf16_f32 v51, v22, v23
  v_mfma_f32_32x32x16_bf16 v[32:47], v[76:79], v[8:11], v[32:47]
  ds_read_b128 v[72:75], v100 offset:16128
  ds_read_b32 v80, v101 offset:16128
  v_exp_f32 v26, v26
  v_exp_f32 v27, v27
  v_exp_f32 v28, v28
  v_exp_f32 v29, v29
  s_waitcnt lgkmcnt(3)
  v_mfma_f32_32x32x16_bf16 v[56:71], v[84:87], v[48:51], v[56:71]
  ds_read_b128 v[92:95], v102 offset:15808
  ds_read_b128 v[96:99], v102 offset:16416
  v_exp_f32 v30, v30
  v_exp_f32 v31, v31
  v_cvt_pk_bf16_f32 v52, v24, v25
  v_cvt_pk_bf16_f32 v53, v26, v27
  v_cvt_pk_bf16_f32 v54, v28, v29
  v_cvt_pk_bf16_f32 v55, v30, v31
  v_exp_f32 v32, v32
  v_exp_f32 v33, v33
  v_exp_f32 v34, v34
  v_exp_f32 v35, v35
  s_waitcnt lgkmcnt(2)
  v_mfma_f32_32x32x8_bf16 v[16:31], v[80:81], v[12:13], 0
  v_exp_f32 v36, v36
  v_exp_f32 v37, v37
  v_cvt_pk_bf16_f32 v48, v32, v33
  v_exp_f32 v38, v38
  v_cvt_pk_bf16_f32 v49, v34, v35
  v_mfma_f32_32x32x16_bf16 v[56:71], v[88:91], v[52:55], v[56:71]
  v_exp_f32 v39, v39
  v_exp_f32 v40, v40
  v_cvt_pk_bf16_f32 v50, v36, v37
  v_exp_f32 v41, v41
  v_cvt_pk_bf16_f32 v51, v38, v39
  v_mfma_f32_32x32x16_bf16 v[16:31], v[72:75], v[8:11], v[16:31]
  ds_read_b128 v[76:79], v100 offset:17280
  ds_read_b32 v82, v101 offset:17280
  v_exp_f32 v42, v42
  v_exp_f32 v43, v43
  v_exp_f32 v44, v44
  v_exp_f32 v45, v45
  s_waitcnt lgkmcnt(3)
  v_mfma_f32_32x32x16_bf16 v[56:71], v[92:95], v[48:51], v[56:71]
  ds_read_b128 v[84:87], v102 offset:17024
  ds_read_b128 v[88:91], v102 offset:17632
  v_exp_f32 v46, v46
  v_exp_f32 v47, v47
  v_cvt_pk_bf16_f32 v52, v40, v41
  v_cvt_pk_bf16_f32 v53, v42, v43
  v_cvt_pk_bf16_f32 v54, v44, v45
  v_cvt_pk_bf16_f32 v55, v46, v47
  s_cmp_lg_u32 s21, 0
  s_cbranch_scc1 K2_NOBAR
  s_barrier
K2_NOBAR:
  v_add_u32 v100, s22, v100
  v_add_u32 v101, s22, v101
  s_waitcnt vmcnt(1)
  ds_read_b64_tr_b16 v[124:125], v120
  ds_read_b64_tr_b16 v[126:127], v120 offset:512
  v_exp_f32 v16, v16
  v_exp_f32 v17, v17
  v_exp_f32 v18, v18
  v_exp_f32 v19, v19
  s_waitcnt lgkmcnt(4)
  v_mfma_f32_32x32x8_bf16 v[32:47], v[82:83], v[12:13], 0
  v_exp_f32 v20, v20
  v_exp_f32 v21, v21
  v_cvt_pk_bf16_f32 v48, v16, v17
  v_exp_f32 v22, v22
  v_cvt_pk_bf16_f32 v49, v18, v19
  v_mfma_f32_32x32x16_bf16 v[56:71], v[96:99], v[52:55], v[56:71]
  v_exp_f32 v23, v23
  v_exp_f32 v24, v24
  v_cvt_pk_bf16_f32 v50, v20, v21
  v_exp_f32 v25, v25
  v_cvt_pk_bf16_f32 v51, v22, v23
  v_mfma_f32_32x32x16_bf16 v[32:47], v[76:79], v[8:11], v[32:47]
  ds_read_b128 v[72:75], v100 offset:0
  ds_read_b32 v80, v101 offset:0
  v_exp_f32 v26, v26
  v_exp_f32 v27, v27
  v_exp_f32 v28, v28
  v_exp_f32 v29, v29
  s_waitcnt lgkmcnt(5)
  v_mfma_f32_32x32x16_bf16 v[56:71], v[84:87], v[48:51], v[56:71]
  ds_read_b128 v[92:95], v102 offset:18240
  ds_read_b128 v[96:99], v102 offset:18848
  v_exp_f32 v30, v30
  v_exp_f32 v31, v31
  v_cvt_pk_bf16_f32 v52, v24, v25
  v_cvt_pk_bf16_f32 v53, v26, v27
  v_cvt_pk_bf16_f32 v54, v28, v29
  v_cvt_pk_bf16_f32 v55, v30, v31
  v_add_u32 v102, s22, v102
  s_waitcnt lgkmcnt(5)
  v_dot2_f32_bf16 v121, v124, v122, v121
  v_dot2_f32_bf16 v121, v125, v122, v121
  s_waitcnt lgkmcnt(4)
  v_dot2_f32_bf16 v121, v126, v122, v121
  v_dot2_f32_bf16 v121, v127, v122, v121
  s_cmp_eq_u32 s21, 3
  s_cselect_b32 s58, 0, s58
  s_mov_b32 m0, s52
  s_cmp_eq_u32 s21, 99
  buffer_load_dwordx4 v118, s[56:59], s8 offen nt lds
  s_cselect_b32 s51, s11, s10
  s_add_u32 s8, s8, s51
  buffer_store_dwordx4 v[124:127], v119, s[60:63], s9 offen sc1
  s_bitcmp1_b32 s21, 0
  s_cselect_b32 s53, s14, 256
  s_add_u32 s9, s9, s53
  v_exp_f32 v32, v32
  v_exp_f32 v33, v33
  v_exp_f32 v34, v34
  v_exp_f32 v35, v35
  s_waitcnt lgkmcnt(2)
  v_mfma_f32_32x32x8_bf16 v[16:31], v[80:81], v[12:13], 0
  v_exp_f32 v36, v36
  v_exp_f32 v37, v37
  v_cvt_pk_bf16_f32 v48, v32, v33
  v_exp_f32 v38, v38
  v_cvt_pk_bf16_f32 v49, v34, v35
  v_mfma_f32_32x32x16_bf16 v[56:71], v[88:91], v[52:55], v[56:71]
  v_exp_f32 v39, v39
  v_exp_f32 v40, v40
  v_cvt_pk_bf16_f32 v50, v36, v37
  v_exp_f32 v41, v41
  v_cvt_pk_bf16_f32 v51, v38, v39
  v_mfma_f32_32x32x16_bf16 v[16:31], v[72:75], v[8:11], v[16:31]
  ds_read_b128 v[76:79], v100 offset:1152
  ds_read_b32 v82, v101 offset:1152
  v_exp_f32 v42, v42
  v_exp_f32 v43, v43
  v_exp_f32 v44, v44
  v_exp_f32 v45, v45
  s_waitcnt lgkmcnt(3)
  v_mfma_f32_32x32x16_bf16 v[56:71], v[92:95], v[48:51], v[56:71]
  ds_read_b128 v[84:87], v102 offset:0
  ds_read_b128 v[88:91], v102 offset:608
  v_exp_f32 v46, v46
  v_exp_f32 v47, v47
  v_cvt_pk_bf16_f32 v52, v40, v41
  v_cvt_pk_bf16_f32 v53, v42, v43
  v_cvt_pk_bf16_f32 v54, v44, v45
  v_cvt_pk_bf16_f32 v55, v46, v47
  s_add_u32 s21, s21, 1
  s_cmp_lt_u32 s21, 4
  s_cbranch_scc1 K2_LOOP
  s_waitcnt lgkmcnt(4)
  v_mfma_f32_32x32x16_bf16 v[56:71], v[96:99], v[52:55], v[56:71]
  v_lshlrev_b32 v104, 2, v1
  buffer_store_dword v121, v104, s[4:7], s15 offen sc1
  s_waitcnt vmcnt(2)
  s_nop 8
  v_mov_b32 v104, v66
  v_mov_b32 v105, v66
  s_nop 1
  v_permlane32_swap_b32 v104, v105
  v_max3_f32 v106, |v56|, |v57|, |v58|
  v_max3_f32 v106, |v59|, |v60|, v106
  v_max3_f32 v106, |v61|, |v62|, v106
  v_max3_f32 v106, |v63|, |v64|, v106
  v_max_f32 v106, |v65|, v106
  v_cmp_lt_f32 vcc, 0x21800000, v104
  s_mov_b32 s38, 0x5d800000
  s_mov_b32 s39, 0x7b800000
  v_cmp_gt_f32 s[36:37], s38, v104
  v_cmp_gt_f32 s[40:41], s39, v106
  s_and_b64 s[36:37], s[36:37], vcc
  s_and_b64 s[36:37], s[36:37], s[40:41]
  s_cmp_eq_u64 s[36:37], -1
  s_cbranch_scc0 K2_SLOW
K2_FIN:
  v_rcp_f32 v104, v104
  s_nop 0
  v_mul_f32 v56, v56, v104
  v_mul_f32 v57, v57, v104
  v_mul_f32 v58, v58, v104
  v_mul_f32 v59, v59, v104
  v_mul_f32 v60, v60, v104
  v_mul_f32 v61, v61, v104
  v_mul_f32 v62, v62, v104
  v_mul_f32 v63, v63, v104
  v_mul_f32 v64, v64, v104
  v_mul_f32 v65, v65, v104
  v_cvt_pk_bf16_f32 v48, v56, v57
  v_cvt_pk_bf16_f32 v49, v58, v59
  v_cvt_pk_bf16_f32 v50, v60, v61
  v_cvt_pk_bf16_f32 v51, v62, v63
  v_cvt_pk_bf16_f32 v52, v64, v65
  s_lshr_b32 s22, s16, 1
  s_mul_i32 s22, s22, 40960
  s_and_b32 s23, s16, 1
  s_mul_i32 s23, s23, 1168
  s_add_u32 s22, s22, s23
  s_add_u32 s22, s22, 37888
  v_mul_u32_u24 v105, 36, v3
  v_add_u32 v105, s22, v105
  v_lshl_add_u32 v106, v2, 3, v105
  ds_write2_b32 v106, v48, v49 offset0:0 offset1:1
  ds_write2_b32 v106, v50, v51 offset0:4 offset1:5
  s_mov_b32 exec_hi, 0
  ds_write_b32 v105, v52 offset:32
  s_mov_b32 exec_hi, -1
  s_waitcnt lgkmcnt(0)
  s_barrier
  s_mov_b32 s47, 37888
  s_lshr_b32 s48, s3, 1
  s_mul_i32 s48, s48, 18432
  s_and_b32 s49, s3, 1
  s_lshl_b32 s49, s49, 7
  s_add_u32 s48, s48, s49
  v_and_b32 v107, 7, v1
  v_bfe_u32 v108, v1, 3, 2
  v_lshrrev_b32 v109, 5, v1
  s_lshl_b32 s23, s16, 1
  v_add_u32 v109, s23, v109
  v_lshrrev_b32 v110, 1, v107
  v_mul_u32_u24 v110, 40960, v110
  v_and_b32 v111, 1, v107
  v_mul_u32_u24 v111, 1168, v111
  v_add3_u32 v110, v110, v111, s47
  v_lshl_add_u32 v110, v109, 6, v110
  v_lshl_add_u32 v110, v108, 4, v110
  ds_read_b128 v[48:51], v110
  v_lshlrev_b32 v111, 10, v109
  v_lshl_add_u32 v111, v108, 8, v111
  v_lshl_add_u32 v111, v107, 4, v111
  s_waitcnt lgkmcnt(0)
  buffer_store_dwordx4 v[48:51], v111, s[32:35], s48 offen sc1
  s_cmp_lg_u32 s16, 0
  s_cbranch_scc1 K2_DONE
  s_mov_b32 s50, 8
  v_and_b32 v107, 7, v1
  v_bfe_u32 v108, v1, 3, 2
  v_lshrrev_b32 v109, 5, v1
  s_lshl_b32 s23, s50, 1
  v_add_u32 v109, s23, v109
  v_lshrrev_b32 v110, 1, v107
  v_mul_u32_u24 v110, 40960, v110
  v_and_b32 v111, 1, v107
  v_mul_u32_u24 v111, 1168, v111
  v_add3_u32 v110, v110, v111, s47
  v_lshl_add_u32 v110, v109, 6, v110
  v_lshl_add_u32 v110, v108, 4, v110
  ds_read_b128 v[48:51], v110
  v_lshlrev_b32 v111, 10, v109
  v_lshl_add_u32 v111, v108, 8, v111
  v_lshl_add_u32 v111, v107, 4, v111
  s_waitcnt lgkmcnt(0)
  buffer_store_dwordx4 v[48:51], v111, s[32:35], s48 offen sc1
K2_DONE:
  s_branch M_AEND
K2_SLOW:
  v_lshlrev_b32 v100, 4, v1
  v_lshlrev_b32 v101, 2, v3
  v_add_u32 v101, 1024, v101
  v_mov_b32 v56, 0
  v_mov_b32 v57, 0
  v_mov_b32 v58, 0
  v_mov_b32 v59, 0
  v_mov_b32 v60, 0
  v_mov_b32 v61, 0
  v_mov_b32 v62, 0
  v_mov_b32 v63, 0
  v_mov_b32 v64, 0
  v_mov_b32 v65, 0
  v_mov_b32 v66, 0
  v_mov_b32 v67, 0
  v_mov_b32 v68, 0
  v_mov_b32 v69, 0
  v_mov_b32 v70, 0
  v_mov_b32 v71, 0
  v_mov_b32 v112, 0xff61b1e6
  s_mov_b32 s43, 23680
  s_mov_b32 s44, 1152
  s_mov_b32 s45, 22720
  s_mov_b32 s46, 1216
  s_mov_b32 s21, 0
K2_SLOOP:
  buffer_load_dwordx4 v[72:75], v100, s[28:31], 0 offen
  buffer_load_dword v80, v101, s[28:31], 0 offen
  buffer_load_dwordx4 v[84:87], v102, s[28:31], 0 offen
  buffer_load_dwordx4 v[88:91], v102, s[28:31], 0 offen offset:608
  s_waitcnt vmcnt(2)
  v_mfma_f32_32x32x8_bf16 v[16:31], v[80:81], v[12:13], 0
  v_mfma_f32_32x32x16_bf16 v[16:31], v[72:75], v[8:11], v[16:31]
  s_nop 11
  v_max3_f32 v113, v16, v17, v18
  v_max3_f32 v113, v19, v20, v113
  v_max3_f32 v113, v21, v22, v113
  v_max3_f32 v113, v23, v24, v113
  v_max3_f32 v113, v25, v26, v113
  v_max3_f32 v113, v27, v28, v113
  v_max3_f32 v113, v29, v30, v113
  v_max_f32 v113, v31, v113
  v_mov_b32 v114, v113
  s_nop 1
  v_permlane32_swap_b32 v113, v114
  v_max3_f32 v113, v113, v114, v112
  v_sub_f32 v114, v112, v113
  v_exp_f32 v114, v114
  v_mov_b32 v112, v113
  v_sub_f32 v16, v16, v112
  v_sub_f32 v17, v17, v112
  v_sub_f32 v18, v18, v112
  v_sub_f32 v19, v19, v112
  v_sub_f32 v20, v20, v112
  v_sub_f32 v21, v21, v112
  v_sub_f32 v22, v22, v112
  v_sub_f32 v23, v23, v112
  v_sub_f32 v24, v24, v112
  v_sub_f32 v25, v25, v112
  v_sub_f32 v26, v26, v112
  v_sub_f32 v27, v27, v112
  v_sub_f32 v28, v28, v112
  v_sub_f32 v29, v29, v112
  v_sub_f32 v30, v30, v112
  v_sub_f32 v31, v31, v112
  v_exp_f32 v16, v16
  v_exp_f32 v17, v17
  v_exp_f32 v18, v18
  v_exp_f32 v19, v19
  v_exp_f32 v20, v20
  v_exp_f32 v21, v21
  v_exp_f32 v22, v22
  v_exp_f32 v23, v23
  v_exp_f32 v24, v24
  v_exp_f32 v25, v25
  v_exp_f32 v26, v26
  v_exp_f32 v27, v27
  v_exp_f32 v28, v28
  v_exp_f32 v29, v29
  v_exp_f32 v30, v30
  v_exp_f32 v31, v31
  v_mul_f32 v56, v56, v114
  v_mul_f32 v57, v57, v114
  v_mul_f32 v58, v58, v114
  v_mul_f32 v59, v59, v114
  v_mul_f32 v60, v60, v114
  v_mul_f32 v61, v61, v114
  v_mul_f32 v62, v62, v114
  v_mul_f32 v63, v63, v114
  v_mul_f32 v64, v64, v114
  v_mul_f32 v65, v65, v114
  v_mul_f32 v66, v66, v114
  v_mul_f32 v67, v67, v114
  v_mul_f32 v68, v68, v114
  v_mul_f32 v69, v69, v114
  v_mul_f32 v70, v70, v114
  v_mul_f32 v71, v71, v114
  v_cvt_pk_bf16_f32 v48, v16, v17
  v_cvt_pk_bf16_f32 v49, v18, v19
  v_cvt_pk_bf16_f32 v50, v20, v21
  v_cvt_pk_bf16_f32 v51, v22, v23
  v_cvt_pk_bf16_f32 v52, v24, v25
  v_cvt_pk_bf16_f32 v53, v26, v27
  v_cvt_pk_bf16_f32 v54, v28, v29
  v_cvt_pk_bf16_f32 v55, v30, v31
  s_waitcnt vmcnt(1)
  v_mfma_f32_32x32x16_bf16 v[56:71], v[84:87], v[48:51], v[56:71]
  s_waitcnt vmcnt(0)
  v_mfma_f32_32x32x16_bf16 v[56:71], v[88:91], v[52:55], v[56:71]
  s_add_u32 s21, s21, 1
  s_and_b32 s22, s21, 15
  s_cmp_eq_u32 s22, 0
  s_cselect_b32 s22, s43, s44
  s_cselect_b32 s23, s45, s46
  v_add_u32 v100, s22, v100
  v_add_u32 v101, s22, v101
  v_add_u32 v102, s23, v102
  s_cmp_lt_u32 s21, 64
  s_cbranch_scc1 K2_SLOOP
  s_nop 1
  v_mov_b32 v104, v66
  v_mov_b32 v105, v66
  s_nop 1
  v_permlane32_swap_b32 v104, v105
  s_nop 1
  s_branch K2_FIN
K2_FILL:
  s_lshl_b32 s44, s17, 10
  v_lshlrev_b32 v136, 4, v1
  v_add_u32 v136, s44, v136
  v_mov_b32 v140, -1
  v_mov_b32 v141, -1
  v_mov_b32 v142, -1
  v_mov_b32 v143, -1
  s_add_u32 s44, s12, 0x4c0000
  s_addc_u32 s45, s13, 0
  s_mov_b32 s46, 0x240000
  s_mov_b32 s47, 0x00020000
  v_add_u32 v137, 0, v136
  buffer_store_dwordx4 v[140:143], v137, s[44:47], 0 offen sc1
  v_add_u32 v138, 2097152, v136
  buffer_store_dwordx4 v[140:143], v138, s[44:47], 0 offen sc1
  s_branch K2_FILL_B
M_WOT:
  s_add_u32 s44, s12, 0x4000000
  s_addc_u32 s45, s13, 0
  s_mov_b32 s46, 0x1200000
  s_mov_b32 s47, 0x00020000
  s_lshr_b32 s36, s2, 3
  s_lshl_b32 s36, s36, 3
  s_add_u32 s36, s36, s16
  s_mul_i32 s36, s36, 21
  v_min_u32 v136, 20, v1
  v_add_u32 v136, s36, v136
  v_min_u32 v136, 5183, v136
  v_lshlrev_b32 v136, 7, v136
  s_mov_b32 s36, 0x1040000
  buffer_load_dword v137, v136, s[44:47], s36 offen
  s_branch M_WOT_B
M_AEND:
  s_load_dwordx2 s[4:5], s[0:1], 72
  s_load_dwordx2 s[10:11], s[0:1], 0
  s_mov_b32 s17, s16
  s_and_b32 s16, s17, 3
  v_and_b32 v7, 63, v0
  v_lshlrev_b32 v1, 4, v7
  s_and_b32 s33, s2, 3
  s_lshl_b32 s33, s33, 2
  s_lshr_b32 s34, s2, 6
  s_add_u32 s15, s33, s34
  s_mul_i32 s14, s15, 663552
  s_mov_b32 s96, 200000
  s_mov_b32 s97, 0
  s_add_u32 s60, s12, 0x730000
  s_addc_u32 s61, s13, 0
  s_mov_b32 s62, 0x20400
  s_mov_b32 s63, 0x00020000
  s_add_u32 s24, s12, 0x4000000
  s_addc_u32 s25, s13, 0
  s_mov_b32 s26, 0x1200000
  s_mov_b32 s27, 0x00020000
  s_cmp_ge_u32 s2, 192
  s_cbranch_scc1 M_IDLE
  s_lshr_b32 s20, s17, 2
  s_and_b32 s21, s2, 7
  s_lshr_b32 s22, s2, 3
  s_and_b32 s22, s22, 3
  s_lshl_b32 s22, s22, 3
  s_add_u32 s19, s21, s22
  s_lshr_b32 s18, s2, 5
  s_mul_i32 s47, s18, 110592
  s_add_u32 s47, s47, 0x1040000
  s_cmp_ge_u32 s17, 6
  s_cbranch_scc1 M_WO0_Y
  s_lshr_b32 s48, s17, 1
  s_mul_i32 s48, s48, 40960
  s_and_b32 s49, s17, 1
  s_mul_i32 s49, s49, 18432
  s_add_u32 s48, s48, s49
  s_add_u32 s48, s48, 0
  s_mul_i32 s49, s17, 18432
  s_add_u32 s49, s49, s47
  s_add_u32 s49, s49, 0
  s_mov_b32 m0, s48
  s_nop 0
  buffer_load_dwordx4 v1, s[24:27], s49 offen offset:0 lds
  buffer_load_dwordx4 v1, s[24:27], s49 offen offset:1024 lds
  buffer_load_dwordx4 v1, s[24:27], s49 offen offset:2048 lds
  buffer_load_dwordx4 v1, s[24:27], s49 offen offset:3072 lds
  s_add_u32 s48, s48, 4096
  s_add_u32 s49, s49, 4096
  s_mov_b32 m0, s48
  s_nop 0
  buffer_load_dwordx4 v1, s[24:27], s49 offen offset:0 lds
  buffer_load_dwordx4 v1, s[24:27], s49 offen offset:1024 lds
  buffer_load_dwordx4 v1, s[24:27], s49 offen offset:2048 lds
  s_branch M_WO0_E
M_WO0_Y:
  s_sub_u32 s33, s17, 6
  s_mul_i32 s33, s33, 3
  s_add_u32 s33, s33, 0
  s_lshr_b32 s48, s33, 1
  s_mul_i32 s48, s48, 40960
  s_and_b32 s49, s33, 1
  s_mul_i32 s49, s49, 18432
  s_add_u32 s48, s48, s49
  s_add_u32 s48, s48, 14336
  s_mul_i32 s49, s33, 18432
  s_add_u32 s49, s49, s47
  s_add_u32 s49, s49, 14336
  s_mov_b32 m0, s48
  s_nop 0
  buffer_load_dwordx4 v1, s[24:27], s49 offen offset:0 lds
  buffer_load_dwordx4 v1, s[24:27], s49 offen offset:1024 lds
  buffer_load_dwordx4 v1, s[24:27], s49 offen offset:2048 lds
  buffer_load_dwordx4 v1, s[24:27], s49 offen offset:3072 lds
  s_sub_u32 s33, s17, 6
  s_mul_i32 s33, s33, 3
  s_add_u32 s33, s33, 1
  s_lshr_b32 s48, s33, 1
  s_mul_i32 s48, s48, 40960
  s_and_b32 s49, s33, 1
  s_mul_i32 s49, s49, 18432
  s_add_u32 s48, s48, s49
  s_add_u32 s48, s48, 14336
  s_mul_i32 s49, s33, 18432
  s_add_u32 s49, s49, s47
  s_add_u32 s49, s49, 14336
  s_mov_b32 m0, s48
  s_nop 0
  buffer_load_dwordx4 v1, s[24:27], s49 offen offset:0 lds
  buffer_load_dwordx4 v1, s[24:27], s49 offen offset:1024 lds
  buffer_load_dwordx4 v1, s[24:27], s49 offen offset:2048 lds
M_WO0_E:
  v_and_b32 v162, 15, v7
  v_lshrrev_b32 v161, 4, v7
  s_lshl_b32 s23, s19, 2
  s_add_u32 s23, s23, s16
  s_lshl_b32 s33, s23, 4
  v_add_u32 v163, s33, v162
  s_mul_i32 s44, s23, 18432
  s_mul_i32 s33, s20, 9216
  s_add_u32 s44, s44, s33
  s_mul_i32 s33, s18, 192
  s_mul_i32 s35, s20, 96
  s_add_u32 s50, s33, s35
  v_mul_u32_u24 v168, 1152, v163
  v_lshl_add_u32 v169, v161, 3, v168
  s_mul_i32 s33, s20, 9216
  v_add_u32 v164, s33, v1
  v_add_u32 v165, 40960, v164
  v_add_u32 v179, 81920, v164
  s_mul_i32 s33, s16, 6144
  s_add_u32 s33, s33, 122880
  v_add_u32 v166, s33, v1
  v_mov_b32 v178, 0x3f803f80
  s_mul_i32 s51, s23, 18432
  s_mul_i32 s33, s18, 6
  s_mul_i32 s35, s20, 3
  s_add_u32 s33, s33, s35
  s_lshl_b32 s33, s33, 9
  s_add_u32 s51, s51, s33
  v_lshrrev_b32 v170, 1, v161
  v_lshlrev_b32 v170, 8, v170
  v_lshl_add_u32 v171, v162, 4, v170
  v_and_b32 v170, 1, v161
  v_lshl_add_u32 v167, v170, 9, v171
  v_lshrrev_b32 v172, 5, v7
  v_lshlrev_b32 v172, 7, v172
  s_lshl_b32 s45, s23, 8
  s_add_u32 s45, s45, 65536
  s_add_u32 s40, s12, 0x280000
  s_addc_u32 s41, s13, 0
  s_mov_b32 s42, 0x240000
  s_mov_b32 s43, 0x00020000
  s_add_u32 s36, s12, 0x4c0000
  s_addc_u32 s37, s13, 0
  s_mov_b32 s38, 0x340000
  s_mov_b32 s39, 0x00020000
  s_waitcnt lgkmcnt(0)
  s_mov_b32 s52, s10
  s_mov_b32 s53, s11
  s_mov_b32 s54, 0x240000
  s_mov_b32 s55, 0x00020000
  s_waitcnt vmcnt(7)
  s_barrier
  s_cmp_lg_u32 s17, 0
  s_cbranch_scc1 M_PUBA1
  s_lshl_b32 s33, s3, 7
  s_add_u32 s33, s33, 65536
  v_lshlrev_b32 v20, 2, v7
  v_mov_b32 v21, 1
  s_mov_b32 exec_hi, 0
  buffer_store_dword v21, v20, s[60:63], s33 offen sc1
  s_mov_b32 exec_hi, -1
M_PUBA1:
  s_mul_i32 s47, s18, 110592
  s_add_u32 s47, s47, 0x1040000
  s_cmp_ge_u32 s17, 6
  s_cbranch_scc1 M_WO1_Y
  s_lshr_b32 s48, s17, 1
  s_mul_i32 s48, s48, 40960
  s_and_b32 s49, s17, 1
  s_mul_i32 s49, s49, 18432
  s_add_u32 s48, s48, s49
  s_add_u32 s48, s48, 7168
  s_mul_i32 s49, s17, 18432
  s_add_u32 s49, s49, s47
  s_add_u32 s49, s49, 7168
  s_mov_b32 m0, s48
  s_nop 0
  buffer_load_dwordx4 v1, s[24:27], s49 offen offset:0 lds
  buffer_load_dwordx4 v1, s[24:27], s49 offen offset:1024 lds
  buffer_load_dwordx4 v1, s[24:27], s49 offen offset:2048 lds
  buffer_load_dwordx4 v1, s[24:27], s49 offen offset:3072 lds
  s_add_u32 s48, s48, 4096
  s_add_u32 s49, s49, 4096
  s_mov_b32 m0, s48
  s_nop 0
  buffer_load_dwordx4 v1, s[24:27], s49 offen offset:0 lds
  buffer_load_dwordx4 v1, s[24:27], s49 offen offset:1024 lds
  buffer_load_dwordx4 v1, s[24:27], s49 offen offset:2048 lds
  s_branch M_WO1_E
M_WO1_Y:
  s_sub_u32 s33, s17, 6
  s_mul_i32 s33, s33, 3
  s_add_u32 s33, s33, 1
  s_lshr_b32 s48, s33, 1
  s_mul_i32 s48, s48, 40960
  s_and_b32 s49, s33, 1
  s_mul_i32 s49, s49, 18432
  s_add_u32 s48, s48, s49
  s_add_u32 s48, s48, 17408
  s_mul_i32 s49, s33, 18432
  s_add_u32 s49, s49, s47
  s_add_u32 s49, s49, 17408
  s_mov_b32 m0, s48
  s_nop 0
  buffer_load_dwordx4 v1, s[24:27], s49 offen offset:0 lds
  s_sub_u32 s33, s17, 6
  s_mul_i32 s33, s33, 3
  s_add_u32 s33, s33, 2
  s_lshr_b32 s48, s33, 1
  s_mul_i32 s48, s48, 40960
  s_and_b32 s49, s33, 1
  s_mul_i32 s49, s49, 18432
  s_add_u32 s48, s48, s49
  s_add_u32 s48, s48, 14336
  s_mul_i32 s49, s33, 18432
  s_add_u32 s49, s49, s47
  s_add_u32 s49, s49, 14336
  s_mov_b32 m0, s48
  s_nop 0
  buffer_load_dwordx4 v1, s[24:27], s49 offen offset:0 lds
  buffer_load_dwordx4 v1, s[24:27], s49 offen offset:1024 lds
  buffer_load_dwordx4 v1, s[24:27], s49 offen offset:2048 lds
  buffer_load_dwordx4 v1, s[24:27], s49 offen offset:3072 lds
  s_mov_b32 m0, s48
  s_nop 0
  buffer_load_dwordx4 v1, s[24:27], s49 offen offset:0 lds
  buffer_load_dwordx4 v1, s[24:27], s49 offen offset:1024 lds
M_WO1_E:
  buffer_load_dwordx2 v[128:129], v169, s[52:55], s50 offen offset:0
  buffer_load_dwordx2 v[130:131], v169, s[52:55], s50 offen offset:32
  buffer_load_dwordx2 v[132:133], v169, s[52:55], s50 offen offset:64
  s_mov_b32 s8, s96
M_OPROBE:
  buffer_load_dword v173, v172, s[60:63], s45 offen sc0 sc1
  s_waitcnt vmcnt(0)
  v_cmp_eq_u32 s[6:7], 0, v173
  s_cmp_eq_u64 s[6:7], 0
  s_cbranch_scc1 M_OPROBE_OK
  s_sub_u32 s8, s8, 1
  s_cmp_lg_u32 s8, 0
  s_cbranch_scc1 M_OPROBE
  s_cmp_lg_u32 s97, 0
  s_cbranch_scc1 M_FL0
  s_mov_b32 s97, 1
  s_mov_b32 s96, 1
  s_mov_b64 exec, 1
  v_mov_b32 v254, 1
  s_mov_b32 s6, 98432
  buffer_atomic_add v254, off, s[60:63], s6 sc0 sc1
  s_waitcnt vmcnt(0)
  v_readfirstlane_b32 s6, v254
  s_cmp_eq_u32 s6, 0
  s_cselect_b32 s6, 1, 0
  v_mov_b32 v254, 163832
  v_mov_b32 v255, 1
  ds_write_b32 v254, v255
  v_mov_b32 v255, s6
  ds_or_b32 v254, v255 offset:4
  s_waitcnt lgkmcnt(0)
  s_mov_b64 exec, -1
M_FL0:
M_OPROBE_OK:
  s_barrier
  buffer_load_dwordx4 v[32:35], v1, s[40:43], s44 offen offset:0
  buffer_load_dwordx4 v[36:39], v1, s[40:43], s44 offen offset:1024
  buffer_load_dwordx4 v[40:43], v1, s[40:43], s44 offen offset:2048
  buffer_load_dwordx4 v[44:47], v1, s[40:43], s44 offen offset:3072
  s_add_u32 s44, s44, 4096
  buffer_load_dwordx4 v[48:51], v1, s[40:43], s44 offen offset:0
  buffer_load_dwordx4 v[52:55], v1, s[40:43], s44 offen offset:1024
  buffer_load_dwordx4 v[56:59], v1, s[40:43], s44 offen offset:2048
  buffer_load_dwordx4 v[60:63], v1, s[40:43], s44 offen offset:3072
  s_add_u32 s44, s44, 4096
  buffer_load_dwordx4 v[64:67], v1, s[40:43], s44 offen offset:0
  s_mov_b32 s33, 98304
  buffer_load_dword v173, off, s[60:63], s33 sc0 sc1
  ds_read_b128 v[72:75], v164 offset:0
  ds_read_b128 v[76:79], v164 offset:18432
  ds_read_b128 v[80:83], v165 offset:0
  ds_read_b128 v[84:87], v165 offset:18432
  ds_read_b128 v[88:91], v179 offset:0
  ds_read_b128 v[92:95], v179 offset:18432
  ds_read_b128 v[96:99], v164 offset:1024
  s_waitcnt vmcnt(9) lgkmcnt(6)
  v_mfma_f32_16x16x32_bf16 v[104:107], v[72:75], v[32:35], 0
  ds_read_b128 v[100:103], v164 offset:19456
  s_waitcnt lgkmcnt(6)
  v_mfma_f32_16x16x32_bf16 v[108:111], v[76:79], v[32:35], 0
  ds_read_b128 v[72:75], v165 offset:1024
  s_waitcnt lgkmcnt(6)
  v_mfma_f32_16x16x32_bf16 v[112:115], v[80:83], v[32:35], 0
  ds_read_b128 v[76:79], v165 offset:19456
  s_waitcnt lgkmcnt(6)
  v_mfma_f32_16x16x32_bf16 v[116:119], v[84:87], v[32:35], 0
  ds_read_b128 v[80:83], v179 offset:1024
  s_waitcnt lgkmcnt(6)
  v_mfma_f32_16x16x32_bf16 v[120:123], v[88:91], v[32:35], 0
  ds_read_b128 v[84:87], v179 offset:19456
  s_waitcnt lgkmcnt(6)
  v_mfma_f32_16x16x32_bf16 v[124:127], v[92:95], v[32:35], 0
  ds_read_b128 v[88:91], v164 offset:2048
  s_waitcnt vmcnt(8) lgkmcnt(6)
  v_mfma_f32_16x16x32_bf16 v[104:107], v[96:99], v[36:39], v[104:107]
  ds_read_b128 v[92:95], v164 offset:20480
  s_waitcnt lgkmcnt(6)
  v_mfma_f32_16x16x32_bf16 v[108:111], v[100:103], v[36:39], v[108:111]
  ds_read_b128 v[96:99], v165 offset:2048
  s_waitcnt lgkmcnt(6)
  v_mfma_f32_16x16x32_bf16 v[112:115], v[72:75], v[36:39], v[112:115]
  ds_read_b128 v[100:103], v165 offset:20480
  s_waitcnt lgkmcnt(6)
  v_mfma_f32_16x16x32_bf16 v[116:119], v[76:79], v[36:39], v[116:119]
  ds_read_b128 v[72:75], v179 offset:2048
  s_waitcnt lgkmcnt(6)
  v_mfma_f32_16x16x32_bf16 v[120:123], v[80:83], v[36:39], v[120:123]
  ds_read_b128 v[76:79], v179 offset:20480
  s_waitcnt lgkmcnt(6)
  v_mfma_f32_16x16x32_bf16 v[124:127], v[84:87], v[36:39], v[124:127]
  ds_read_b128 v[80:83], v164 offset:3072
  s_waitcnt vmcnt(7) lgkmcnt(6)
  v_mfma_f32_16x16x32_bf16 v[104:107], v[88:91], v[40:43], v[104:107]
  ds_read_b128 v[84:87], v164 offset:21504
  s_waitcnt lgkmcnt(6)
  v_mfma_f32_16x16x32_bf16 v[108:111], v[92:95], v[40:43], v[108:111]
  ds_read_b128 v[88:91], v165 offset:3072
  s_waitcnt lgkmcnt(6)
  v_mfma_f32_16x16x32_bf16 v[112:115], v[96:99], v[40:43], v[112:115]
  ds_read_b128 v[92:95], v165 offset:21504
  s_waitcnt lgkmcnt(6)
  v_mfma_f32_16x16x32_bf16 v[116:119], v[100:103], v[40:43], v[116:119]
  ds_read_b128 v[96:99], v179 offset:3072
  s_waitcnt lgkmcnt(6)
  v_mfma_f32_16x16x32_bf16 v[120:123], v[72:75], v[40:43], v[120:123]
  ds_read_b128 v[100:103], v179 offset:21504
  s_waitcnt lgkmcnt(6)
  v_mfma_f32_16x16x32_bf16 v[124:127], v[76:79], v[40:43], v[124:127]
  ds_read_b128 v[72:75], v164 offset:4096
  s_waitcnt vmcnt(6) lgkmcnt(6)
  v_mfma_f32_16x16x32_bf16 v[104:107], v[80:83], v[44:47], v[104:107]
  ds_read_b128 v[76:79], v164 offset:22528
  s_waitcnt lgkmcnt(6)
  v_mfma_f32_16x16x32_bf16 v[108:111], v[84:87], v[44:47], v[108:111]
  ds_read_b128 v[80:83], v165 offset:4096
  s_waitcnt lgkmcnt(6)
  v_mfma_f32_16x16x32_bf16 v[112:115], v[88:91], v[44:47], v[112:115]
  ds_read_b128 v[84:87], v165 offset:22528
  s_waitcnt lgkmcnt(6)
  v_mfma_f32_16x16x32_bf16 v[116:119], v[92:95], v[44:47], v[116:119]
  ds_read_b128 v[88:91], v179 offset:4096
  s_waitcnt lgkmcnt(6)
  v_mfma_f32_16x16x32_bf16 v[120:123], v[96:99], v[44:47], v[120:123]
  ds_read_b128 v[92:95], v179 offset:22528
  s_waitcnt lgkmcnt(6)
  v_mfma_f32_16x16x32_bf16 v[124:127], v[100:103], v[44:47], v[124:127]
  ds_read_b128 v[96:99], v164 offset:5120
  s_waitcnt vmcnt(5) lgkmcnt(6)
  v_mfma_f32_16x16x32_bf16 v[104:107], v[72:75], v[48:51], v[104:107]
  ds_read_b128 v[100:103], v164 offset:23552
  s_waitcnt lgkmcnt(6)
  v_mfma_f32_16x16x32_bf16 v[108:111], v[76:79], v[48:51], v[108:111]
  ds_read_b128 v[72:75], v165 offset:5120
  s_waitcnt lgkmcnt(6)
  v_mfma_f32_16x16x32_bf16 v[112:115], v[80:83], v[48:51], v[112:115]
  ds_read_b128 v[76:79], v165 offset:23552
  s_waitcnt lgkmcnt(6)
  v_mfma_f32_16x16x32_bf16 v[116:119], v[84:87], v[48:51], v[116:119]
  ds_read_b128 v[80:83], v179 offset:5120
  s_waitcnt lgkmcnt(6)
  v_mfma_f32_16x16x32_bf16 v[120:123], v[88:91], v[48:51], v[120:123]
  ds_read_b128 v[84:87], v179 offset:23552
  s_waitcnt lgkmcnt(6)
  v_mfma_f32_16x16x32_bf16 v[124:127], v[92:95], v[48:51], v[124:127]
  ds_read_b128 v[88:91], v164 offset:6144
  s_waitcnt vmcnt(4) lgkmcnt(6)
  v_mfma_f32_16x16x32_bf16 v[104:107], v[96:99], v[52:55], v[104:107]
  ds_read_b128 v[92:95], v164 offset:24576
  s_waitcnt lgkmcnt(6)
  v_mfma_f32_16x16x32_bf16 v[108:111], v[100:103], v[52:55], v[108:111]
  ds_read_b128 v[96:99], v165 offset:6144
  s_waitcnt lgkmcnt(6)
  v_mfma_f32_16x16x32_bf16 v[112:115], v[72:75], v[52:55], v[112:115]
  ds_read_b128 v[100:103], v165 offset:24576
  s_waitcnt lgkmcnt(6)
  v_mfma_f32_16x16x32_bf16 v[116:119], v[76:79], v[52:55], v[116:119]
  ds_read_b128 v[72:75], v179 offset:6144
  s_waitcnt lgkmcnt(6)
  v_mfma_f32_16x16x32_bf16 v[120:123], v[80:83], v[52:55], v[120:123]
  ds_read_b128 v[76:79], v179 offset:24576
  s_waitcnt lgkmcnt(6)
  v_mfma_f32_16x16x32_bf16 v[124:127], v[84:87], v[52:55], v[124:127]
  ds_read_b128 v[80:83], v164 offset:7168
  s_waitcnt vmcnt(3) lgkmcnt(6)
  v_mfma_f32_16x16x32_bf16 v[104:107], v[88:91], v[56:59], v[104:107]
  ds_read_b128 v[84:87], v164 offset:25600
  s_waitcnt lgkmcnt(6)
  v_mfma_f32_16x16x32_bf16 v[108:111], v[92:95], v[56:59], v[108:111]
  ds_read_b128 v[88:91], v165 offset:7168
  s_waitcnt lgkmcnt(6)
  v_mfma_f32_16x16x32_bf16 v[112:115], v[96:99], v[56:59], v[112:115]
  ds_read_b128 v[92:95], v165 offset:25600
  s_waitcnt lgkmcnt(6)
  v_mfma_f32_16x16x32_bf16 v[116:119], v[100:103], v[56:59], v[116:119]
  ds_read_b128 v[96:99], v179 offset:7168
  s_waitcnt lgkmcnt(6)
  v_mfma_f32_16x16x32_bf16 v[120:123], v[72:75], v[56:59], v[120:123]
  ds_read_b128 v[100:103], v179 offset:25600
  s_waitcnt lgkmcnt(6)
  v_mfma_f32_16x16x32_bf16 v[124:127], v[76:79], v[56:59], v[124:127]
  ds_read_b128 v[72:75], v164 offset:8192
  s_waitcnt vmcnt(2) lgkmcnt(6)
  v_mfma_f32_16x16x32_bf16 v[104:107], v[80:83], v[60:63], v[104:107]
  ds_read_b128 v[76:79], v164 offset:26624
  s_waitcnt lgkmcnt(6)
  v_mfma_f32_16x16x32_bf16 v[108:111], v[84:87], v[60:63], v[108:111]
  ds_read_b128 v[80:83], v165 offset:8192
  s_waitcnt lgkmcnt(6)
  v_mfma_f32_16x16x32_bf16 v[112:115], v[88:91], v[60:63], v[112:115]
  ds_read_b128 v[84:87], v165 offset:26624
  s_waitcnt lgkmcnt(6)
  v_mfma_f32_16x16x32_bf16 v[116:119], v[92:95], v[60:63], v[116:119]
  ds_read_b128 v[88:91], v179 offset:8192
  s_waitcnt lgkmcnt(6)
  v_mfma_f32_16x16x32_bf16 v[120:123], v[96:99], v[60:63], v[120:123]
  ds_read_b128 v[92:95], v179 offset:26624
  s_waitcnt lgkmcnt(6)
  v_mfma_f32_16x16x32_bf16 v[124:127], v[100:103], v[60:63], v[124:127]
  s_waitcnt vmcnt(1) lgkmcnt(5)
  v_mfma_f32_16x16x32_bf16 v[104:107], v[72:75], v[64:67], v[104:107]
  s_waitcnt lgkmcnt(4)
  v_mfma_f32_16x16x32_bf16 v[108:111], v[76:79], v[64:67], v[108:111]
  s_waitcnt lgkmcnt(3)
  v_mfma_f32_16x16x32_bf16 v[112:115], v[80:83], v[64:67], v[112:115]
  s_waitcnt lgkmcnt(2)
  v_mfma_f32_16x16x32_bf16 v[116:119], v[84:87], v[64:67], v[116:119]
  s_waitcnt lgkmcnt(1)
  v_mfma_f32_16x16x32_bf16 v[120:123], v[88:91], v[64:67], v[120:123]
  s_waitcnt lgkmcnt(0)
  v_mfma_f32_16x16x32_bf16 v[124:127], v[92:95], v[64:67], v[124:127]
  s_waitcnt vmcnt(0)
  v_readfirstlane_b32 s46, v173
  s_cmp_lg_u32 s20, 0
  s_cbranch_scc1 M_BH1
  s_setprio 3
  s_nop 7
  ds_write_b128 v166, v[116:119] offset:3072
  ds_write_b128 v166, v[120:123] offset:4096
  ds_write_b128 v166, v[124:127] offset:5120
  s_waitcnt lgkmcnt(0)
  s_barrier
  v_mov_b32 v176, 0
  v_mov_b32 v177, 0
  ds_read_b128 v[136:139], v166 offset:0
  ds_read_b128 v[140:143], v166 offset:1024
  ds_read_b128 v[144:147], v166 offset:2048
  v_mov_b32 v173, 163832
  ds_read_b32 v173, v173
  s_waitcnt lgkmcnt(0)
  v_readfirstlane_b32 s47, v173
  s_cmp_lg_u32 s47, 0
  s_cselect_b32 s38, 0, s38
  s_cmp_eq_u32 s46, 0
  s_cbranch_scc1 M_PDW0
M_PDW0_B:
  v_lshlrev_b32 v172, 16, v128
  v_and_b32 v173, 0xffff0000, v128
  v_lshlrev_b32 v174, 16, v129
  v_and_b32 v175, 0xffff0000, v129
  v_add_f32 v104, v104, v136
  v_add_f32 v105, v105, v137
  v_add_f32 v106, v106, v138
  v_add_f32 v107, v107, v139
  v_add_f32 v172, v172, v104
  v_add_f32 v173, v173, v105
  v_add_f32 v174, v174, v106
  v_add_f32 v175, v175, v107
  v_cvt_pk_bf16_f32 v128, v172, v173
  v_cvt_pk_bf16_f32 v129, v174, v175
  v_dot2_f32_bf16 v176, v128, v178, v176
  v_dot2_f32_bf16 v177, v128, v128, v177
  v_dot2_f32_bf16 v176, v129, v178, v176
  v_dot2_f32_bf16 v177, v129, v129, v177
  v_lshlrev_b32 v172, 16, v130
  v_and_b32 v173, 0xffff0000, v130
  v_lshlrev_b32 v174, 16, v131
  v_and_b32 v175, 0xffff0000, v131
  v_add_f32 v108, v108, v140
  v_add_f32 v109, v109, v141
  v_add_f32 v110, v110, v142
  v_add_f32 v111, v111, v143
  v_add_f32 v172, v172, v108
  v_add_f32 v173, v173, v109
  v_add_f32 v174, v174, v110
  v_add_f32 v175, v175, v111
  v_cvt_pk_bf16_f32 v130, v172, v173
  v_cvt_pk_bf16_f32 v131, v174, v175
  v_dot2_f32_bf16 v176, v130, v178, v176
  v_dot2_f32_bf16 v177, v130, v130, v177
  v_dot2_f32_bf16 v176, v131, v178, v176
  v_dot2_f32_bf16 v177, v131, v131, v177
  s_nop 2
  v_permlane16_swap_b32 v128, v130
  v_permlane16_swap_b32 v129, v131
  buffer_store_dwordx4 v[128:131], v167, s[36:39], s51 offen sc1
  v_lshlrev_b32 v172, 16, v132
  v_and_b32 v173, 0xffff0000, v132
  v_lshlrev_b32 v174, 16, v133
  v_and_b32 v175, 0xffff0000, v133
  v_add_f32 v112, v112, v144
  v_add_f32 v113, v113, v145
  v_add_f32 v114, v114, v146
  v_add_f32 v115, v115, v147
  v_add_f32 v172, v172, v112
  v_add_f32 v173, v173, v113
  v_add_f32 v174, v174, v114
  v_add_f32 v175, v175, v115
  v_cvt_pk_bf16_f32 v132, v172, v173
  v_cvt_pk_bf16_f32 v133, v174, v175
  v_dot2_f32_bf16 v176, v132, v178, v176
  v_dot2_f32_bf16 v177, v132, v132, v177
  v_dot2_f32_bf16 v176, v133, v178, v176
  v_dot2_f32_bf16 v177, v133, v133, v177
  s_nop 2
  v_permlane16_swap_b32 v132, v134
  v_permlane16_swap_b32 v133, v135
  s_mov_b32 exec_lo, 0xffff
  s_mov_b32 exec_hi, 0xffff
  buffer_store_dwordx4 v[132:135], v167, s[36:39], s51 offen offset:1024 sc1
  s_mov_b64 exec, -1
  s_lshl_b32 s33, s17, 12
  s_add_u32 s35, s14, s33
  s_mov_b32 m0, s33
  s_nop 0
  buffer_load_dwordx4 v1, s[24:27], s35 offen offset:0 lds
  buffer_load_dwordx4 v1, s[24:27], s35 offen offset:1024 lds
  buffer_load_dwordx4 v1, s[24:27], s35 offen offset:2048 lds
  buffer_load_dwordx4 v1, s[24:27], s35 offen offset:3072 lds
  s_lshl_b32 s33, s16, 10
  s_add_u32 s33, s33, 32768
  s_add_u32 s35, s14, s33
  s_mov_b32 m0, s33
  s_nop 0
  buffer_load_dwordx4 v1, s[24:27], s35 offen lds
  v_mov_b32 v168, v176
  s_nop 1
  v_permlane16_swap_b32 v176, v168
  v_add_f32 v176, v176, v168
  v_mov_b32 v168, v176
  s_nop 1
  v_permlane32_swap_b32 v176, v168
  v_add_f32 v176, v176, v168
  v_mov_b32 v168, v177
  s_nop 1
  v_permlane16_swap_b32 v177, v168
  v_add_f32 v177, v177, v168
  v_mov_b32 v168, v177
  s_nop 1
  v_permlane32_swap_b32 v177, v168
  v_add_f32 v177, v177, v168
  s_lshl_b32 s33, s18, 1
  s_add_u32 s33, s33, s20
  s_lshl_b32 s33, s33, 14
  s_add_u32 s33, s33, 0x240000
  v_lshlrev_b32 v168, 3, v163
  s_setprio 0
  s_mov_b64 exec, 0xffff
  buffer_store_dwordx2 v[176:177], v168, s[36:39], s33 offen sc1
  s_mov_b64 exec, -1
  s_branch M_CSTART
M_PDW0:
  s_mov_b32 s47, 98304
  s_mov_b32 s8, s96
M_PDS0:
  buffer_load_dword v172, off, s[60:63], s47 sc0 sc1
  s_waitcnt vmcnt(0)
  v_cmp_eq_u32 s[6:7], 0, v172
  s_cmp_eq_u64 s[6:7], 0
  s_cbranch_scc1 M_PDS0_OK
  s_sub_u32 s8, s8, 1
  s_cmp_lg_u32 s8, 0
  s_cbranch_scc1 M_PDS0
  s_cmp_lg_u32 s97, 0
  s_cbranch_scc1 M_FL1
  s_mov_b32 s97, 1
  s_mov_b32 s96, 1
  s_mov_b64 exec, 1
  v_mov_b32 v254, 1
  s_mov_b32 s6, 98432
  buffer_atomic_add v254, off, s[60:63], s6 sc0 sc1
  s_waitcnt vmcnt(0)
  v_readfirstlane_b32 s6, v254
  s_cmp_eq_u32 s6, 0
  s_cselect_b32 s6, 1, 0
  v_mov_b32 v254, 163832
  v_mov_b32 v255, 1
  ds_write_b32 v254, v255
  v_mov_b32 v255, s6
  ds_or_b32 v254, v255 offset:4
  s_waitcnt lgkmcnt(0)
  s_mov_b64 exec, -1
M_FL1:
  s_mov_b32 s38, 0
M_PDS0_OK:
  s_branch M_PDW0_B
M_BH1:
  s_setprio 3
  s_nop 7
  ds_write_b128 v166, v[104:107] offset:0
  ds_write_b128 v166, v[108:111] offset:1024
  ds_write_b128 v166, v[112:115] offset:2048
  s_waitcnt lgkmcnt(0)
  s_barrier
  v_mov_b32 v176, 0
  v_mov_b32 v177, 0
  ds_read_b128 v[136:139], v166 offset:3072
  ds_read_b128 v[140:143], v166 offset:4096
  ds_read_b128 v[144:147], v166 offset:5120
  v_mov_b32 v173, 163832
  ds_read_b32 v173, v173
  s_waitcnt lgkmcnt(0)
  v_readfirstlane_b32 s47, v173
  s_cmp_lg_u32 s47, 0
  s_cselect_b32 s38, 0, s38
  s_cmp_eq_u32 s46, 0
  s_cbranch_scc1 M_PDW1
M_PDW1_B:
  v_lshlrev_b32 v172, 16, v128
  v_and_b32 v173, 0xffff0000, v128
  v_lshlrev_b32 v174, 16, v129
  v_and_b32 v175, 0xffff0000, v129
  v_add_f32 v116, v116, v136
  v_add_f32 v117, v117, v137
  v_add_f32 v118, v118, v138
  v_add_f32 v119, v119, v139
  v_add_f32 v172, v172, v116
  v_add_f32 v173, v173, v117
  v_add_f32 v174, v174, v118
  v_add_f32 v175, v175, v119
  v_cvt_pk_bf16_f32 v128, v172, v173
  v_cvt_pk_bf16_f32 v129, v174, v175
  v_dot2_f32_bf16 v176, v128, v178, v176
  v_dot2_f32_bf16 v177, v128, v128, v177
  v_dot2_f32_bf16 v176, v129, v178, v176
  v_dot2_f32_bf16 v177, v129, v129, v177
  v_lshlrev_b32 v172, 16, v130
  v_and_b32 v173, 0xffff0000, v130
  v_lshlrev_b32 v174, 16, v131
  v_and_b32 v175, 0xffff0000, v131
  v_add_f32 v120, v120, v140
  v_add_f32 v121, v121, v141
  v_add_f32 v122, v122, v142
  v_add_f32 v123, v123, v143
  v_add_f32 v172, v172, v120
  v_add_f32 v173, v173, v121
  v_add_f32 v174, v174, v122
  v_add_f32 v175, v175, v123
  v_cvt_pk_bf16_f32 v130, v172, v173
  v_cvt_pk_bf16_f32 v131, v174, v175
  v_dot2_f32_bf16 v176, v130, v178, v176
  v_dot2_f32_bf16 v177, v130, v130, v177
  v_dot2_f32_bf16 v176, v131, v178, v176
  v_dot2_f32_bf16 v177, v131, v131, v177
  s_nop 2
  v_permlane16_swap_b32 v128, v130
  v_permlane16_swap_b32 v129, v131
  buffer_store_dwordx4 v[128:131], v167, s[36:39], s51 offen sc1
  v_lshlrev_b32 v172, 16, v132
  v_and_b32 v173, 0xffff0000, v132
  v_lshlrev_b32 v174, 16, v133
  v_and_b32 v175, 0xffff0000, v133
  v_add_f32 v124, v124, v144
  v_add_f32 v125, v125, v145
  v_add_f32 v126, v126, v146
  v_add_f32 v127, v127, v147
  v_add_f32 v172, v172, v124
  v_add_f32 v173, v173, v125
  v_add_f32 v174, v174, v126
  v_add_f32 v175, v175, v127
  v_cvt_pk_bf16_f32 v132, v172, v173
  v_cvt_pk_bf16_f32 v133, v174, v175
  v_dot2_f32_bf16 v176, v132, v178, v176
  v_dot2_f32_bf16 v177, v132, v132, v177
  v_dot2_f32_bf16 v176, v133, v178, v176
  v_dot2_f32_bf16 v177, v133, v133, v177
  s_nop 2
  v_permlane16_swap_b32 v132, v134
  v_permlane16_swap_b32 v133, v135
  s_mov_b32 exec_lo, 0xffff
  s_mov_b32 exec_hi, 0xffff
  buffer_store_dwordx4 v[132:135], v167, s[36:39], s51 offen offset:1024 sc1
  s_mov_b64 exec, -1
  s_lshl_b32 s33, s17, 12
  s_add_u32 s35, s14, s33
  s_mov_b32 m0, s33
  s_nop 0
  buffer_load_dwordx4 v1, s[24:27], s35 offen offset:0 lds
  buffer_load_dwordx4 v1, s[24:27], s35 offen offset:1024 lds
  buffer_load_dwordx4 v1, s[24:27], s35 offen offset:2048 lds
  buffer_load_dwordx4 v1, s[24:27], s35 offen offset:3072 lds
  s_lshl_b32 s33, s16, 10
  s_add_u32 s33, s33, 32768
  s_add_u32 s35, s14, s33
  s_mov_b32 m0, s33
  s_nop 0
  buffer_load_dwordx4 v1, s[24:27], s35 offen lds
  v_mov_b32 v168, v176
  s_nop 1
  v_permlane16_swap_b32 v176, v168
  v_add_f32 v176, v176, v168
  v_mov_b32 v168, v176
  s_nop 1
  v_permlane32_swap_b32 v176, v168
  v_add_f32 v176, v176, v168
  v_mov_b32 v168, v177
  s_nop 1
  v_permlane16_swap_b32 v177, v168
  v_add_f32 v177, v177, v168
  v_mov_b32 v168, v177
  s_nop 1
  v_permlane32_swap_b32 v177, v168
  v_add_f32 v177, v177, v168
  s_lshl_b32 s33, s18, 1
  s_add_u32 s33, s33, s20
  s_lshl_b32 s33, s33, 14
  s_add_u32 s33, s33, 0x240000
  v_lshlrev_b32 v168, 3, v163
  s_setprio 0
  s_mov_b64 exec, 0xffff
  buffer_store_dwordx2 v[176:177], v168, s[36:39], s33 offen sc1
  s_mov_b64 exec, -1
  s_branch M_CSTART
M_PDW1:
  s_mov_b32 s47, 98304
  s_mov_b32 s8, s96
M_PDS1:
  buffer_load_dword v172, off, s[60:63], s47 sc0 sc1
  s_waitcnt vmcnt(0)
  v_cmp_eq_u32 s[6:7], 0, v172
  s_cmp_eq_u64 s[6:7], 0
  s_cbranch_scc1 M_PDS1_OK
  s_sub_u32 s8, s8, 1
  s_cmp_lg_u32 s8, 0
  s_cbranch_scc1 M_PDS1
  s_cmp_lg_u32 s97, 0
  s_cbranch_scc1 M_FL2
  s_mov_b32 s97, 1
  s_mov_b32 s96, 1
  s_mov_b64 exec, 1
  v_mov_b32 v254, 1
  s_mov_b32 s6, 98432
  buffer_atomic_add v254, off, s[60:63], s6 sc0 sc1
  s_waitcnt vmcnt(0)
  v_readfirstlane_b32 s6, v254
  s_cmp_eq_u32 s6, 0
  s_cselect_b32 s6, 1, 0
  v_mov_b32 v254, 163832
  v_mov_b32 v255, 1
  ds_write_b32 v254, v255
  v_mov_b32 v255, s6
  ds_or_b32 v254, v255 offset:4
  s_waitcnt lgkmcnt(0)
  s_mov_b64 exec, -1
M_FL2:
  s_mov_b32 s38, 0
M_PDS1_OK:
  s_branch M_PDW1_B
M_IDLE:
  s_waitcnt lgkmcnt(0)
  s_waitcnt vmcnt(0)
  s_barrier
  s_cmp_lg_u32 s17, 0
  s_cbranch_scc1 M_PUBA2
  s_lshl_b32 s33, s3, 7
  s_add_u32 s33, s33, 65536
  v_lshlrev_b32 v20, 2, v7
  v_mov_b32 v21, 1
  s_mov_b32 exec_hi, 0
  buffer_store_dword v21, v20, s[60:63], s33 offen sc1
  s_mov_b32 exec_hi, -1
M_PUBA2:
  s_cmp_eq_u32 s2, 255
  s_cselect_b32 s33, s17, 0
  s_cmp_eq_u32 s33, 7
  s_cbranch_scc0 M_NOCOL
  v_lshlrev_b32 v20, 7, v7
  s_mov_b32 s33, 65536
  s_mov_b32 s8, s96
M_COL:
  buffer_load_dword v24, v20, s[60:63], s33 offen sc0 sc1
  v_add_u32 v20, 8192, v20
  buffer_load_dword v25, v20, s[60:63], s33 offen sc0 sc1
  v_add_u32 v20, 8192, v20
  buffer_load_dword v26, v20, s[60:63], s33 offen sc0 sc1
  v_add_u32 v20, 8192, v20
  buffer_load_dword v27, v20, s[60:63], s33 offen sc0 sc1
  v_add_u32 v20, 4294942720, v20
  s_waitcnt vmcnt(0)
  v_min_u32 v24, v24, v25
  v_min_u32 v26, v26, v27
  v_min_u32 v24, v24, v26
  v_cmp_eq_u32 s[6:7], 0, v24
  s_cmp_eq_u64 s[6:7], 0
  s_cbranch_scc1 M_COL_OK
  s_sub_u32 s8, s8, 1
  s_cmp_lg_u32 s8, 0
  s_cbranch_scc1 M_COL
  s_cmp_lg_u32 s97, 0
  s_cbranch_scc1 M_FL3
  s_mov_b32 s97, 1
  s_mov_b32 s96, 1
  s_mov_b64 exec, 1
  v_mov_b32 v254, 1
  s_mov_b32 s6, 98432
  buffer_atomic_add v254, off, s[60:63], s6 sc0 sc1
  s_waitcnt vmcnt(0)
  v_readfirstlane_b32 s6, v254
  s_cmp_eq_u32 s6, 0
  s_cselect_b32 s6, 1, 0
  v_mov_b32 v254, 163832
  v_mov_b32 v255, 1
  ds_write_b32 v254, v255
  v_mov_b32 v255, s6
  ds_or_b32 v254, v255 offset:4
  s_waitcnt lgkmcnt(0)
  s_mov_b64 exec, -1
M_FL3:
  s_branch M_NOCOL
M_COL_OK:
  s_mov_b32 s33, 98304
  v_lshlrev_b32 v20, 2, v7
  v_mov_b32 v21, 1
  s_mov_b32 exec_hi, 0
  buffer_store_dword v21, v20, s[60:63], s33 offen sc1
  s_mov_b32 exec_hi, -1
M_NOCOL:
  s_cmp_lg_u32 s17, 0
  s_cbranch_scc1 M_PDI_OK
  s_mov_b32 s47, 98304
  s_mov_b32 s8, s96
M_PDI:
  buffer_load_dword v24, off, s[60:63], s47 sc0 sc1
  s_waitcnt vmcnt(0)
  v_cmp_eq_u32 s[6:7], 0, v24
  s_cmp_eq_u64 s[6:7], 0
  s_cbranch_scc1 M_PDI_OK
  s_sub_u32 s8, s8, 1
  s_cmp_lg_u32 s8, 0
  s_cbranch_scc1 M_PDI
  s_cmp_lg_u32 s97, 0
  s_cbranch_scc1 M_FL4
  s_mov_b32 s97, 1
  s_mov_b32 s96, 1
  s_mov_b64 exec, 1
  v_mov_b32 v254, 1
  s_mov_b32 s6, 98432
  buffer_atomic_add v254, off, s[60:63], s6 sc0 sc1
  s_waitcnt vmcnt(0)
  v_readfirstlane_b32 s6, v254
  s_cmp_eq_u32 s6, 0
  s_cselect_b32 s6, 1, 0
  v_mov_b32 v254, 163832
  v_mov_b32 v255, 1
  ds_write_b32 v254, v255
  v_mov_b32 v255, s6
  ds_or_b32 v254, v255 offset:4
  s_waitcnt lgkmcnt(0)
  s_mov_b64 exec, -1
M_FL4:
M_PDI_OK:
  s_barrier
  s_lshr_b32 s33, s2, 3
  s_sub_u32 s33, s33, 24
  s_lshl_b32 s33, s33, 3
  s_add_u32 s33, s33, s17
  s_mul_i32 s34, s33, 54
  v_min_u32 v16, 53, v7
  v_add_u32 v16, s34, v16
  v_mul_u32_u24 v17, 4855, v16
  v_lshrrev_b32 v17, 22, v17
  v_mul_u32_u24 v18, 864, v17
  v_sub_u32 v16, v16, v18
  v_mul_u32_u24 v17, 663552, v17
  v_lshl_add_u32 v16, v16, 7, v17
  s_and_b32 s34, s2, 3
  s_mul_i32 s35, s34, 2654208
  s_mul_i32 s33, s33, 11
  v_min_u32 v17, 10, v7
  v_add_u32 v17, s33, v17
  v_min_u32 v17, 647, v17
  v_mul_u32_u24 v18, 1821, v17
  v_lshrrev_b32 v18, 16, v18
  v_mul_u32_u24 v19, 36, v18
  v_sub_u32 v17, v17, v19
  v_mul_u32_u24 v18, 18432, v18
  v_lshl_add_u32 v17, v17, 7, v18
  s_mul_i32 s34, s34, 4608
  s_add_u32 s34, s34, 0x1100000
  buffer_load_dword v20, v16, s[24:27], s35 offen
  buffer_load_dword v21, v17, s[24:27], s34 offen
  s_lshl_b32 s33, s17, 12
  s_add_u32 s35, s14, s33
  s_mov_b32 m0, s33
  s_nop 0
  buffer_load_dwordx4 v1, s[24:27], s35 offen offset:0 lds
  buffer_load_dwordx4 v1, s[24:27], s35 offen offset:1024 lds
  buffer_load_dwordx4 v1, s[24:27], s35 offen offset:2048 lds
  buffer_load_dwordx4 v1, s[24:27], s35 offen offset:3072 lds
  s_lshl_b32 s33, s16, 10
  s_add_u32 s33, s33, 32768
  s_add_u32 s35, s14, s33
  s_mov_b32 m0, s33
  s_nop 0
  buffer_load_dwordx4 v1, s[24:27], s35 offen lds
M_CSTART:
  s_and_b32 s33, s2, 7
  s_lshr_b32 s34, s2, 3
  s_lshr_b32 s19, s33, 2
  s_lshl_b32 s19, s19, 3
  s_and_b32 s35, s34, 7
  s_add_u32 s19, s19, s35
  s_and_b32 s28, s33, 3
  s_lshr_b32 s18, s34, 3
  s_mov_b32 s20, s15
  s_lshl_b32 s46, s19, 2
  s_add_u32 s46, s46, s16
  s_mul_i32 s44, s46, 144
  s_mul_i32 s33, s28, 36
  s_add_u32 s44, s44, s33
  s_lshl_b32 s29, s44, 11
  s_add_u32 s44, s44, s18
  s_lshl_b32 s44, s44, 11
  s_lshl_b32 s33, s19, 2
  s_add_u32 s33, s33, s28
  s_lshl_b32 s33, s33, 2
  s_add_u32 s33, s33, s16
  s_lshl_b32 s33, s33, 7
  s_add_u32 s56, s33, 32768
  s_mov_b32 s21, s14
  s_cmp_ge_u32 s17, 4
  s_cbranch_scc1 FF_PROD
  s_mul_i32 s35, s46, 36864
  s_add_u32 s45, s35, 18432
  v_and_b32 v8, 15, v7
  v_lshrrev_b32 v9, 4, v7
  s_lshl_b32 s33, s46, 5
  v_add_u32 v10, s33, v8
  v_lshrrev_b32 v12, 1, v9
  v_lshlrev_b32 v12, 8, v12
  v_lshl_add_u32 v12, v8, 4, v12
  v_and_b32 v13, 1, v9
  v_lshl_add_u32 v12, v13, 3, v12
  v_mul_u32_u24 v11, 1152, v10
  v_lshl_add_u32 v11, v9, 3, v11
  v_lshlrev_b32 v8, 3, v10
  v_mul_u32_u24 v10, 49152, v9
  v_add_u32 v8, v8, v10
  v_lshlrev_b32 v6, 4, v9
  v_add_u32 v6, 147328, v6
  v_mov_b32 v4, v1
  v_add_u32 v5, 36864, v1
  s_mov_b32 s22, 0
  s_add_u32 s36, s12, 0x4c0000
  s_addc_u32 s37, s13, 0
  s_mov_b32 s38, 0x340000
  s_mov_b32 s39, 0x00020000
  s_add_u32 s40, s12, 0x800000
  s_addc_u32 s41, s13, 0
  s_mov_b32 s42, 0x1200000
  s_mov_b32 s43, 0x00020000
  v_min_u32 v252, 23, v7
  v_cmp_le_u32 vcc, 12, v252
  s_nop 1
  v_cndmask_b32 v253, 0, 1, vcc
  v_mul_u32_u24 v253, 196480, v253
  v_lshlrev_b32 v252, 14, v252
  v_sub_u32 v252, v252, v253
  s_lshl_b32 s33, s46, 8
  s_add_u32 s33, s33, 0x240000
  s_lshl_b32 s23, s16, 12
  s_add_u32 s23, s23, 18432
  s_lshl_b32 s34, s19, 2
  s_add_u32 s34, s34, s18
  s_lshl_b32 s34, s34, 2
  s_add_u32 s34, s34, s16
  s_mul_i32 s58, s34, 36864
  s_lshl_b32 s57, s34, 7
  s_mul_i32 s59, s18, 288
  s_mul_i32 s30, s46, 36864
  s_mul_i32 s34, s18, 4608
  s_add_u32 s30, s30, s34
  s_lshl_b32 s34, s28, 1
  s_add_u32 s34, s34, 1
  s_cmp_eq_u32 s28, 0
  s_cselect_b32 s34, 0, s34
  s_lshl_b32 s34, s34, 9
  s_add_u32 s31, s34, s30
  s_add_u32 s24, s12, 0x1a00000
  s_addc_u32 s25, s13, 0
  s_mov_b32 s26, 0x1200000
  s_mov_b32 s27, 0x00020000
  s_mov_b32 s52, s4
  s_mov_b32 s53, s5
  s_mov_b32 s54, 0x240000
  s_mov_b32 s55, 0x00020000
  s_waitcnt vmcnt(0)
  s_cmp_lt_u32 s2, 192
  s_cbranch_scc1 M_P1_OK
  s_mov_b32 s8, s96
M_P1:
  buffer_load_dword v248, off, s[36:39], s33 sc0 sc1
  s_waitcnt vmcnt(0)
  v_cmp_eq_u32 s[6:7], -1, v248
  s_cmp_eq_u64 s[6:7], 0
  s_cbranch_scc1 M_P1_OK
  s_sub_u32 s8, s8, 1
  s_cmp_lg_u32 s8, 0
  s_cbranch_scc1 M_P1
  s_cmp_lg_u32 s97, 0
  s_cbranch_scc1 M_FL5
  s_mov_b32 s97, 1
  s_mov_b32 s96, 1
  s_mov_b64 exec, 1
  v_mov_b32 v254, 1
  s_mov_b32 s6, 98432
  buffer_atomic_add v254, off, s[60:63], s6 sc0 sc1
  s_waitcnt vmcnt(0)
  v_readfirstlane_b32 s6, v254
  s_cmp_eq_u32 s6, 0
  s_cselect_b32 s6, 1, 0
  v_mov_b32 v254, 163832
  v_mov_b32 v255, 1
  ds_write_b32 v254, v255
  v_mov_b32 v255, s6
  ds_or_b32 v254, v255 offset:4
  s_waitcnt lgkmcnt(0)
  s_mov_b64 exec, -1
M_FL5:
M_P1_OK:
  s_mov_b32 s8, s96
M_P24:
  buffer_load_dword v248, v252, s[36:39], s33 offen sc0 sc1
  s_waitcnt vmcnt(0)
  v_cmp_eq_u32 s[6:7], -1, v248
  s_cmp_eq_u64 s[6:7], 0
  s_cbranch_scc1 M_P24_OK
  s_sub_u32 s8, s8, 1
  s_cmp_lg_u32 s8, 0
  s_cbranch_scc1 M_P24
  s_cmp_lg_u32 s97, 0
  s_cbranch_scc1 M_FL6
  s_mov_b32 s97, 1
  s_mov_b32 s96, 1
  s_mov_b64 exec, 1
  v_mov_b32 v254, 1
  s_mov_b32 s6, 98432
  buffer_atomic_add v254, off, s[60:63], s6 sc0 sc1
  s_waitcnt vmcnt(0)
  v_readfirstlane_b32 s6, v254
  s_cmp_eq_u32 s6, 0
  s_cselect_b32 s6, 1, 0
  v_mov_b32 v254, 163832
  v_mov_b32 v255, 1
  ds_write_b32 v254, v255
  v_mov_b32 v255, s6
  ds_or_b32 v254, v255 offset:4
  s_waitcnt lgkmcnt(0)
  s_mov_b64 exec, -1
M_FL6:
M_P24_OK:
  v_mov_b32 v253, 0
  buffer_load_dwordx4 v[16:19], v1, s[36:39], s35 offen offset:0
  buffer_load_dwordx4 v[20:23], v1, s[36:39], s45 offen offset:0
  buffer_load_dwordx4 v[24:27], v1, s[36:39], s35 offen offset:1024
  buffer_load_dwordx4 v[28:31], v1, s[36:39], s45 offen offset:1024
  buffer_load_dwordx4 v[32:35], v1, s[36:39], s35 offen offset:2048
  buffer_load_dwordx4 v[36:39], v1, s[36:39], s45 offen offset:2048
  buffer_load_dwordx4 v[40:43], v1, s[36:39], s35 offen offset:3072
  buffer_load_dwordx4 v[44:47], v1, s[36:39], s45 offen offset:3072
  s_add_u32 s35, s35, 4096
  s_add_u32 s45, s45, 4096
  buffer_load_dwordx4 v[48:51], v1, s[36:39], s35 offen offset:0
  buffer_load_dwordx4 v[52:55], v1, s[36:39], s45 offen offset:0
  buffer_load_dwordx4 v[56:59], v1, s[36:39], s35 offen offset:1024
  buffer_load_dwordx4 v[60:63], v1, s[36:39], s45 offen offset:1024
  buffer_load_dwordx4 v[64:67], v1, s[36:39], s35 offen offset:2048
  buffer_load_dwordx4 v[68:71], v1, s[36:39], s45 offen offset:2048
  buffer_load_dwordx4 v[72:75], v1, s[36:39], s35 offen offset:3072
  buffer_load_dwordx4 v[76:79], v1, s[36:39], s45 offen offset:3072
  s_add_u32 s35, s35, 4096
  s_add_u32 s45, s45, 4096
  buffer_load_dwordx4 v[80:83], v1, s[36:39], s35 offen offset:0
  buffer_load_dwordx4 v[84:87], v1, s[36:39], s45 offen offset:0
  buffer_load_dwordx4 v[88:91], v1, s[36:39], s35 offen offset:1024
  buffer_load_dwordx4 v[92:95], v1, s[36:39], s45 offen offset:1024
  s_barrier
  v_mov_b32 v248, 163832
  ds_read_b32 v248, v248
  ds_read_b128 v[192:195], v4 offset:0
  ds_read_b128 v[196:199], v4 offset:1024
  ds_read_b128 v[200:203], v4 offset:2048
  ds_read_b128 v[204:207], v4 offset:3072
  ds_read_b128 v[208:211], v4 offset:4096
  ds_read_b128 v[212:215], v4 offset:5120
  ds_read_b128 v[216:219], v4 offset:6144
  ds_read_b128 v[220:223], v4 offset:7168
  ds_read_b128 v[224:227], v4 offset:8192
  ds_read_b128 v[228:231], v4 offset:9216
  s_waitcnt lgkmcnt(10)
  v_readfirstlane_b32 s47, v248
  s_cmp_lg_u32 s47, 0
  s_cselect_b32 s42, 0, s42
  s_cselect_b32 s62, 0, s62
  s_waitcnt lgkmcnt(8)
  s_waitcnt vmcnt(19)
  v_mfma_f32_16x16x32_bf16 v[160:163], v[192:195], v[16:19], 0
  buffer_load_dwordx4 v[96:99], v1, s[36:39], s35 offen offset:2048
  s_waitcnt vmcnt(19)
  v_mfma_f32_16x16x32_bf16 v[164:167], v[192:195], v[20:23], 0
  ds_read_b128 v[232:235], v4 offset:10240
  v_mfma_f32_16x16x32_bf16 v[168:171], v[196:199], v[16:19], 0
  s_waitcnt lgkmcnt(7)
  buffer_load_dwordx4 v[100:103], v1, s[36:39], s45 offen offset:2048
  v_mfma_f32_16x16x32_bf16 v[172:175], v[196:199], v[20:23], 0
  ds_read_b128 v[236:239], v4 offset:11264
  v_max3_u32 v253, v16, v20, v253
  s_waitcnt vmcnt(19)
  v_mfma_f32_16x16x32_bf16 v[160:163], v[200:203], v[24:27], v[160:163]
  buffer_load_dwordx4 v[104:107], v1, s[36:39], s35 offen offset:3072
  s_waitcnt vmcnt(19)
  v_mfma_f32_16x16x32_bf16 v[164:167], v[200:203], v[28:31], v[164:167]
  ds_read_b128 v[192:195], v4 offset:12288
  v_mfma_f32_16x16x32_bf16 v[168:171], v[204:207], v[24:27], v[168:171]
  s_waitcnt lgkmcnt(7)
  buffer_load_dwordx4 v[108:111], v1, s[36:39], s45 offen offset:3072
  s_add_u32 s35, s35, 4096
  s_add_u32 s45, s45, 4096
  v_mfma_f32_16x16x32_bf16 v[172:175], v[204:207], v[28:31], v[172:175]
  ds_read_b128 v[196:199], v4 offset:13312
  v_max3_u32 v253, v24, v28, v253
  s_waitcnt vmcnt(19)
  v_mfma_f32_16x16x32_bf16 v[160:163], v[208:211], v[32:35], v[160:163]
  buffer_load_dwordx4 v[112:115], v1, s[36:39], s35 offen offset:0
  s_waitcnt vmcnt(19)
  v_mfma_f32_16x16x32_bf16 v[164:167], v[208:211], v[36:39], v[164:167]
  ds_read_b128 v[200:203], v4 offset:14336
  v_mfma_f32_16x16x32_bf16 v[168:171], v[212:215], v[32:35], v[168:171]
  s_waitcnt lgkmcnt(7)
  buffer_load_dwordx4 v[116:119], v1, s[36:39], s45 offen offset:0
  v_mfma_f32_16x16x32_bf16 v[172:175], v[212:215], v[36:39], v[172:175]
  ds_read_b128 v[204:207], v4 offset:15360
  v_max3_u32 v253, v32, v36, v253
  s_waitcnt vmcnt(19)
  v_mfma_f32_16x16x32_bf16 v[160:163], v[216:219], v[40:43], v[160:163]
  buffer_load_dwordx4 v[120:123], v1, s[36:39], s35 offen offset:1024
  s_waitcnt vmcnt(19)
  v_mfma_f32_16x16x32_bf16 v[164:167], v[216:219], v[44:47], v[164:167]
  ds_read_b128 v[208:211], v4 offset:16384
  v_mfma_f32_16x16x32_bf16 v[168:171], v[220:223], v[40:43], v[168:171]
  s_waitcnt lgkmcnt(7)
  buffer_load_dwordx4 v[124:127], v1, s[36:39], s45 offen offset:1024
  v_mfma_f32_16x16x32_bf16 v[172:175], v[220:223], v[44:47], v[172:175]
  ds_read_b128 v[212:215], v4 offset:17408
  v_max3_u32 v253, v40, v44, v253
  s_waitcnt vmcnt(19)
  v_mfma_f32_16x16x32_bf16 v[160:163], v[224:227], v[48:51], v[160:163]
  buffer_load_dwordx4 v[128:131], v1, s[36:39], s35 offen offset:2048
  s_waitcnt vmcnt(19)
  v_mfma_f32_16x16x32_bf16 v[164:167], v[224:227], v[52:55], v[164:167]
  ds_read_b128 v[216:219], v4 offset:18432
  v_mfma_f32_16x16x32_bf16 v[168:171], v[228:231], v[48:51], v[168:171]
  s_waitcnt lgkmcnt(7)
  buffer_load_dwordx4 v[132:135], v1, s[36:39], s45 offen offset:2048
  v_mfma_f32_16x16x32_bf16 v[172:175], v[228:231], v[52:55], v[172:175]
  ds_read_b128 v[220:223], v4 offset:19456
  v_max3_u32 v253, v48, v52, v253
  s_waitcnt vmcnt(19)
  v_mfma_f32_16x16x32_bf16 v[160:163], v[232:235], v[56:59], v[160:163]
  buffer_load_dwordx4 v[136:139], v1, s[36:39], s35 offen offset:3072
  s_waitcnt vmcnt(19)
  v_mfma_f32_16x16x32_bf16 v[164:167], v[232:235], v[60:63], v[164:167]
  ds_read_b128 v[224:227], v4 offset:20480
  v_mfma_f32_16x16x32_bf16 v[168:171], v[236:239], v[56:59], v[168:171]
  s_waitcnt lgkmcnt(7)
  buffer_load_dwordx4 v[140:143], v1, s[36:39], s45 offen offset:3072
  s_add_u32 s35, s35, 4096
  s_add_u32 s45, s45, 4096
  v_mfma_f32_16x16x32_bf16 v[172:175], v[236:239], v[60:63], v[172:175]
  ds_read_b128 v[228:231], v4 offset:21504
  v_max3_u32 v253, v56, v60, v253
  s_waitcnt vmcnt(19)
  v_mfma_f32_16x16x32_bf16 v[160:163], v[192:195], v[64:67], v[160:163]
  buffer_load_dwordx4 v[144:147], v1, s[36:39], s35 offen offset:0
  s_waitcnt vmcnt(19)
  v_mfma_f32_16x16x32_bf16 v[164:167], v[192:195], v[68:71], v[164:167]
  ds_read_b128 v[232:235], v4 offset:22528
  v_mfma_f32_16x16x32_bf16 v[168:171], v[196:199], v[64:67], v[168:171]
  s_waitcnt lgkmcnt(7)
  buffer_load_dwordx4 v[148:151], v1, s[36:39], s45 offen offset:0
  v_mfma_f32_16x16x32_bf16 v[172:175], v[196:199], v[68:71], v[172:175]
  ds_read_b128 v[236:239], v4 offset:23552
  v_max3_u32 v253, v64, v68, v253
  s_waitcnt vmcnt(19)
  v_mfma_f32_16x16x32_bf16 v[160:163], v[200:203], v[72:75], v[160:163]
  buffer_load_dwordx4 v[152:155], v1, s[36:39], s35 offen offset:1024
  s_waitcnt vmcnt(19)
  v_mfma_f32_16x16x32_bf16 v[164:167], v[200:203], v[76:79], v[164:167]
  ds_read_b128 v[192:195], v4 offset:24576
  v_mfma_f32_16x16x32_bf16 v[168:171], v[204:207], v[72:75], v[168:171]
  s_waitcnt lgkmcnt(7)
  buffer_load_dwordx4 v[156:159], v1, s[36:39], s45 offen offset:1024
  v_mfma_f32_16x16x32_bf16 v[172:175], v[204:207], v[76:79], v[172:175]
  ds_read_b128 v[196:199], v4 offset:25600
  v_max3_u32 v253, v72, v76, v253
  s_waitcnt vmcnt(19)
  v_mfma_f32_16x16x32_bf16 v[160:163], v[208:211], v[80:83], v[160:163]
  s_mov_b32 s35, 0x240000
  s_waitcnt vmcnt(18)
  v_mfma_f32_16x16x32_bf16 v[164:167], v[208:211], v[84:87], v[164:167]
  ds_read_b128 v[200:203], v4 offset:26624
  v_mfma_f32_16x16x32_bf16 v[168:171], v[212:215], v[80:83], v[168:171]
  s_waitcnt lgkmcnt(7)
  buffer_load_dwordx2 v[176:177], v8, s[36:39], s35 offen offset:0 sc0 sc1
  v_mfma_f32_16x16x32_bf16 v[172:175], v[212:215], v[84:87], v[172:175]
  ds_read_b128 v[204:207], v4 offset:27648
  v_max3_u32 v253, v80, v84, v253
  s_waitcnt vmcnt(18)
  v_mfma_f32_16x16x32_bf16 v[160:163], v[216:219], v[88:91], v[160:163]
  buffer_load_dwordx2 v[182:183], v8, s[36:39], s35 offen offset:128 sc0 sc1
  s_add_u32 s35, s35, 16384
  s_waitcnt vmcnt(18)
  v_mfma_f32_16x16x32_bf16 v[164:167], v[216:219], v[92:95], v[164:167]
  ds_read_b128 v[208:211], v4 offset:28672
  v_mfma_f32_16x16x32_bf16 v[168:171], v[220:223], v[88:91], v[168:171]
  s_waitcnt lgkmcnt(7)
  buffer_load_dwordx2 v[178:179], v8, s[36:39], s35 offen offset:0 sc0 sc1
  v_mfma_f32_16x16x32_bf16 v[172:175], v[220:223], v[92:95], v[172:175]
  ds_read_b128 v[212:215], v4 offset:29696
  v_max3_u32 v253, v88, v92, v253
  s_waitcnt vmcnt(18)
  v_mfma_f32_16x16x32_bf16 v[160:163], v[224:227], v[96:99], v[160:163]
  buffer_load_dwordx2 v[184:185], v8, s[36:39], s35 offen offset:128 sc0 sc1
  s_add_u32 s35, s35, 16384
  s_waitcnt vmcnt(18)
  v_mfma_f32_16x16x32_bf16 v[164:167], v[224:227], v[100:103], v[164:167]
  ds_read_b128 v[216:219], v4 offset:30720
  v_mfma_f32_16x16x32_bf16 v[168:171], v[228:231], v[96:99], v[168:171]
  s_waitcnt lgkmcnt(7)
  buffer_load_dwordx2 v[180:181], v8, s[36:39], s35 offen offset:0 sc0 sc1
  v_mfma_f32_16x16x32_bf16 v[172:175], v[228:231], v[100:103], v[172:175]
  ds_read_b128 v[220:223], v4 offset:31744
  v_max3_u32 v253, v96, v100, v253
  s_waitcnt vmcnt(18)
  v_mfma_f32_16x16x32_bf16 v[160:163], v[232:235], v[104:107], v[160:163]
  buffer_load_dwordx2 v[186:187], v8, s[36:39], s35 offen offset:128 sc0 sc1
  s_waitcnt vmcnt(18)
  v_mfma_f32_16x16x32_bf16 v[164:167], v[232:235], v[108:111], v[164:167]
  ds_read_b128 v[224:227], v4 offset:32768
  v_mfma_f32_16x16x32_bf16 v[168:171], v[236:239], v[104:107], v[168:171]
  s_waitcnt lgkmcnt(7)
  v_mfma_f32_16x16x32_bf16 v[172:175], v[236:239], v[108:111], v[172:175]
  ds_read_b128 v[228:231], v4 offset:33792
  v_max3_u32 v253, v104, v108, v253
  s_waitcnt vmcnt(17)
  v_mfma_f32_16x16x32_bf16 v[160:163], v[192:195], v[112:115], v[160:163]
  s_waitcnt vmcnt(16)
  v_mfma_f32_16x16x32_bf16 v[164:167], v[192:195], v[116:119], v[164:167]
  ds_read_b128 v[232:235], v4 offset:34816
  v_mfma_f32_16x16x32_bf16 v[168:171], v[196:199], v[112:115], v[168:171]
  s_waitcnt lgkmcnt(7)
  v_mfma_f32_16x16x32_bf16 v[172:175], v[196:199], v[116:119], v[172:175]
  ds_read_b128 v[236:239], v4 offset:35840
  v_max3_u32 v253, v112, v116, v253
  s_barrier
  s_waitcnt vmcnt(15)
  v_mfma_f32_16x16x32_bf16 v[160:163], v[200:203], v[120:123], v[160:163]
  s_waitcnt vmcnt(14)
  v_mfma_f32_16x16x32_bf16 v[164:167], v[200:203], v[124:127], v[164:167]
  ds_read_b128 v[192:195], v5 offset:0
  v_mfma_f32_16x16x32_bf16 v[168:171], v[204:207], v[120:123], v[168:171]
  s_waitcnt lgkmcnt(7)
  v_mfma_f32_16x16x32_bf16 v[172:175], v[204:207], v[124:127], v[172:175]
  ds_read_b128 v[196:199], v5 offset:1024
  v_max3_u32 v253, v120, v124, v253
  s_waitcnt vmcnt(13)
  v_mfma_f32_16x16x32_bf16 v[160:163], v[208:211], v[128:131], v[160:163]
  s_waitcnt vmcnt(5)
  v_max3_u32 v253, v176, v177, v253
  s_waitcnt vmcnt(3)
  v_max3_u32 v253, v178, v179, v253
  v_mfma_f32_16x16x32_bf16 v[164:167], v[208:211], v[132:135], v[164:167]
  ds_read_b128 v[200:203], v5 offset:2048
  s_waitcnt vmcnt(1)
  v_max3_u32 v253, v180, v181, v253
  v_mfma_f32_16x16x32_bf16 v[168:171], v[212:215], v[128:131], v[168:171]
  s_waitcnt lgkmcnt(7)
  v_max3_u32 v253, v182, v183, v253
  v_mfma_f32_16x16x32_bf16 v[172:175], v[212:215], v[132:135], v[172:175]
  ds_read_b128 v[204:207], v5 offset:3072
  v_max3_u32 v253, v128, v132, v253
  v_max3_u32 v253, v184, v185, v253
  v_mfma_f32_16x16x32_bf16 v[160:163], v[216:219], v[136:139], v[160:163]
  s_waitcnt vmcnt(0)
  v_max3_u32 v253, v186, v187, v253
  v_add_f32 v2, v176, v178
  v_mfma_f32_16x16x32_bf16 v[164:167], v[216:219], v[140:143], v[164:167]
  ds_read_b128 v[208:211], v5 offset:4096
  v_add_f32 v14, v177, v179
  v_mfma_f32_16x16x32_bf16 v[168:171], v[220:223], v[136:139], v[168:171]
  s_waitcnt lgkmcnt(7)
  v_add_f32 v2, v2, v180
  v_mfma_f32_16x16x32_bf16 v[172:175], v[220:223], v[140:143], v[172:175]
  ds_read_b128 v[212:215], v5 offset:5120
  v_max3_u32 v253, v136, v140, v253
  v_add_f32 v14, v14, v181
  v_mfma_f32_16x16x32_bf16 v[160:163], v[224:227], v[144:147], v[160:163]
  v_mov_b32 v7, v2
  s_nop 1
  v_mfma_f32_16x16x32_bf16 v[164:167], v[224:227], v[148:151], v[164:167]
  ds_read_b128 v[216:219], v5 offset:6144
  v_permlane16_swap_b32 v2, v7
  v_mfma_f32_16x16x32_bf16 v[168:171], v[228:231], v[144:147], v[168:171]
  s_waitcnt lgkmcnt(7)
  v_add_f32 v2, v2, v7
  v_mfma_f32_16x16x32_bf16 v[172:175], v[228:231], v[148:151], v[172:175]
  ds_read_b128 v[220:223], v5 offset:7168
  v_max3_u32 v253, v144, v148, v253
  v_mov_b32 v7, v2
  v_mfma_f32_16x16x32_bf16 v[160:163], v[232:235], v[152:155], v[160:163]
  s_nop 1
  v_permlane32_swap_b32 v2, v7
  v_mfma_f32_16x16x32_bf16 v[164:167], v[232:235], v[156:159], v[164:167]
  ds_read_b128 v[224:227], v5 offset:8192
  v_add_f32 v2, v2, v7
  v_mfma_f32_16x16x32_bf16 v[168:171], v[236:239], v[152:155], v[168:171]
  s_waitcnt lgkmcnt(7)
  v_mul_f32 v2, 0xbae38e39, v2
  v_mfma_f32_16x16x32_bf16 v[172:175], v[236:239], v[156:159], v[172:175]
  ds_read_b128 v[228:231], v5 offset:9216
  v_max3_u32 v253, v152, v156, v253
  v_add_f32 v3, v182, v184
  v_add_f32 v15, v183, v185
  v_add_f32 v3, v3, v186
  v_add_f32 v15, v15, v187
  v_mov_b32 v7, v3
  s_nop 1
  v_permlane16_swap_b32 v3, v7
  v_add_f32 v3, v3, v7
  v_mov_b32 v7, v3
  s_nop 1
  v_permlane32_swap_b32 v3, v7
  v_add_f32 v3, v3, v7
  v_mul_f32 v3, 0xbae38e39, v3
  ds_read_b128 v[240:243], v6 offset:128
  ds_read_b128 v[244:247], v6 offset:192
  v_cmp_eq_u32 s[6:7], -1, v253
  s_cmp_lg_u64 s[6:7], 0
  s_cbranch_scc1 FF_XSLOW
FF_XSLOW_B:
  v_mfma_f32_16x16x32_bf16 v[176:179], v[192:195], v[16:19], 0
  v_mfma_f32_16x16x32_bf16 v[180:183], v[192:195], v[20:23], 0
  ds_read_b128 v[232:235], v5 offset:10240
  v_mfma_f32_16x16x32_bf16 v[184:187], v[196:199], v[16:19], 0
  s_waitcnt lgkmcnt(9)
  s_waitcnt lgkmcnt(2)
  v_fmac_f32 v160, v2, v240
  v_mfma_f32_16x16x32_bf16 v[188:191], v[196:199], v[20:23], 0
  ds_read_b128 v[236:239], v5 offset:11264
  v_fmac_f32 v161, v2, v241
  v_mfma_f32_16x16x32_bf16 v[176:179], v[200:203], v[24:27], v[176:179]
  v_fmac_f32 v162, v2, v242
  v_fmac_f32 v163, v2, v243
  v_mfma_f32_16x16x32_bf16 v[180:183], v[200:203], v[28:31], v[180:183]
  ds_read_b128 v[192:195], v5 offset:12288
  s_waitcnt lgkmcnt(3)
  v_fmac_f32 v168, v2, v244
  v_mfma_f32_16x16x32_bf16 v[184:187], v[204:207], v[24:27], v[184:187]
  v_fmac_f32 v169, v2, v245
  v_mfma_f32_16x16x32_bf16 v[188:191], v[204:207], v[28:31], v[188:191]
  ds_read_b128 v[196:199], v5 offset:13312
  v_fmac_f32 v170, v2, v246
  v_mfma_f32_16x16x32_bf16 v[176:179], v[208:211], v[32:35], v[176:179]
  v_fmac_f32 v171, v2, v247
  v_mul_f32 v160, v160, v168
  v_mfma_f32_16x16x32_bf16 v[180:183], v[208:211], v[36:39], v[180:183]
  ds_read_b128 v[200:203], v5 offset:14336
  v_mul_f32 v161, v161, v169
  v_mfma_f32_16x16x32_bf16 v[184:187], v[212:215], v[32:35], v[184:187]
  v_mul_f32 v162, v162, v170
  v_mfma_f32_16x16x32_bf16 v[188:191], v[212:215], v[36:39], v[188:191]
  ds_read_b128 v[204:207], v5 offset:15360
  v_mul_f32 v163, v163, v171
  v_mfma_f32_16x16x32_bf16 v[176:179], v[216:219], v[40:43], v[176:179]
  v_cvt_pk_bf16_f32 v248, v160, v161
  v_cvt_pk_bf16_f32 v249, v162, v163
  v_mfma_f32_16x16x32_bf16 v[180:183], v[216:219], v[44:47], v[180:183]
  ds_read_b128 v[208:211], v5 offset:16384
  v_fmac_f32 v164, v3, v240
  v_mfma_f32_16x16x32_bf16 v[184:187], v[220:223], v[40:43], v[184:187]
  v_fmac_f32 v165, v3, v241
  v_mfma_f32_16x16x32_bf16 v[188:191], v[220:223], v[44:47], v[188:191]
  ds_read_b128 v[212:215], v5 offset:17408
  v_fmac_f32 v166, v3, v242
  v_mfma_f32_16x16x32_bf16 v[176:179], v[224:227], v[48:51], v[176:179]
  v_fmac_f32 v167, v3, v243
  v_fmac_f32 v172, v3, v244
  v_mfma_f32_16x16x32_bf16 v[180:183], v[224:227], v[52:55], v[180:183]
  ds_read_b128 v[216:219], v5 offset:18432
  v_fmac_f32 v173, v3, v245
  v_mfma_f32_16x16x32_bf16 v[184:187], v[228:231], v[48:51], v[184:187]
  s_waitcnt lgkmcnt(7)
  v_fmac_f32 v174, v3, v246
  v_mfma_f32_16x16x32_bf16 v[188:191], v[228:231], v[52:55], v[188:191]
  ds_read_b128 v[220:223], v5 offset:19456
  v_fmac_f32 v175, v3, v247
  v_mfma_f32_16x16x32_bf16 v[176:179], v[232:235], v[56:59], v[176:179]
  v_mul_f32 v164, v164, v172
  v_mul_f32 v165, v165, v173
  v_mfma_f32_16x16x32_bf16 v[180:183], v[232:235], v[60:63], v[180:183]
  ds_read_b128 v[224:227], v5 offset:20480
  v_mul_f32 v166, v166, v174
  v_mfma_f32_16x16x32_bf16 v[184:187], v[236:239], v[56:59], v[184:187]
  s_waitcnt lgkmcnt(7)
  v_mul_f32 v167, v167, v175
  v_mfma_f32_16x16x32_bf16 v[188:191], v[236:239], v[60:63], v[188:191]
  ds_read_b128 v[228:231], v5 offset:21504
  v_cvt_pk_bf16_f32 v252, v164, v165
  v_mfma_f32_16x16x32_bf16 v[176:179], v[192:195], v[64:67], v[176:179]
  v_cvt_pk_bf16_f32 v253, v166, v167
  v_mfma_f32_16x16x32_bf16 v[180:183], v[192:195], v[68:71], v[180:183]
  ds_read_b128 v[232:235], v5 offset:22528
  v_mfma_f32_16x16x32_bf16 v[184:187], v[196:199], v[64:67], v[184:187]
  s_waitcnt lgkmcnt(7)
  v_mfma_f32_16x16x32_bf16 v[188:191], v[196:199], v[68:71], v[188:191]
  ds_read_b128 v[236:239], v5 offset:23552
  v_mfma_f32_16x16x32_bf16 v[176:179], v[200:203], v[72:75], v[176:179]
  v_mfma_f32_16x16x32_bf16 v[180:183], v[200:203], v[76:79], v[180:183]
  ds_read_b128 v[192:195], v5 offset:24576
  v_mfma_f32_16x16x32_bf16 v[184:187], v[204:207], v[72:75], v[184:187]
  s_waitcnt lgkmcnt(7)
  v_mfma_f32_16x16x32_bf16 v[188:191], v[204:207], v[76:79], v[188:191]
  ds_read_b128 v[196:199], v5 offset:25600
  v_mfma_f32_16x16x32_bf16 v[176:179], v[208:211], v[80:83], v[176:179]
  v_mfma_f32_16x16x32_bf16 v[180:183], v[208:211], v[84:87], v[180:183]
  ds_read_b128 v[200:203], v5 offset:26624
  v_mfma_f32_16x16x32_bf16 v[184:187], v[212:215], v[80:83], v[184:187]
  s_waitcnt lgkmcnt(7)
  v_mfma_f32_16x16x32_bf16 v[188:191], v[212:215], v[84:87], v[188:191]
  ds_read_b128 v[204:207], v5 offset:27648
  v_mfma_f32_16x16x32_bf16 v[176:179], v[216:219], v[88:91], v[176:179]
  v_mfma_f32_16x16x32_bf16 v[180:183], v[216:219], v[92:95], v[180:183]
  ds_read_b128 v[208:211], v5 offset:28672
  v_mfma_f32_16x16x32_bf16 v[184:187], v[220:223], v[88:91], v[184:187]
  s_waitcnt lgkmcnt(7)
  v_mfma_f32_16x16x32_bf16 v[188:191], v[220:223], v[92:95], v[188:191]
  ds_read_b128 v[212:215], v5 offset:29696
  v_mfma_f32_16x16x32_bf16 v[176:179], v[224:227], v[96:99], v[176:179]
  v_mfma_f32_16x16x32_bf16 v[180:183], v[224:227], v[100:103], v[180:183]
  ds_read_b128 v[216:219], v5 offset:30720
  v_mfma_f32_16x16x32_bf16 v[184:187], v[228:231], v[96:99], v[184:187]
  s_waitcnt lgkmcnt(7)
  v_mfma_f32_16x16x32_bf16 v[188:191], v[228:231], v[100:103], v[188:191]
  ds_read_b128 v[220:223], v5 offset:31744
  v_mfma_f32_16x16x32_bf16 v[176:179], v[232:235], v[104:107], v[176:179]
  v_mfma_f32_16x16x32_bf16 v[180:183], v[232:235], v[108:111], v[180:183]
  ds_read_b128 v[224:227], v5 offset:32768
  v_mfma_f32_16x16x32_bf16 v[184:187], v[236:239], v[104:107], v[184:187]
  s_waitcnt lgkmcnt(7)
  v_mfma_f32_16x16x32_bf16 v[188:191], v[236:239], v[108:111], v[188:191]
  ds_read_b128 v[228:231], v5 offset:33792
  v_mfma_f32_16x16x32_bf16 v[176:179], v[192:195], v[112:115], v[176:179]
  v_mfma_f32_16x16x32_bf16 v[180:183], v[192:195], v[116:119], v[180:183]
  ds_read_b128 v[232:235], v5 offset:34816
  v_mfma_f32_16x16x32_bf16 v[184:187], v[196:199], v[112:115], v[184:187]
  s_waitcnt lgkmcnt(7)
  v_mfma_f32_16x16x32_bf16 v[188:191], v[196:199], v[116:119], v[188:191]
  ds_read_b128 v[236:239], v5 offset:35840
  s_barrier
  v_mfma_f32_16x16x32_bf16 v[176:179], v[200:203], v[120:123], v[176:179]
  s_xor_b32 s22, s22, 73728
  v_add_u32 v4, s22, v1
  v_mfma_f32_16x16x32_bf16 v[180:183], v[200:203], v[124:127], v[180:183]
  ds_read_b128 v[192:195], v4 offset:0
  v_mfma_f32_16x16x32_bf16 v[184:187], v[204:207], v[120:123], v[184:187]
  s_waitcnt lgkmcnt(7)
  v_add_u32 v5, 36864, v4
  v_mfma_f32_16x16x32_bf16 v[188:191], v[204:207], v[124:127], v[188:191]
  ds_read_b128 v[196:199], v4 offset:1024
  v_add_u32 v6, 256, v6
  v_mfma_f32_16x16x32_bf16 v[176:179], v[208:211], v[128:131], v[176:179]
  ds_read_b128 v[240:243], v6 offset:0
  v_mfma_f32_16x16x32_bf16 v[180:183], v[208:211], v[132:135], v[180:183]
  ds_read_b128 v[200:203], v4 offset:2048
  v_mfma_f32_16x16x32_bf16 v[184:187], v[212:215], v[128:131], v[184:187]
  s_waitcnt lgkmcnt(8)
  v_mfma_f32_16x16x32_bf16 v[188:191], v[212:215], v[132:135], v[188:191]
  ds_read_b128 v[204:207], v4 offset:3072
  v_mfma_f32_16x16x32_bf16 v[176:179], v[216:219], v[136:139], v[176:179]
  ds_read_b128 v[244:247], v6 offset:64
  v_mfma_f32_16x16x32_bf16 v[180:183], v[216:219], v[140:143], v[180:183]
  ds_read_b128 v[208:211], v4 offset:4096
  v_mfma_f32_16x16x32_bf16 v[184:187], v[220:223], v[136:139], v[184:187]
  s_waitcnt lgkmcnt(9)
  v_mfma_f32_16x16x32_bf16 v[188:191], v[220:223], v[140:143], v[188:191]
  ds_read_b128 v[212:215], v4 offset:5120
  v_mfma_f32_16x16x32_bf16 v[176:179], v[224:227], v[144:147], v[176:179]
  v_mfma_f32_16x16x32_bf16 v[180:183], v[224:227], v[148:151], v[180:183]
  ds_read_b128 v[216:219], v4 offset:6144
  v_mfma_f32_16x16x32_bf16 v[184:187], v[228:231], v[144:147], v[184:187]
  s_waitcnt lgkmcnt(9)
  v_mfma_f32_16x16x32_bf16 v[188:191], v[228:231], v[148:151], v[188:191]
  ds_read_b128 v[220:223], v4 offset:7168
  v_mfma_f32_16x16x32_bf16 v[176:179], v[232:235], v[152:155], v[176:179]
  v_mfma_f32_16x16x32_bf16 v[180:183], v[232:235], v[156:159], v[180:183]
  ds_read_b128 v[224:227], v4 offset:8192
  v_mfma_f32_16x16x32_bf16 v[184:187], v[236:239], v[152:155], v[184:187]
  s_waitcnt lgkmcnt(9)
  v_mfma_f32_16x16x32_bf16 v[188:191], v[236:239], v[156:159], v[188:191]
  ds_read_b128 v[228:231], v4 offset:9216
  s_mov_b32 s49, 1
FF_LOOP1:
  v_mfma_f32_16x16x32_bf16 v[160:163], v[192:195], v[16:19], 0
  v_mfma_f32_16x16x32_bf16 v[164:167], v[192:195], v[20:23], 0
  ds_read_b128 v[232:235], v4 offset:10240
  v_mfma_f32_16x16x32_bf16 v[168:171], v[196:199], v[16:19], 0
  s_waitcnt lgkmcnt(8)
  v_fmac_f32 v176, v2, v240
  v_mfma_f32_16x16x32_bf16 v[172:175], v[196:199], v[20:23], 0
  ds_read_b128 v[236:239], v4 offset:11264
  v_fmac_f32 v177, v2, v241
  v_mfma_f32_16x16x32_bf16 v[160:163], v[200:203], v[24:27], v[160:163]
  v_fmac_f32 v178, v2, v242
  v_fmac_f32 v179, v2, v243
  v_mfma_f32_16x16x32_bf16 v[164:167], v[200:203], v[28:31], v[164:167]
  ds_read_b128 v[192:195], v4 offset:12288
  s_waitcnt lgkmcnt(9)
  v_fmac_f32 v184, v2, v244
  v_mfma_f32_16x16x32_bf16 v[168:171], v[204:207], v[24:27], v[168:171]
  s_waitcnt lgkmcnt(7)
  v_fmac_f32 v185, v2, v245
  v_mfma_f32_16x16x32_bf16 v[172:175], v[204:207], v[28:31], v[172:175]
  ds_read_b128 v[196:199], v4 offset:13312
  v_fmac_f32 v186, v2, v246
  v_mfma_f32_16x16x32_bf16 v[160:163], v[208:211], v[32:35], v[160:163]
  v_fmac_f32 v187, v2, v247
  v_mul_f32 v176, v176, v184
  v_mfma_f32_16x16x32_bf16 v[164:167], v[208:211], v[36:39], v[164:167]
  ds_read_b128 v[200:203], v4 offset:14336
  v_mul_f32 v177, v177, v185
  v_mfma_f32_16x16x32_bf16 v[168:171], v[212:215], v[32:35], v[168:171]
  s_waitcnt lgkmcnt(7)
  v_mul_f32 v178, v178, v186
  v_mfma_f32_16x16x32_bf16 v[172:175], v[212:215], v[36:39], v[172:175]
  ds_read_b128 v[204:207], v4 offset:15360
  v_mul_f32 v179, v179, v187
  v_mfma_f32_16x16x32_bf16 v[160:163], v[216:219], v[40:43], v[160:163]
  v_cvt_pk_bf16_f32 v250, v176, v177
  v_cvt_pk_bf16_f32 v251, v178, v179
  v_mfma_f32_16x16x32_bf16 v[164:167], v[216:219], v[44:47], v[164:167]
  ds_read_b128 v[208:211], v4 offset:16384
  v_fmac_f32 v180, v3, v240
  v_mfma_f32_16x16x32_bf16 v[168:171], v[220:223], v[40:43], v[168:171]
  s_waitcnt lgkmcnt(7)
  v_fmac_f32 v181, v3, v241
  v_mfma_f32_16x16x32_bf16 v[172:175], v[220:223], v[44:47], v[172:175]
  ds_read_b128 v[212:215], v4 offset:17408
  v_fmac_f32 v182, v3, v242
  v_mfma_f32_16x16x32_bf16 v[160:163], v[224:227], v[48:51], v[160:163]
  v_fmac_f32 v183, v3, v243
  v_fmac_f32 v188, v3, v244
  v_mfma_f32_16x16x32_bf16 v[164:167], v[224:227], v[52:55], v[164:167]
  ds_read_b128 v[216:219], v4 offset:18432
  v_fmac_f32 v189, v3, v245
  v_mfma_f32_16x16x32_bf16 v[168:171], v[228:231], v[48:51], v[168:171]
  s_waitcnt lgkmcnt(7)
  v_fmac_f32 v190, v3, v246
  v_mfma_f32_16x16x32_bf16 v[172:175], v[228:231], v[52:55], v[172:175]
  ds_read_b128 v[220:223], v4 offset:19456
  v_fmac_f32 v191, v3, v247
  v_mfma_f32_16x16x32_bf16 v[160:163], v[232:235], v[56:59], v[160:163]
  v_mul_f32 v180, v180, v188
  v_mul_f32 v181, v181, v189
  v_mfma_f32_16x16x32_bf16 v[164:167], v[232:235], v[60:63], v[164:167]
  ds_read_b128 v[224:227], v4 offset:20480
  v_mul_f32 v182, v182, v190
  v_mfma_f32_16x16x32_bf16 v[168:171], v[236:239], v[56:59], v[168:171]
  s_waitcnt lgkmcnt(7)
  v_mul_f32 v183, v183, v191
  v_mfma_f32_16x16x32_bf16 v[172:175], v[236:239], v[60:63], v[172:175]
  ds_read_b128 v[228:231], v4 offset:21504
  v_cvt_pk_bf16_f32 v254, v180, v181
  v_mfma_f32_16x16x32_bf16 v[160:163], v[192:195], v[64:67], v[160:163]
  v_cvt_pk_bf16_f32 v255, v182, v183
  v_mfma_f32_16x16x32_bf16 v[164:167], v[192:195], v[68:71], v[164:167]
  ds_read_b128 v[232:235], v4 offset:22528
  v_mfma_f32_16x16x32_bf16 v[168:171], v[196:199], v[64:67], v[168:171]
  s_waitcnt lgkmcnt(7)
  v_mfma_f32_16x16x32_bf16 v[172:175], v[196:199], v[68:71], v[172:175]
  ds_read_b128 v[236:239], v4 offset:23552
  v_mfma_f32_16x16x32_bf16 v[160:163], v[200:203], v[72:75], v[160:163]
  v_mfma_f32_16x16x32_bf16 v[164:167], v[200:203], v[76:79], v[164:167]
  ds_read_b128 v[192:195], v4 offset:24576
  v_mfma_f32_16x16x32_bf16 v[168:171], v[204:207], v[72:75], v[168:171]
  s_waitcnt lgkmcnt(7)
  v_mfma_f32_16x16x32_bf16 v[172:175], v[204:207], v[76:79], v[172:175]
  ds_read_b128 v[196:199], v4 offset:25600
  v_mfma_f32_16x16x32_bf16 v[160:163], v[208:211], v[80:83], v[160:163]
  s_nop 0
  buffer_store_dwordx4 v[248:251], v1, s[40:43], s44 offen offset:0 sc1
  v_mfma_f32_16x16x32_bf16 v[164:167], v[208:211], v[84:87], v[164:167]
  ds_read_b128 v[200:203], v4 offset:26624
  v_mfma_f32_16x16x32_bf16 v[168:171], v[212:215], v[80:83], v[168:171]
  s_waitcnt lgkmcnt(7)
  v_mfma_f32_16x16x32_bf16 v[172:175], v[212:215], v[84:87], v[172:175]
  ds_read_b128 v[204:207], v4 offset:27648
  v_mfma_f32_16x16x32_bf16 v[160:163], v[216:219], v[88:91], v[160:163]
  s_nop 0
  buffer_store_dwordx4 v[252:255], v1, s[40:43], s44 offen offset:1024 sc1
  v_mfma_f32_16x16x32_bf16 v[164:167], v[216:219], v[92:95], v[164:167]
  ds_read_b128 v[208:211], v4 offset:28672
  s_add_u32 s44, s44, 8192
  v_mfma_f32_16x16x32_bf16 v[168:171], v[220:223], v[88:91], v[168:171]
  s_waitcnt lgkmcnt(7)
  v_mfma_f32_16x16x32_bf16 v[172:175], v[220:223], v[92:95], v[172:175]
  ds_read_b128 v[212:215], v4 offset:29696
  v_mfma_f32_16x16x32_bf16 v[160:163], v[224:227], v[96:99], v[160:163]
  v_mfma_f32_16x16x32_bf16 v[164:167], v[224:227], v[100:103], v[164:167]
  ds_read_b128 v[216:219], v4 offset:30720
  v_mfma_f32_16x16x32_bf16 v[168:171], v[228:231], v[96:99], v[168:171]
  s_waitcnt lgkmcnt(7)
  v_mfma_f32_16x16x32_bf16 v[172:175], v[228:231], v[100:103], v[172:175]
  ds_read_b128 v[220:223], v4 offset:31744
  v_mfma_f32_16x16x32_bf16 v[160:163], v[232:235], v[104:107], v[160:163]
  v_mfma_f32_16x16x32_bf16 v[164:167], v[232:235], v[108:111], v[164:167]
  ds_read_b128 v[224:227], v4 offset:32768
  v_mfma_f32_16x16x32_bf16 v[168:171], v[236:239], v[104:107], v[168:171]
  s_waitcnt lgkmcnt(7)
  v_mfma_f32_16x16x32_bf16 v[172:175], v[236:239], v[108:111], v[172:175]
  ds_read_b128 v[228:231], v4 offset:33792
  v_mfma_f32_16x16x32_bf16 v[160:163], v[192:195], v[112:115], v[160:163]
  v_mfma_f32_16x16x32_bf16 v[164:167], v[192:195], v[116:119], v[164:167]
  ds_read_b128 v[232:235], v4 offset:34816
  v_mfma_f32_16x16x32_bf16 v[168:171], v[196:199], v[112:115], v[168:171]
  s_waitcnt lgkmcnt(7)
  v_mfma_f32_16x16x32_bf16 v[172:175], v[196:199], v[116:119], v[172:175]
  ds_read_b128 v[236:239], v4 offset:35840
  s_barrier
  v_mfma_f32_16x16x32_bf16 v[160:163], v[200:203], v[120:123], v[160:163]
  v_mfma_f32_16x16x32_bf16 v[164:167], v[200:203], v[124:127], v[164:167]
  ds_read_b128 v[192:195], v5 offset:0
  v_mfma_f32_16x16x32_bf16 v[168:171], v[204:207], v[120:123], v[168:171]
  s_waitcnt lgkmcnt(7)
  v_mfma_f32_16x16x32_bf16 v[172:175], v[204:207], v[124:127], v[172:175]
  ds_read_b128 v[196:199], v5 offset:1024
  v_mfma_f32_16x16x32_bf16 v[160:163], v[208:211], v[128:131], v[160:163]
  ds_read_b128 v[240:243], v6 offset:128
  v_mfma_f32_16x16x32_bf16 v[164:167], v[208:211], v[132:135], v[164:167]
  ds_read_b128 v[200:203], v5 offset:2048
  v_mfma_f32_16x16x32_bf16 v[168:171], v[212:215], v[128:131], v[168:171]
  s_waitcnt lgkmcnt(8)
  v_mfma_f32_16x16x32_bf16 v[172:175], v[212:215], v[132:135], v[172:175]
  ds_read_b128 v[204:207], v5 offset:3072
  v_mfma_f32_16x16x32_bf16 v[160:163], v[216:219], v[136:139], v[160:163]
  ds_read_b128 v[244:247], v6 offset:192
  v_mfma_f32_16x16x32_bf16 v[164:167], v[216:219], v[140:143], v[164:167]
  ds_read_b128 v[208:211], v5 offset:4096
  v_mfma_f32_16x16x32_bf16 v[168:171], v[220:223], v[136:139], v[168:171]
  s_waitcnt lgkmcnt(9)
  v_mfma_f32_16x16x32_bf16 v[172:175], v[220:223], v[140:143], v[172:175]
  ds_read_b128 v[212:215], v5 offset:5120
  v_mfma_f32_16x16x32_bf16 v[160:163], v[224:227], v[144:147], v[160:163]
  v_mfma_f32_16x16x32_bf16 v[164:167], v[224:227], v[148:151], v[164:167]
  ds_read_b128 v[216:219], v5 offset:6144
  v_mfma_f32_16x16x32_bf16 v[168:171], v[228:231], v[144:147], v[168:171]
  s_waitcnt lgkmcnt(9)
  v_mfma_f32_16x16x32_bf16 v[172:175], v[228:231], v[148:151], v[172:175]
  ds_read_b128 v[220:223], v5 offset:7168
  v_mfma_f32_16x16x32_bf16 v[160:163], v[232:235], v[152:155], v[160:163]
  v_mfma_f32_16x16x32_bf16 v[164:167], v[232:235], v[156:159], v[164:167]
  ds_read_b128 v[224:227], v5 offset:8192
  v_mfma_f32_16x16x32_bf16 v[168:171], v[236:239], v[152:155], v[168:171]
  s_waitcnt lgkmcnt(9)
  v_mfma_f32_16x16x32_bf16 v[172:175], v[236:239], v[156:159], v[172:175]
  ds_read_b128 v[228:231], v5 offset:9216
  v_mfma_f32_16x16x32_bf16 v[176:179], v[192:195], v[16:19], 0
  v_mfma_f32_16x16x32_bf16 v[180:183], v[192:195], v[20:23], 0
  ds_read_b128 v[232:235], v5 offset:10240
  v_mfma_f32_16x16x32_bf16 v[184:187], v[196:199], v[16:19], 0
  s_waitcnt lgkmcnt(8)
  v_fmac_f32 v160, v2, v240
  v_mfma_f32_16x16x32_bf16 v[188:191], v[196:199], v[20:23], 0
  ds_read_b128 v[236:239], v5 offset:11264
  v_fmac_f32 v161, v2, v241
  v_mfma_f32_16x16x32_bf16 v[176:179], v[200:203], v[24:27], v[176:179]
  v_fmac_f32 v162, v2, v242
  v_fmac_f32 v163, v2, v243
  v_mfma_f32_16x16x32_bf16 v[180:183], v[200:203], v[28:31], v[180:183]
  ds_read_b128 v[192:195], v5 offset:12288
  s_waitcnt lgkmcnt(9)
  v_fmac_f32 v168, v2, v244
  v_mfma_f32_16x16x32_bf16 v[184:187], v[204:207], v[24:27], v[184:187]
  s_waitcnt lgkmcnt(7)
  v_fmac_f32 v169, v2, v245
  v_mfma_f32_16x16x32_bf16 v[188:191], v[204:207], v[28:31], v[188:191]
  ds_read_b128 v[196:199], v5 offset:13312
  v_fmac_f32 v170, v2, v246
  v_mfma_f32_16x16x32_bf16 v[176:179], v[208:211], v[32:35], v[176:179]
  v_fmac_f32 v171, v2, v247
  v_mul_f32 v160, v160, v168
  v_mfma_f32_16x16x32_bf16 v[180:183], v[208:211], v[36:39], v[180:183]
  ds_read_b128 v[200:203], v5 offset:14336
  v_mul_f32 v161, v161, v169
  v_mfma_f32_16x16x32_bf16 v[184:187], v[212:215], v[32:35], v[184:187]
  s_waitcnt lgkmcnt(7)
  v_mul_f32 v162, v162, v170
  v_mfma_f32_16x16x32_bf16 v[188:191], v[212:215], v[36:39], v[188:191]
  ds_read_b128 v[204:207], v5 offset:15360
  v_mul_f32 v163, v163, v171
  v_mfma_f32_16x16x32_bf16 v[176:179], v[216:219], v[40:43], v[176:179]
  v_cvt_pk_bf16_f32 v248, v160, v161
  v_cvt_pk_bf16_f32 v249, v162, v163
  v_mfma_f32_16x16x32_bf16 v[180:183], v[216:219], v[44:47], v[180:183]
  ds_read_b128 v[208:211], v5 offset:16384
  v_fmac_f32 v164, v3, v240
  v_mfma_f32_16x16x32_bf16 v[184:187], v[220:223], v[40:43], v[184:187]
  s_waitcnt lgkmcnt(7)
  v_fmac_f32 v165, v3, v241
  v_mfma_f32_16x16x32_bf16 v[188:191], v[220:223], v[44:47], v[188:191]
  ds_read_b128 v[212:215], v5 offset:17408
  v_fmac_f32 v166, v3, v242
  v_mfma_f32_16x16x32_bf16 v[176:179], v[224:227], v[48:51], v[176:179]
  v_fmac_f32 v167, v3, v243
  v_fmac_f32 v172, v3, v244
  v_mfma_f32_16x16x32_bf16 v[180:183], v[224:227], v[52:55], v[180:183]
  ds_read_b128 v[216:219], v5 offset:18432
  v_fmac_f32 v173, v3, v245
  v_mfma_f32_16x16x32_bf16 v[184:187], v[228:231], v[48:51], v[184:187]
  s_waitcnt lgkmcnt(7)
  v_fmac_f32 v174, v3, v246
  v_mfma_f32_16x16x32_bf16 v[188:191], v[228:231], v[52:55], v[188:191]
  ds_read_b128 v[220:223], v5 offset:19456
  v_fmac_f32 v175, v3, v247
  v_mfma_f32_16x16x32_bf16 v[176:179], v[232:235], v[56:59], v[176:179]
  v_mul_f32 v164, v164, v172
  v_mul_f32 v165, v165, v173
  v_mfma_f32_16x16x32_bf16 v[180:183], v[232:235], v[60:63], v[180:183]
  ds_read_b128 v[224:227], v5 offset:20480
  v_mul_f32 v166, v166, v174
  v_mfma_f32_16x16x32_bf16 v[184:187], v[236:239], v[56:59], v[184:187]
  s_waitcnt lgkmcnt(7)
  v_mul_f32 v167, v167, v175
  v_mfma_f32_16x16x32_bf16 v[188:191], v[236:239], v[60:63], v[188:191]
  ds_read_b128 v[228:231], v5 offset:21504
  v_cvt_pk_bf16_f32 v252, v164, v165
  v_mfma_f32_16x16x32_bf16 v[176:179], v[192:195], v[64:67], v[176:179]
  v_cvt_pk_bf16_f32 v253, v166, v167
  v_mfma_f32_16x16x32_bf16 v[180:183], v[192:195], v[68:71], v[180:183]
  ds_read_b128 v[232:235], v5 offset:22528
  v_mfma_f32_16x16x32_bf16 v[184:187], v[196:199], v[64:67], v[184:187]
  s_waitcnt lgkmcnt(7)
  v_mfma_f32_16x16x32_bf16 v[188:191], v[196:199], v[68:71], v[188:191]
  ds_read_b128 v[236:239], v5 offset:23552
  v_mfma_f32_16x16x32_bf16 v[176:179], v[200:203], v[72:75], v[176:179]
  v_mfma_f32_16x16x32_bf16 v[180:183], v[200:203], v[76:79], v[180:183]
  ds_read_b128 v[192:195], v5 offset:24576
  v_mfma_f32_16x16x32_bf16 v[184:187], v[204:207], v[72:75], v[184:187]
  s_waitcnt lgkmcnt(7)
  v_mfma_f32_16x16x32_bf16 v[188:191], v[204:207], v[76:79], v[188:191]
  ds_read_b128 v[196:199], v5 offset:25600
  v_mfma_f32_16x16x32_bf16 v[176:179], v[208:211], v[80:83], v[176:179]
  v_mfma_f32_16x16x32_bf16 v[180:183], v[208:211], v[84:87], v[180:183]
  ds_read_b128 v[200:203], v5 offset:26624
  v_mfma_f32_16x16x32_bf16 v[184:187], v[212:215], v[80:83], v[184:187]
  s_waitcnt lgkmcnt(7)
  v_mfma_f32_16x16x32_bf16 v[188:191], v[212:215], v[84:87], v[188:191]
  ds_read_b128 v[204:207], v5 offset:27648
  v_mfma_f32_16x16x32_bf16 v[176:179], v[216:219], v[88:91], v[176:179]
  v_mfma_f32_16x16x32_bf16 v[180:183], v[216:219], v[92:95], v[180:183]
  ds_read_b128 v[208:211], v5 offset:28672
  v_mfma_f32_16x16x32_bf16 v[184:187], v[220:223], v[88:91], v[184:187]
  s_waitcnt lgkmcnt(7)
  v_mfma_f32_16x16x32_bf16 v[188:191], v[220:223], v[92:95], v[188:191]
  ds_read_b128 v[212:215], v5 offset:29696
  v_mfma_f32_16x16x32_bf16 v[176:179], v[224:227], v[96:99], v[176:179]
  s_cmp_eq_u32 s49, 5
  s_cbranch_scc1 FF_PUB1
FF_PUB1_B:
  v_mfma_f32_16x16x32_bf16 v[180:183], v[224:227], v[100:103], v[180:183]
  ds_read_b128 v[216:219], v5 offset:30720
  v_mfma_f32_16x16x32_bf16 v[184:187], v[228:231], v[96:99], v[184:187]
  s_waitcnt lgkmcnt(7)
  v_mfma_f32_16x16x32_bf16 v[188:191], v[228:231], v[100:103], v[188:191]
  ds_read_b128 v[220:223], v5 offset:31744
  v_mfma_f32_16x16x32_bf16 v[176:179], v[232:235], v[104:107], v[176:179]
  v_mfma_f32_16x16x32_bf16 v[180:183], v[232:235], v[108:111], v[180:183]
  ds_read_b128 v[224:227], v5 offset:32768
  v_mfma_f32_16x16x32_bf16 v[184:187], v[236:239], v[104:107], v[184:187]
  s_waitcnt lgkmcnt(7)
  v_mfma_f32_16x16x32_bf16 v[188:191], v[236:239], v[108:111], v[188:191]
  ds_read_b128 v[228:231], v5 offset:33792
  v_mfma_f32_16x16x32_bf16 v[176:179], v[192:195], v[112:115], v[176:179]
  v_mfma_f32_16x16x32_bf16 v[180:183], v[192:195], v[116:119], v[180:183]
  ds_read_b128 v[232:235], v5 offset:34816
  v_mfma_f32_16x16x32_bf16 v[184:187], v[196:199], v[112:115], v[184:187]
  s_waitcnt lgkmcnt(7)
  v_mfma_f32_16x16x32_bf16 v[188:191], v[196:199], v[116:119], v[188:191]
  ds_read_b128 v[236:239], v5 offset:35840
  s_barrier
  v_mfma_f32_16x16x32_bf16 v[176:179], v[200:203], v[120:123], v[176:179]
  s_xor_b32 s22, s22, 73728
  v_add_u32 v4, s22, v1
  v_mfma_f32_16x16x32_bf16 v[180:183], v[200:203], v[124:127], v[180:183]
  ds_read_b128 v[192:195], v4 offset:0
  v_mfma_f32_16x16x32_bf16 v[184:187], v[204:207], v[120:123], v[184:187]
  s_waitcnt lgkmcnt(7)
  v_add_u32 v5, 36864, v4
  v_mfma_f32_16x16x32_bf16 v[188:191], v[204:207], v[124:127], v[188:191]
  ds_read_b128 v[196:199], v4 offset:1024
  v_add_u32 v6, 256, v6
  v_mfma_f32_16x16x32_bf16 v[176:179], v[208:211], v[128:131], v[176:179]
  ds_read_b128 v[240:243], v6 offset:0
  v_mfma_f32_16x16x32_bf16 v[180:183], v[208:211], v[132:135], v[180:183]
  ds_read_b128 v[200:203], v4 offset:2048
  v_mfma_f32_16x16x32_bf16 v[184:187], v[212:215], v[128:131], v[184:187]
  s_waitcnt lgkmcnt(8)
  v_mfma_f32_16x16x32_bf16 v[188:191], v[212:215], v[132:135], v[188:191]
  ds_read_b128 v[204:207], v4 offset:3072
  v_mfma_f32_16x16x32_bf16 v[176:179], v[216:219], v[136:139], v[176:179]
  ds_read_b128 v[244:247], v6 offset:64
  v_mfma_f32_16x16x32_bf16 v[180:183], v[216:219], v[140:143], v[180:183]
  ds_read_b128 v[208:211], v4 offset:4096
  v_mfma_f32_16x16x32_bf16 v[184:187], v[220:223], v[136:139], v[184:187]
  s_waitcnt lgkmcnt(9)
  v_mfma_f32_16x16x32_bf16 v[188:191], v[220:223], v[140:143], v[188:191]
  ds_read_b128 v[212:215], v4 offset:5120
  v_mfma_f32_16x16x32_bf16 v[176:179], v[224:227], v[144:147], v[176:179]
  v_mfma_f32_16x16x32_bf16 v[180:183], v[224:227], v[148:151], v[180:183]
  ds_read_b128 v[216:219], v4 offset:6144
  v_mfma_f32_16x16x32_bf16 v[184:187], v[228:231], v[144:147], v[184:187]
  s_waitcnt lgkmcnt(9)
  v_mfma_f32_16x16x32_bf16 v[188:191], v[228:231], v[148:151], v[188:191]
  ds_read_b128 v[220:223], v4 offset:7168
  v_mfma_f32_16x16x32_bf16 v[176:179], v[232:235], v[152:155], v[176:179]
  v_mfma_f32_16x16x32_bf16 v[180:183], v[232:235], v[156:159], v[180:183]
  ds_read_b128 v[224:227], v4 offset:8192
  v_mfma_f32_16x16x32_bf16 v[184:187], v[236:239], v[152:155], v[184:187]
  s_waitcnt lgkmcnt(9)
  v_mfma_f32_16x16x32_bf16 v[188:191], v[236:239], v[156:159], v[188:191]
  ds_read_b128 v[228:231], v4 offset:9216
  s_add_u32 s49, s49, 1
  s_cmp_le_u32 s49, 7
  s_cbranch_scc1 FF_LOOP1
  v_mfma_f32_16x16x32_bf16 v[160:163], v[192:195], v[16:19], 0
  v_mfma_f32_16x16x32_bf16 v[164:167], v[192:195], v[20:23], 0
  ds_read_b128 v[232:235], v4 offset:10240
  v_mfma_f32_16x16x32_bf16 v[168:171], v[196:199], v[16:19], 0
  s_waitcnt lgkmcnt(8)
  v_fmac_f32 v176, v2, v240
  v_mfma_f32_16x16x32_bf16 v[172:175], v[196:199], v[20:23], 0
  ds_read_b128 v[236:239], v4 offset:11264
  v_fmac_f32 v177, v2, v241
  v_mfma_f32_16x16x32_bf16 v[160:163], v[200:203], v[24:27], v[160:163]
  v_fmac_f32 v178, v2, v242
  v_fmac_f32 v179, v2, v243
  v_mfma_f32_16x16x32_bf16 v[164:167], v[200:203], v[28:31], v[164:167]
  ds_read_b128 v[192:195], v4 offset:12288
  s_waitcnt lgkmcnt(9)
  v_fmac_f32 v184, v2, v244
  v_mfma_f32_16x16x32_bf16 v[168:171], v[204:207], v[24:27], v[168:171]
  s_waitcnt lgkmcnt(7)
  v_fmac_f32 v185, v2, v245
  v_mfma_f32_16x16x32_bf16 v[172:175], v[204:207], v[28:31], v[172:175]
  ds_read_b128 v[196:199], v4 offset:13312
  v_fmac_f32 v186, v2, v246
  v_mfma_f32_16x16x32_bf16 v[160:163], v[208:211], v[32:35], v[160:163]
  v_fmac_f32 v187, v2, v247
  v_mul_f32 v176, v176, v184
  v_mfma_f32_16x16x32_bf16 v[164:167], v[208:211], v[36:39], v[164:167]
  ds_read_b128 v[200:203], v4 offset:14336
  v_mul_f32 v177, v177, v185
  v_mfma_f32_16x16x32_bf16 v[168:171], v[212:215], v[32:35], v[168:171]
  s_waitcnt lgkmcnt(7)
  v_mul_f32 v178, v178, v186
  v_mfma_f32_16x16x32_bf16 v[172:175], v[212:215], v[36:39], v[172:175]
  ds_read_b128 v[204:207], v4 offset:15360
  v_mul_f32 v179, v179, v187
  v_mfma_f32_16x16x32_bf16 v[160:163], v[216:219], v[40:43], v[160:163]
  v_cvt_pk_bf16_f32 v250, v176, v177
  v_cvt_pk_bf16_f32 v251, v178, v179
  v_mfma_f32_16x16x32_bf16 v[164:167], v[216:219], v[44:47], v[164:167]
  ds_read_b128 v[208:211], v4 offset:16384
  v_fmac_f32 v180, v3, v240
  v_mfma_f32_16x16x32_bf16 v[168:171], v[220:223], v[40:43], v[168:171]
  s_waitcnt lgkmcnt(7)
  v_fmac_f32 v181, v3, v241
  v_mfma_f32_16x16x32_bf16 v[172:175], v[220:223], v[44:47], v[172:175]
  ds_read_b128 v[212:215], v4 offset:17408
  v_fmac_f32 v182, v3, v242
  v_mfma_f32_16x16x32_bf16 v[160:163], v[224:227], v[48:51], v[160:163]
  v_fmac_f32 v183, v3, v243
  v_fmac_f32 v188, v3, v244
  v_mfma_f32_16x16x32_bf16 v[164:167], v[224:227], v[52:55], v[164:167]
  ds_read_b128 v[216:219], v4 offset:18432
  v_fmac_f32 v189, v3, v245
  v_mfma_f32_16x16x32_bf16 v[168:171], v[228:231], v[48:51], v[168:171]
  s_waitcnt lgkmcnt(7)
  v_fmac_f32 v190, v3, v246
  v_mfma_f32_16x16x32_bf16 v[172:175], v[228:231], v[52:55], v[172:175]
  ds_read_b128 v[220:223], v4 offset:19456
  v_fmac_f32 v191, v3, v247
  v_mfma_f32_16x16x32_bf16 v[160:163], v[232:235], v[56:59], v[160:163]
  v_mul_f32 v180, v180, v188
  v_mul_f32 v181, v181, v189
  v_mfma_f32_16x16x32_bf16 v[164:167], v[232:235], v[60:63], v[164:167]
  ds_read_b128 v[224:227], v4 offset:20480
  v_mul_f32 v182, v182, v190
  v_mfma_f32_16x16x32_bf16 v[168:171], v[236:239], v[56:59], v[168:171]
  s_waitcnt lgkmcnt(7)
  v_mul_f32 v183, v183, v191
  v_mfma_f32_16x16x32_bf16 v[172:175], v[236:239], v[60:63], v[172:175]
  ds_read_b128 v[228:231], v4 offset:21504
  v_cvt_pk_bf16_f32 v254, v180, v181
  v_mfma_f32_16x16x32_bf16 v[160:163], v[192:195], v[64:67], v[160:163]
  v_cvt_pk_bf16_f32 v255, v182, v183
  v_mfma_f32_16x16x32_bf16 v[164:167], v[192:195], v[68:71], v[164:167]
  ds_read_b128 v[232:235], v4 offset:22528
  v_mfma_f32_16x16x32_bf16 v[168:171], v[196:199], v[64:67], v[168:171]
  s_waitcnt lgkmcnt(7)
  v_mfma_f32_16x16x32_bf16 v[172:175], v[196:199], v[68:71], v[172:175]
  ds_read_b128 v[236:239], v4 offset:23552
  v_mfma_f32_16x16x32_bf16 v[160:163], v[200:203], v[72:75], v[160:163]
  v_mfma_f32_16x16x32_bf16 v[164:167], v[200:203], v[76:79], v[164:167]
  ds_read_b128 v[192:195], v4 offset:24576
  v_mfma_f32_16x16x32_bf16 v[168:171], v[204:207], v[72:75], v[168:171]
  s_waitcnt lgkmcnt(7)
  v_mfma_f32_16x16x32_bf16 v[172:175], v[204:207], v[76:79], v[172:175]
  ds_read_b128 v[196:199], v4 offset:25600
  v_mfma_f32_16x16x32_bf16 v[160:163], v[208:211], v[80:83], v[160:163]
  s_nop 0
  buffer_store_dwordx4 v[248:251], v1, s[40:43], s44 offen offset:0 sc1
  v_mfma_f32_16x16x32_bf16 v[164:167], v[208:211], v[84:87], v[164:167]
  ds_read_b128 v[200:203], v4 offset:26624
  v_mfma_f32_16x16x32_bf16 v[168:171], v[212:215], v[80:83], v[168:171]
  s_waitcnt lgkmcnt(7)
  v_mfma_f32_16x16x32_bf16 v[172:175], v[212:215], v[84:87], v[172:175]
  ds_read_b128 v[204:207], v4 offset:27648
  v_mfma_f32_16x16x32_bf16 v[160:163], v[216:219], v[88:91], v[160:163]
  s_nop 0
  buffer_store_dwordx4 v[252:255], v1, s[40:43], s44 offen offset:1024 sc1
  v_mfma_f32_16x16x32_bf16 v[164:167], v[216:219], v[92:95], v[164:167]
  ds_read_b128 v[208:211], v4 offset:28672
  s_add_u32 s44, s44, 8192
  v_mfma_f32_16x16x32_bf16 v[168:171], v[220:223], v[88:91], v[168:171]
  s_waitcnt lgkmcnt(7)
  v_mfma_f32_16x16x32_bf16 v[172:175], v[220:223], v[92:95], v[172:175]
  ds_read_b128 v[212:215], v4 offset:29696
  v_mfma_f32_16x16x32_bf16 v[160:163], v[224:227], v[96:99], v[160:163]
  v_mfma_f32_16x16x32_bf16 v[164:167], v[224:227], v[100:103], v[164:167]
  ds_read_b128 v[216:219], v4 offset:30720
  v_mfma_f32_16x16x32_bf16 v[168:171], v[228:231], v[96:99], v[168:171]
  s_waitcnt lgkmcnt(7)
  v_mfma_f32_16x16x32_bf16 v[172:175], v[228:231], v[100:103], v[172:175]
  ds_read_b128 v[220:223], v4 offset:31744
  v_mfma_f32_16x16x32_bf16 v[160:163], v[232:235], v[104:107], v[160:163]
  v_mfma_f32_16x16x32_bf16 v[164:167], v[232:235], v[108:111], v[164:167]
  ds_read_b128 v[224:227], v4 offset:32768
  v_mfma_f32_16x16x32_bf16 v[168:171], v[236:239], v[104:107], v[168:171]
  s_waitcnt lgkmcnt(7)
  v_mfma_f32_16x16x32_bf16 v[172:175], v[236:239], v[108:111], v[172:175]
  ds_read_b128 v[228:231], v4 offset:33792
  v_mfma_f32_16x16x32_bf16 v[160:163], v[192:195], v[112:115], v[160:163]
  v_mfma_f32_16x16x32_bf16 v[164:167], v[192:195], v[116:119], v[164:167]
  ds_read_b128 v[232:235], v4 offset:34816
  v_mfma_f32_16x16x32_bf16 v[168:171], v[196:199], v[112:115], v[168:171]
  s_waitcnt lgkmcnt(7)
  v_mfma_f32_16x16x32_bf16 v[172:175], v[196:199], v[116:119], v[172:175]
  ds_read_b128 v[236:239], v4 offset:35840
  s_barrier
  v_mfma_f32_16x16x32_bf16 v[160:163], v[200:203], v[120:123], v[160:163]
  v_mfma_f32_16x16x32_bf16 v[164:167], v[200:203], v[124:127], v[164:167]
  ds_read_b128 v[192:195], v5 offset:0
  v_mfma_f32_16x16x32_bf16 v[168:171], v[204:207], v[120:123], v[168:171]
  s_waitcnt lgkmcnt(7)
  v_mfma_f32_16x16x32_bf16 v[172:175], v[204:207], v[124:127], v[172:175]
  ds_read_b128 v[196:199], v5 offset:1024
  v_mfma_f32_16x16x32_bf16 v[160:163], v[208:211], v[128:131], v[160:163]
  ds_read_b128 v[240:243], v6 offset:128
  v_mfma_f32_16x16x32_bf16 v[164:167], v[208:211], v[132:135], v[164:167]
  ds_read_b128 v[200:203], v5 offset:2048
  v_mfma_f32_16x16x32_bf16 v[168:171], v[212:215], v[128:131], v[168:171]
  s_waitcnt lgkmcnt(8)
  v_mfma_f32_16x16x32_bf16 v[172:175], v[212:215], v[132:135], v[172:175]
  ds_read_b128 v[204:207], v5 offset:3072
  v_mfma_f32_16x16x32_bf16 v[160:163], v[216:219], v[136:139], v[160:163]
  ds_read_b128 v[244:247], v6 offset:192
  v_mfma_f32_16x16x32_bf16 v[164:167], v[216:219], v[140:143], v[164:167]
  ds_read_b128 v[208:211], v5 offset:4096
  v_mfma_f32_16x16x32_bf16 v[168:171], v[220:223], v[136:139], v[168:171]
  s_waitcnt lgkmcnt(9)
  v_mfma_f32_16x16x32_bf16 v[172:175], v[220:223], v[140:143], v[172:175]
  ds_read_b128 v[212:215], v5 offset:5120
  v_mfma_f32_16x16x32_bf16 v[160:163], v[224:227], v[144:147], v[160:163]
  v_mfma_f32_16x16x32_bf16 v[164:167], v[224:227], v[148:151], v[164:167]
  ds_read_b128 v[216:219], v5 offset:6144
  v_mfma_f32_16x16x32_bf16 v[168:171], v[228:231], v[144:147], v[168:171]
  s_waitcnt lgkmcnt(9)
  v_mfma_f32_16x16x32_bf16 v[172:175], v[228:231], v[148:151], v[172:175]
  ds_read_b128 v[220:223], v5 offset:7168
  v_mfma_f32_16x16x32_bf16 v[160:163], v[232:235], v[152:155], v[160:163]
  v_mfma_f32_16x16x32_bf16 v[164:167], v[232:235], v[156:159], v[164:167]
  ds_read_b128 v[224:227], v5 offset:8192
  v_mfma_f32_16x16x32_bf16 v[168:171], v[236:239], v[152:155], v[168:171]
  s_waitcnt lgkmcnt(9)
  v_mfma_f32_16x16x32_bf16 v[172:175], v[236:239], v[156:159], v[172:175]
  ds_read_b128 v[228:231], v5 offset:9216
  v_mfma_f32_16x16x32_bf16 v[176:179], v[192:195], v[16:19], 0
  v_mfma_f32_16x16x32_bf16 v[180:183], v[192:195], v[20:23], 0
  ds_read_b128 v[232:235], v5 offset:10240
  v_mfma_f32_16x16x32_bf16 v[184:187], v[196:199], v[16:19], 0
  s_waitcnt lgkmcnt(8)
  v_fmac_f32 v160, v2, v240
  v_mfma_f32_16x16x32_bf16 v[188:191], v[196:199], v[20:23], 0
  ds_read_b128 v[236:239], v5 offset:11264
  v_fmac_f32 v161, v2, v241
  v_mfma_f32_16x16x32_bf16 v[176:179], v[200:203], v[24:27], v[176:179]
  v_fmac_f32 v162, v2, v242
  v_fmac_f32 v163, v2, v243
  v_mfma_f32_16x16x32_bf16 v[180:183], v[200:203], v[28:31], v[180:183]
  ds_read_b128 v[192:195], v5 offset:12288
  s_waitcnt lgkmcnt(9)
  v_fmac_f32 v168, v2, v244
  v_mfma_f32_16x16x32_bf16 v[184:187], v[204:207], v[24:27], v[184:187]
  s_waitcnt lgkmcnt(7)
  v_fmac_f32 v169, v2, v245
  v_mfma_f32_16x16x32_bf16 v[188:191], v[204:207], v[28:31], v[188:191]
  ds_read_b128 v[196:199], v5 offset:13312
  v_fmac_f32 v170, v2, v246
  v_mfma_f32_16x16x32_bf16 v[176:179], v[208:211], v[32:35], v[176:179]
  v_fmac_f32 v171, v2, v247
  v_mul_f32 v160, v160, v168
  v_mfma_f32_16x16x32_bf16 v[180:183], v[208:211], v[36:39], v[180:183]
  ds_read_b128 v[200:203], v5 offset:14336
  v_mul_f32 v161, v161, v169
  v_mfma_f32_16x16x32_bf16 v[184:187], v[212:215], v[32:35], v[184:187]
  s_waitcnt lgkmcnt(7)
  v_mul_f32 v162, v162, v170
  v_mfma_f32_16x16x32_bf16 v[188:191], v[212:215], v[36:39], v[188:191]
  ds_read_b128 v[204:207], v5 offset:15360
  v_mul_f32 v163, v163, v171
  v_mfma_f32_16x16x32_bf16 v[176:179], v[216:219], v[40:43], v[176:179]
  v_cvt_pk_bf16_f32 v248, v160, v161
  v_cvt_pk_bf16_f32 v249, v162, v163
  v_mfma_f32_16x16x32_bf16 v[180:183], v[216:219], v[44:47], v[180:183]
  ds_read_b128 v[208:211], v5 offset:16384
  v_fmac_f32 v164, v3, v240
  v_mfma_f32_16x16x32_bf16 v[184:187], v[220:223], v[40:43], v[184:187]
  s_waitcnt lgkmcnt(7)
  v_fmac_f32 v165, v3, v241
  v_mfma_f32_16x16x32_bf16 v[188:191], v[220:223], v[44:47], v[188:191]
  ds_read_b128 v[212:215], v5 offset:17408
  v_fmac_f32 v166, v3, v242
  v_mfma_f32_16x16x32_bf16 v[176:179], v[224:227], v[48:51], v[176:179]
  v_fmac_f32 v167, v3, v243
  v_fmac_f32 v172, v3, v244
  v_mfma_f32_16x16x32_bf16 v[180:183], v[224:227], v[52:55], v[180:183]
  ds_read_b128 v[216:219], v5 offset:18432
  v_fmac_f32 v173, v3, v245
  v_mfma_f32_16x16x32_bf16 v[184:187], v[228:231], v[48:51], v[184:187]
  s_waitcnt lgkmcnt(7)
  v_fmac_f32 v174, v3, v246
  v_mfma_f32_16x16x32_bf16 v[188:191], v[228:231], v[52:55], v[188:191]
  ds_read_b128 v[220:223], v5 offset:19456
  v_fmac_f32 v175, v3, v247
  v_mfma_f32_16x16x32_bf16 v[176:179], v[232:235], v[56:59], v[176:179]
  v_mul_f32 v164, v164, v172
  v_mul_f32 v165, v165, v173
  v_mfma_f32_16x16x32_bf16 v[180:183], v[232:235], v[60:63], v[180:183]
  ds_read_b128 v[224:227], v5 offset:20480
  v_mul_f32 v166, v166, v174
  v_mfma_f32_16x16x32_bf16 v[184:187], v[236:239], v[56:59], v[184:187]
  s_waitcnt lgkmcnt(7)
  v_mul_f32 v167, v167, v175
  v_mfma_f32_16x16x32_bf16 v[188:191], v[236:239], v[60:63], v[188:191]
  ds_read_b128 v[228:231], v5 offset:21504
  v_cvt_pk_bf16_f32 v252, v164, v165
  v_mfma_f32_16x16x32_bf16 v[176:179], v[192:195], v[64:67], v[176:179]
  v_cvt_pk_bf16_f32 v253, v166, v167
  v_mfma_f32_16x16x32_bf16 v[180:183], v[192:195], v[68:71], v[180:183]
  ds_read_b128 v[232:235], v5 offset:22528
  v_mfma_f32_16x16x32_bf16 v[184:187], v[196:199], v[64:67], v[184:187]
  s_waitcnt lgkmcnt(7)
  v_mfma_f32_16x16x32_bf16 v[188:191], v[196:199], v[68:71], v[188:191]
  ds_read_b128 v[236:239], v5 offset:23552
  v_mfma_f32_16x16x32_bf16 v[176:179], v[200:203], v[72:75], v[176:179]
  v_mfma_f32_16x16x32_bf16 v[180:183], v[200:203], v[76:79], v[180:183]
  ds_read_b128 v[192:195], v5 offset:24576
  v_mfma_f32_16x16x32_bf16 v[184:187], v[204:207], v[72:75], v[184:187]
  s_waitcnt lgkmcnt(7)
  v_mfma_f32_16x16x32_bf16 v[188:191], v[204:207], v[76:79], v[188:191]
  ds_read_b128 v[196:199], v5 offset:25600
  v_mfma_f32_16x16x32_bf16 v[176:179], v[208:211], v[80:83], v[176:179]
  v_mfma_f32_16x16x32_bf16 v[180:183], v[208:211], v[84:87], v[180:183]
  ds_read_b128 v[200:203], v5 offset:26624
  v_mfma_f32_16x16x32_bf16 v[184:187], v[212:215], v[80:83], v[184:187]
  s_waitcnt lgkmcnt(7)
  v_mfma_f32_16x16x32_bf16 v[188:191], v[212:215], v[84:87], v[188:191]
  ds_read_b128 v[204:207], v5 offset:27648
  v_mfma_f32_16x16x32_bf16 v[176:179], v[216:219], v[88:91], v[176:179]
  v_mfma_f32_16x16x32_bf16 v[180:183], v[216:219], v[92:95], v[180:183]
  ds_read_b128 v[208:211], v5 offset:28672
  v_mfma_f32_16x16x32_bf16 v[184:187], v[220:223], v[88:91], v[184:187]
  s_waitcnt lgkmcnt(7)
  v_mfma_f32_16x16x32_bf16 v[188:191], v[220:223], v[92:95], v[188:191]
  ds_read_b128 v[212:215], v5 offset:29696
  v_mfma_f32_16x16x32_bf16 v[176:179], v[224:227], v[96:99], v[176:179]
  s_waitcnt vmcnt(2)
  s_mov_b64 exec, 1
  v_mov_b32 v13, 0x100
  buffer_atomic_add v13, off, s[60:63], s56 sc1
  s_mov_b64 exec, -1
  v_mfma_f32_16x16x32_bf16 v[180:183], v[224:227], v[100:103], v[180:183]
  ds_read_b128 v[216:219], v5 offset:30720
  v_mfma_f32_16x16x32_bf16 v[184:187], v[228:231], v[96:99], v[184:187]
  s_waitcnt lgkmcnt(7)
  v_mfma_f32_16x16x32_bf16 v[188:191], v[228:231], v[100:103], v[188:191]
  ds_read_b128 v[220:223], v5 offset:31744
  v_mfma_f32_16x16x32_bf16 v[176:179], v[232:235], v[104:107], v[176:179]
  v_mfma_f32_16x16x32_bf16 v[180:183], v[232:235], v[108:111], v[180:183]
  ds_read_b128 v[224:227], v5 offset:32768
  v_mfma_f32_16x16x32_bf16 v[184:187], v[236:239], v[104:107], v[184:187]
  s_waitcnt lgkmcnt(7)
  v_mfma_f32_16x16x32_bf16 v[188:191], v[236:239], v[108:111], v[188:191]
  ds_read_b128 v[228:231], v5 offset:33792
  v_mfma_f32_16x16x32_bf16 v[176:179], v[192:195], v[112:115], v[176:179]
  v_mfma_f32_16x16x32_bf16 v[180:183], v[192:195], v[116:119], v[180:183]
  ds_read_b128 v[232:235], v5 offset:34816
  v_mfma_f32_16x16x32_bf16 v[184:187], v[196:199], v[112:115], v[184:187]
  s_waitcnt lgkmcnt(7)
  v_mfma_f32_16x16x32_bf16 v[188:191], v[196:199], v[116:119], v[188:191]
  ds_read_b128 v[236:239], v5 offset:35840
  s_barrier
  v_mfma_f32_16x16x32_bf16 v[176:179], v[200:203], v[120:123], v[176:179]
  s_xor_b32 s22, s22, 73728
  v_add_u32 v4, s22, v1
  v_add_u32 v7, s23, v4
  v_mfma_f32_16x16x32_bf16 v[180:183], v[200:203], v[124:127], v[180:183]
  ds_read_b128 v[192:195], v4 offset:0
  v_mfma_f32_16x16x32_bf16 v[184:187], v[204:207], v[120:123], v[184:187]
  s_waitcnt lgkmcnt(7)
  v_add_u32 v5, 36864, v4
  v_mfma_f32_16x16x32_bf16 v[188:191], v[204:207], v[124:127], v[188:191]
  ds_read_b128 v[196:199], v4 offset:1024
  v_add_u32 v6, 256, v6
  v_mfma_f32_16x16x32_bf16 v[176:179], v[208:211], v[128:131], v[176:179]
  ds_read_b128 v[240:243], v6 offset:0
  v_mfma_f32_16x16x32_bf16 v[180:183], v[208:211], v[132:135], v[180:183]
  ds_read_b128 v[88:91], v7 offset:0
  v_mfma_f32_16x16x32_bf16 v[184:187], v[212:215], v[128:131], v[184:187]
  s_waitcnt lgkmcnt(8)
  v_mfma_f32_16x16x32_bf16 v[188:191], v[212:215], v[132:135], v[188:191]
  ds_read_b128 v[200:203], v4 offset:2048
  v_mfma_f32_16x16x32_bf16 v[176:179], v[216:219], v[136:139], v[176:179]
  ds_read_b128 v[244:247], v6 offset:64
  v_mfma_f32_16x16x32_bf16 v[180:183], v[216:219], v[140:143], v[180:183]
  ds_read_b128 v[92:95], v7 offset:1024
  v_mfma_f32_16x16x32_bf16 v[184:187], v[220:223], v[136:139], v[184:187]
  s_waitcnt lgkmcnt(9)
  v_mfma_f32_16x16x32_bf16 v[188:191], v[220:223], v[140:143], v[188:191]
  ds_read_b128 v[204:207], v4 offset:3072
  v_mfma_f32_16x16x32_bf16 v[176:179], v[224:227], v[144:147], v[176:179]
  ds_read_b128 v[96:99], v7 offset:2048
  v_mfma_f32_16x16x32_bf16 v[180:183], v[224:227], v[148:151], v[180:183]
  ds_read_b128 v[208:211], v4 offset:4096
  v_mfma_f32_16x16x32_bf16 v[184:187], v[228:231], v[144:147], v[184:187]
  s_waitcnt lgkmcnt(10)
  v_mfma_f32_16x16x32_bf16 v[188:191], v[228:231], v[148:151], v[188:191]
  ds_read_b128 v[212:215], v4 offset:5120
  v_mfma_f32_16x16x32_bf16 v[176:179], v[232:235], v[152:155], v[176:179]
  ds_read_b128 v[100:103], v7 offset:3072
  v_mfma_f32_16x16x32_bf16 v[180:183], v[232:235], v[156:159], v[180:183]
  ds_read_b128 v[216:219], v4 offset:6144
  v_mfma_f32_16x16x32_bf16 v[184:187], v[236:239], v[152:155], v[184:187]
  s_waitcnt lgkmcnt(11)
  v_mfma_f32_16x16x32_bf16 v[188:191], v[236:239], v[156:159], v[188:191]
  ds_read_b128 v[220:223], v4 offset:7168
  s_barrier
  s_add_u32 s34, s31, 18432
  buffer_load_dwordx2 v[160:161], v12, s[36:39], s31 offen offset:0 sc0 sc1
  buffer_load_dwordx2 v[162:163], v12, s[36:39], s34 offen offset:0 sc0 sc1
  buffer_load_dwordx2 v[164:165], v12, s[36:39], s31 offen offset:512 sc0 sc1
  buffer_load_dwordx2 v[166:167], v12, s[36:39], s34 offen offset:512 sc0 sc1
  buffer_load_dwordx2 v[168:169], v12, s[36:39], s31 offen offset:1024 sc0 sc1
  buffer_load_dwordx2 v[170:171], v12, s[36:39], s34 offen offset:1024 sc0 sc1
  v_mov_b32 v121, 163832
  s_waitcnt lgkmcnt(10)
  v_mfma_f32_16x16x32_bf16 v[16:19], v[192:195], v[88:91], 0
  ds_read_b128 v[224:227], v4 offset:8192
  s_waitcnt lgkmcnt(8)
  v_mfma_f32_16x16x32_bf16 v[20:23], v[192:195], v[92:95], 0
  ds_read_b128 v[228:231], v4 offset:9216
  v_mfma_f32_16x16x32_bf16 v[24:27], v[196:199], v[88:91], 0
  ds_read_b128 v[232:235], v4 offset:10240
  v_fmac_f32 v176, v2, v240
  v_mfma_f32_16x16x32_bf16 v[28:31], v[196:199], v[92:95], 0
  ds_read_b128 v[236:239], v4 offset:11264
  v_fmac_f32 v177, v2, v241
  v_mfma_f32_16x16x32_bf16 v[32:35], v[200:203], v[88:91], 0
  ds_read_b128 v[192:195], v4 offset:12288
  v_fmac_f32 v178, v2, v242
  v_mfma_f32_16x16x32_bf16 v[36:39], v[200:203], v[92:95], 0
  ds_read_b128 v[196:199], v4 offset:13312
  v_fmac_f32 v179, v2, v243
  s_waitcnt lgkmcnt(12)
  v_mfma_f32_16x16x32_bf16 v[40:43], v[204:207], v[88:91], 0
  s_waitcnt lgkmcnt(9)
  v_fmac_f32 v184, v2, v244
  v_mfma_f32_16x16x32_bf16 v[44:47], v[204:207], v[92:95], 0
  ds_read_b128 v[200:203], v4 offset:14336
  v_fmac_f32 v185, v2, v245
  v_mfma_f32_16x16x32_bf16 v[48:51], v[208:211], v[88:91], 0
  v_fmac_f32 v186, v2, v246
  v_fmac_f32 v187, v2, v247
  v_mfma_f32_16x16x32_bf16 v[52:55], v[208:211], v[92:95], 0
  ds_read_b128 v[204:207], v4 offset:15360
  v_mul_f32 v176, v176, v184
  v_mfma_f32_16x16x32_bf16 v[56:59], v[212:215], v[88:91], 0
  s_waitcnt lgkmcnt(8)
  v_mul_f32 v177, v177, v185
  v_mfma_f32_16x16x32_bf16 v[60:63], v[212:215], v[92:95], 0
  ds_read_b128 v[208:211], v4 offset:16384
  v_mul_f32 v178, v178, v186
  v_mfma_f32_16x16x32_bf16 v[64:67], v[216:219], v[88:91], 0
  v_mul_f32 v179, v179, v187
  v_cvt_pk_bf16_f32 v250, v176, v177
  v_mfma_f32_16x16x32_bf16 v[68:71], v[216:219], v[92:95], 0
  ds_read_b128 v[212:215], v4 offset:17408
  v_cvt_pk_bf16_f32 v251, v178, v179
  v_mfma_f32_16x16x32_bf16 v[72:75], v[220:223], v[88:91], 0
  s_waitcnt lgkmcnt(8)
  v_fmac_f32 v180, v3, v240
  v_mfma_f32_16x16x32_bf16 v[76:79], v[220:223], v[92:95], 0
  v_fmac_f32 v181, v3, v241
  v_fmac_f32 v182, v3, v242
  v_mfma_f32_16x16x32_bf16 v[80:83], v[224:227], v[88:91], 0
  v_fmac_f32 v183, v3, v243
  v_fmac_f32 v188, v3, v244
  v_mfma_f32_16x16x32_bf16 v[84:87], v[224:227], v[92:95], 0
  v_fmac_f32 v189, v3, v245
  v_fmac_f32 v190, v3, v246
  v_mfma_f32_16x16x32_bf16 v[16:19], v[228:231], v[96:99], v[16:19]
  s_waitcnt lgkmcnt(6)
  v_fmac_f32 v191, v3, v247
  v_mfma_f32_16x16x32_bf16 v[20:23], v[228:231], v[100:103], v[20:23]
  v_mul_f32 v180, v180, v188
  v_mul_f32 v181, v181, v189
  v_mfma_f32_16x16x32_bf16 v[24:27], v[232:235], v[96:99], v[24:27]
  v_mul_f32 v182, v182, v190
  v_mul_f32 v183, v183, v191
  v_mfma_f32_16x16x32_bf16 v[28:31], v[232:235], v[100:103], v[28:31]
  v_add_u32 v5, 36864, v4
  v_cvt_pk_bf16_f32 v254, v180, v181
  v_mfma_f32_16x16x32_bf16 v[32:35], v[236:239], v[96:99], v[32:35]
  v_cvt_pk_bf16_f32 v255, v182, v183
  v_mfma_f32_16x16x32_bf16 v[36:39], v[236:239], v[100:103], v[36:39]
  v_add_u32 v8, 36864, v7
  s_waitcnt lgkmcnt(0)
  s_barrier
  v_mfma_f32_16x16x32_bf16 v[40:43], v[192:195], v[96:99], v[40:43]
  ds_read_b128 v[216:219], v5 offset:0
  v_mfma_f32_16x16x32_bf16 v[44:47], v[192:195], v[100:103], v[44:47]
  ds_read_b128 v[220:223], v5 offset:1024
  v_mfma_f32_16x16x32_bf16 v[48:51], v[196:199], v[96:99], v[48:51]
  ds_read_b128 v[104:107], v8 offset:0
  v_mfma_f32_16x16x32_bf16 v[52:55], v[196:199], v[100:103], v[52:55]
  ds_read_b128 v[224:227], v5 offset:2048
  v_mfma_f32_16x16x32_bf16 v[56:59], v[200:203], v[96:99], v[56:59]
  ds_read_b128 v[108:111], v8 offset:1024
  v_mfma_f32_16x16x32_bf16 v[60:63], v[200:203], v[100:103], v[60:63]
  ds_read_b128 v[228:231], v5 offset:3072
  v_mfma_f32_16x16x32_bf16 v[64:67], v[204:207], v[96:99], v[64:67]
  ds_read_b128 v[232:235], v5 offset:4096
  v_mfma_f32_16x16x32_bf16 v[68:71], v[204:207], v[100:103], v[68:71]
  ds_read_b128 v[236:239], v5 offset:5120
  v_mfma_f32_16x16x32_bf16 v[72:75], v[208:211], v[96:99], v[72:75]
  ds_read_b128 v[112:115], v8 offset:2048
  v_mfma_f32_16x16x32_bf16 v[76:79], v[208:211], v[100:103], v[76:79]
  ds_read_b128 v[192:195], v5 offset:6144
  v_mfma_f32_16x16x32_bf16 v[80:83], v[212:215], v[96:99], v[80:83]
  ds_read_b128 v[116:119], v8 offset:3072
  v_mfma_f32_16x16x32_bf16 v[84:87], v[212:215], v[100:103], v[84:87]
  ds_read_b128 v[196:199], v5 offset:7168
  s_nop 0
  buffer_store_dwordx4 v[248:251], v1, s[40:43], s44 offen offset:0 sc1
  s_nop 0
  buffer_store_dwordx4 v[252:255], v1, s[40:43], s44 offen offset:1024 sc1
  s_waitcnt lgkmcnt(9)
  v_mfma_f32_16x16x32_bf16 v[16:19], v[216:219], v[104:107], v[16:19]
  ds_read_b128 v[200:203], v5 offset:8192
  v_mov_b32 v13, v14
  s_waitcnt lgkmcnt(8)
  v_mfma_f32_16x16x32_bf16 v[20:23], v[216:219], v[108:111], v[20:23]
  ds_read_b128 v[204:207], v5 offset:9216
  s_nop 1
  v_mfma_f32_16x16x32_bf16 v[24:27], v[220:223], v[104:107], v[24:27]
  ds_read_b128 v[208:211], v5 offset:10240
  v_permlane16_swap_b32 v14, v13
  v_mfma_f32_16x16x32_bf16 v[28:31], v[220:223], v[108:111], v[28:31]
  ds_read_b128 v[212:215], v5 offset:11264
  v_add_f32 v14, v14, v13
  v_mfma_f32_16x16x32_bf16 v[32:35], v[224:227], v[104:107], v[32:35]
  ds_read_b128 v[216:219], v5 offset:12288
  v_mov_b32 v13, v14
  v_mfma_f32_16x16x32_bf16 v[36:39], v[224:227], v[108:111], v[36:39]
  ds_read_b128 v[220:223], v5 offset:13312
  s_nop 1
  s_waitcnt lgkmcnt(12)
  v_mfma_f32_16x16x32_bf16 v[40:43], v[228:231], v[104:107], v[40:43]
  s_waitcnt lgkmcnt(10)
  v_permlane32_swap_b32 v14, v13
  v_mfma_f32_16x16x32_bf16 v[44:47], v[228:231], v[108:111], v[44:47]
  ds_read_b128 v[224:227], v5 offset:14336
  v_add_f32 v14, v14, v13
  v_mfma_f32_16x16x32_bf16 v[48:51], v[232:235], v[104:107], v[48:51]
  v_mul_f32 v14, 0x3ae38e39, v14
  v_fma_f32 v14, -v2, v2, v14
  v_mfma_f32_16x16x32_bf16 v[52:55], v[232:235], v[108:111], v[52:55]
  ds_read_b128 v[228:231], v5 offset:15360
  v_max_f32 v14, 0, v14
  v_mfma_f32_16x16x32_bf16 v[56:59], v[236:239], v[104:107], v[56:59]
  s_waitcnt lgkmcnt(8)
  v_add_f32 v14, 0x3727c5ac, v14
  v_mfma_f32_16x16x32_bf16 v[60:63], v[236:239], v[108:111], v[60:63]
  ds_read_b128 v[232:235], v5 offset:16384
  v_rcp_f32 v14, v14
  v_mfma_f32_16x16x32_bf16 v[64:67], v[192:195], v[104:107], v[64:67]
  v_mov_b32 v13, v15
  s_nop 1
  v_mfma_f32_16x16x32_bf16 v[68:71], v[192:195], v[108:111], v[68:71]
  ds_read_b128 v[236:239], v5 offset:17408
  v_permlane16_swap_b32 v15, v13
  v_mfma_f32_16x16x32_bf16 v[72:75], v[196:199], v[104:107], v[72:75]
  s_waitcnt lgkmcnt(8)
  v_add_f32 v15, v15, v13
  v_mfma_f32_16x16x32_bf16 v[76:79], v[196:199], v[108:111], v[76:79]
  v_mov_b32 v13, v15
  s_nop 1
  v_mfma_f32_16x16x32_bf16 v[80:83], v[200:203], v[104:107], v[80:83]
  v_permlane32_swap_b32 v15, v13
  v_add_f32 v15, v15, v13
  v_mfma_f32_16x16x32_bf16 v[84:87], v[200:203], v[108:111], v[84:87]
  v_mul_f32 v15, 0x3ae38e39, v15
  v_fma_f32 v15, -v3, v3, v15
  v_mfma_f32_16x16x32_bf16 v[16:19], v[204:207], v[112:115], v[16:19]
  s_waitcnt lgkmcnt(6)
  v_max_f32 v15, 0, v15
  v_mfma_f32_16x16x32_bf16 v[20:23], v[204:207], v[116:119], v[20:23]
  s_xor_b32 s22, s22, 73728
  v_add_f32 v15, 0x3727c5ac, v15
  v_rcp_f32 v15, v15
  v_mfma_f32_16x16x32_bf16 v[24:27], v[208:211], v[112:115], v[24:27]
  v_mfma_f32_16x16x32_bf16 v[28:31], v[208:211], v[116:119], v[28:31]
  v_add_u32 v4, s22, v1
  v_mfma_f32_16x16x32_bf16 v[32:35], v[212:215], v[112:115], v[32:35]
  v_mfma_f32_16x16x32_bf16 v[36:39], v[212:215], v[116:119], v[36:39]
  v_add_u32 v7, s23, v4
  s_waitcnt lgkmcnt(0)
  s_barrier
  v_mfma_f32_16x16x32_bf16 v[40:43], v[216:219], v[112:115], v[40:43]
  ds_read_b128 v[192:195], v4 offset:0
  v_mfma_f32_16x16x32_bf16 v[44:47], v[216:219], v[116:119], v[44:47]
  ds_read_b128 v[196:199], v4 offset:1024
  v_mfma_f32_16x16x32_bf16 v[48:51], v[220:223], v[112:115], v[48:51]
  ds_read_b128 v[88:91], v7 offset:0
  v_mfma_f32_16x16x32_bf16 v[52:55], v[220:223], v[116:119], v[52:55]
  ds_read_b128 v[200:203], v4 offset:2048
  v_mfma_f32_16x16x32_bf16 v[56:59], v[224:227], v[112:115], v[56:59]
  ds_read_b128 v[92:95], v7 offset:1024
  v_mfma_f32_16x16x32_bf16 v[60:63], v[224:227], v[116:119], v[60:63]
  ds_read_b128 v[204:207], v4 offset:3072
  v_mfma_f32_16x16x32_bf16 v[64:67], v[228:231], v[112:115], v[64:67]
  ds_read_b128 v[208:211], v4 offset:4096
  v_mfma_f32_16x16x32_bf16 v[68:71], v[228:231], v[116:119], v[68:71]
  ds_read_b128 v[212:215], v4 offset:5120
  v_mfma_f32_16x16x32_bf16 v[72:75], v[232:235], v[112:115], v[72:75]
  ds_read_b128 v[96:99], v7 offset:2048
  v_mfma_f32_16x16x32_bf16 v[76:79], v[232:235], v[116:119], v[76:79]
  ds_read_b128 v[216:219], v4 offset:6144
  v_mfma_f32_16x16x32_bf16 v[80:83], v[236:239], v[112:115], v[80:83]
  ds_read_b128 v[100:103], v7 offset:3072
  v_mfma_f32_16x16x32_bf16 v[84:87], v[236:239], v[116:119], v[84:87]
  ds_read_b128 v[220:223], v4 offset:7168
  s_mov_b32 s49, 1
FF_LOOP2:
  s_waitcnt lgkmcnt(9)
  v_mfma_f32_16x16x32_bf16 v[16:19], v[192:195], v[88:91], v[16:19]
  ds_read_b128 v[224:227], v4 offset:8192
  s_waitcnt lgkmcnt(8)
  v_mfma_f32_16x16x32_bf16 v[20:23], v[192:195], v[92:95], v[20:23]
  ds_read_b128 v[228:231], v4 offset:9216
  v_mfma_f32_16x16x32_bf16 v[24:27], v[196:199], v[88:91], v[24:27]
  ds_read_b128 v[232:235], v4 offset:10240
  v_mfma_f32_16x16x32_bf16 v[28:31], v[196:199], v[92:95], v[28:31]
  ds_read_b128 v[236:239], v4 offset:11264
  v_mfma_f32_16x16x32_bf16 v[32:35], v[200:203], v[88:91], v[32:35]
  ds_read_b128 v[192:195], v4 offset:12288
  v_mfma_f32_16x16x32_bf16 v[36:39], v[200:203], v[92:95], v[36:39]
  ds_read_b128 v[196:199], v4 offset:13312
  s_waitcnt lgkmcnt(12)
  v_mfma_f32_16x16x32_bf16 v[40:43], v[204:207], v[88:91], v[40:43]
  s_waitcnt lgkmcnt(10)
  v_mfma_f32_16x16x32_bf16 v[44:47], v[204:207], v[92:95], v[44:47]
  ds_read_b128 v[200:203], v4 offset:14336
  v_mfma_f32_16x16x32_bf16 v[48:51], v[208:211], v[88:91], v[48:51]
  v_mfma_f32_16x16x32_bf16 v[52:55], v[208:211], v[92:95], v[52:55]
  ds_read_b128 v[204:207], v4 offset:15360
  v_mfma_f32_16x16x32_bf16 v[56:59], v[212:215], v[88:91], v[56:59]
  s_waitcnt lgkmcnt(8)
  v_mfma_f32_16x16x32_bf16 v[60:63], v[212:215], v[92:95], v[60:63]
  ds_read_b128 v[208:211], v4 offset:16384
  v_mfma_f32_16x16x32_bf16 v[64:67], v[216:219], v[88:91], v[64:67]
  v_mfma_f32_16x16x32_bf16 v[68:71], v[216:219], v[92:95], v[68:71]
  ds_read_b128 v[212:215], v4 offset:17408
  v_mfma_f32_16x16x32_bf16 v[72:75], v[220:223], v[88:91], v[72:75]
  s_waitcnt lgkmcnt(8)
  v_mfma_f32_16x16x32_bf16 v[76:79], v[220:223], v[92:95], v[76:79]
  v_mfma_f32_16x16x32_bf16 v[80:83], v[224:227], v[88:91], v[80:83]
  v_mfma_f32_16x16x32_bf16 v[84:87], v[224:227], v[92:95], v[84:87]
  v_mfma_f32_16x16x32_bf16 v[16:19], v[228:231], v[96:99], v[16:19]
  s_waitcnt lgkmcnt(6)
  v_mfma_f32_16x16x32_bf16 v[20:23], v[228:231], v[100:103], v[20:23]
  v_mfma_f32_16x16x32_bf16 v[24:27], v[232:235], v[96:99], v[24:27]
  v_mfma_f32_16x16x32_bf16 v[28:31], v[232:235], v[100:103], v[28:31]
  v_add_u32 v5, 36864, v4
  v_mfma_f32_16x16x32_bf16 v[32:35], v[236:239], v[96:99], v[32:35]
  v_mfma_f32_16x16x32_bf16 v[36:39], v[236:239], v[100:103], v[36:39]
  v_add_u32 v8, 36864, v7
  s_waitcnt lgkmcnt(0)
  s_barrier
  v_mfma_f32_16x16x32_bf16 v[40:43], v[192:195], v[96:99], v[40:43]
  ds_read_b128 v[216:219], v5 offset:0
  v_mfma_f32_16x16x32_bf16 v[44:47], v[192:195], v[100:103], v[44:47]
  ds_read_b128 v[220:223], v5 offset:1024
  v_mfma_f32_16x16x32_bf16 v[48:51], v[196:199], v[96:99], v[48:51]
  ds_read_b128 v[104:107], v8 offset:0
  v_mfma_f32_16x16x32_bf16 v[52:55], v[196:199], v[100:103], v[52:55]
  ds_read_b128 v[224:227], v5 offset:2048
  v_mfma_f32_16x16x32_bf16 v[56:59], v[200:203], v[96:99], v[56:59]
  ds_read_b128 v[108:111], v8 offset:1024
  v_mfma_f32_16x16x32_bf16 v[60:63], v[200:203], v[100:103], v[60:63]
  ds_read_b128 v[228:231], v5 offset:3072
  v_mfma_f32_16x16x32_bf16 v[64:67], v[204:207], v[96:99], v[64:67]
  ds_read_b128 v[232:235], v5 offset:4096
  v_mfma_f32_16x16x32_bf16 v[68:71], v[204:207], v[100:103], v[68:71]
  ds_read_b128 v[236:239], v5 offset:5120
  v_mfma_f32_16x16x32_bf16 v[72:75], v[208:211], v[96:99], v[72:75]
  ds_read_b128 v[112:115], v8 offset:2048
  v_mfma_f32_16x16x32_bf16 v[76:79], v[208:211], v[100:103], v[76:79]
  ds_read_b128 v[192:195], v5 offset:6144
  v_mfma_f32_16x16x32_bf16 v[80:83], v[212:215], v[96:99], v[80:83]
  ds_read_b128 v[116:119], v8 offset:3072
  v_mfma_f32_16x16x32_bf16 v[84:87], v[212:215], v[100:103], v[84:87]
  ds_read_b128 v[196:199], v5 offset:7168
  s_waitcnt lgkmcnt(9)
  v_mfma_f32_16x16x32_bf16 v[16:19], v[216:219], v[104:107], v[16:19]
  ds_read_b128 v[200:203], v5 offset:8192
  s_waitcnt lgkmcnt(8)
  v_mfma_f32_16x16x32_bf16 v[20:23], v[216:219], v[108:111], v[20:23]
  ds_read_b128 v[204:207], v5 offset:9216
  v_mfma_f32_16x16x32_bf16 v[24:27], v[220:223], v[104:107], v[24:27]
  ds_read_b128 v[208:211], v5 offset:10240
  v_mfma_f32_16x16x32_bf16 v[28:31], v[220:223], v[108:111], v[28:31]
  ds_read_b128 v[212:215], v5 offset:11264
  v_mfma_f32_16x16x32_bf16 v[32:35], v[224:227], v[104:107], v[32:35]
  ds_read_b128 v[216:219], v5 offset:12288
  v_mfma_f32_16x16x32_bf16 v[36:39], v[224:227], v[108:111], v[36:39]
  ds_read_b128 v[220:223], v5 offset:13312
  s_waitcnt lgkmcnt(12)
  v_mfma_f32_16x16x32_bf16 v[40:43], v[228:231], v[104:107], v[40:43]
  s_waitcnt lgkmcnt(10)
  v_mfma_f32_16x16x32_bf16 v[44:47], v[228:231], v[108:111], v[44:47]
  ds_read_b128 v[224:227], v5 offset:14336
  v_mfma_f32_16x16x32_bf16 v[48:51], v[232:235], v[104:107], v[48:51]
  v_mfma_f32_16x16x32_bf16 v[52:55], v[232:235], v[108:111], v[52:55]
  ds_read_b128 v[228:231], v5 offset:15360
  v_mfma_f32_16x16x32_bf16 v[56:59], v[236:239], v[104:107], v[56:59]
  s_waitcnt lgkmcnt(8)
  v_mfma_f32_16x16x32_bf16 v[60:63], v[236:239], v[108:111], v[60:63]
  ds_read_b128 v[232:235], v5 offset:16384
  v_mfma_f32_16x16x32_bf16 v[64:67], v[192:195], v[104:107], v[64:67]
  v_mfma_f32_16x16x32_bf16 v[68:71], v[192:195], v[108:111], v[68:71]
  ds_read_b128 v[236:239], v5 offset:17408
  v_mfma_f32_16x16x32_bf16 v[72:75], v[196:199], v[104:107], v[72:75]
  s_waitcnt lgkmcnt(8)
  v_mfma_f32_16x16x32_bf16 v[76:79], v[196:199], v[108:111], v[76:79]
  v_mfma_f32_16x16x32_bf16 v[80:83], v[200:203], v[104:107], v[80:83]
  s_cmp_eq_u32 s49, 1
  s_cbranch_scc1 FF_PUB3
FF_PUB3_B:
  v_mfma_f32_16x16x32_bf16 v[84:87], v[200:203], v[108:111], v[84:87]
  v_mfma_f32_16x16x32_bf16 v[16:19], v[204:207], v[112:115], v[16:19]
  s_waitcnt lgkmcnt(6)
  v_mfma_f32_16x16x32_bf16 v[20:23], v[204:207], v[116:119], v[20:23]
  s_xor_b32 s22, s22, 73728
  v_mfma_f32_16x16x32_bf16 v[24:27], v[208:211], v[112:115], v[24:27]
  v_mfma_f32_16x16x32_bf16 v[28:31], v[208:211], v[116:119], v[28:31]
  v_add_u32 v4, s22, v1
  v_mfma_f32_16x16x32_bf16 v[32:35], v[212:215], v[112:115], v[32:35]
  v_mfma_f32_16x16x32_bf16 v[36:39], v[212:215], v[116:119], v[36:39]
  v_add_u32 v7, s23, v4
  s_waitcnt lgkmcnt(0)
  s_barrier
  v_mfma_f32_16x16x32_bf16 v[40:43], v[216:219], v[112:115], v[40:43]
  ds_read_b128 v[192:195], v4 offset:0
  v_mfma_f32_16x16x32_bf16 v[44:47], v[216:219], v[116:119], v[44:47]
  ds_read_b128 v[196:199], v4 offset:1024
  v_mfma_f32_16x16x32_bf16 v[48:51], v[220:223], v[112:115], v[48:51]
  ds_read_b128 v[88:91], v7 offset:0
  v_mfma_f32_16x16x32_bf16 v[52:55], v[220:223], v[116:119], v[52:55]
  ds_read_b128 v[200:203], v4 offset:2048
  v_mfma_f32_16x16x32_bf16 v[56:59], v[224:227], v[112:115], v[56:59]
  ds_read_b128 v[92:95], v7 offset:1024
  v_mfma_f32_16x16x32_bf16 v[60:63], v[224:227], v[116:119], v[60:63]
  ds_read_b128 v[204:207], v4 offset:3072
  v_mfma_f32_16x16x32_bf16 v[64:67], v[228:231], v[112:115], v[64:67]
  ds_read_b128 v[208:211], v4 offset:4096
  v_mfma_f32_16x16x32_bf16 v[68:71], v[228:231], v[116:119], v[68:71]
  ds_read_b128 v[212:215], v4 offset:5120
  v_mfma_f32_16x16x32_bf16 v[72:75], v[232:235], v[112:115], v[72:75]
  ds_read_b128 v[96:99], v7 offset:2048
  v_mfma_f32_16x16x32_bf16 v[76:79], v[232:235], v[116:119], v[76:79]
  ds_read_b128 v[216:219], v4 offset:6144
  v_mfma_f32_16x16x32_bf16 v[80:83], v[236:239], v[112:115], v[80:83]
  ds_read_b128 v[100:103], v7 offset:3072
  v_mfma_f32_16x16x32_bf16 v[84:87], v[236:239], v[116:119], v[84:87]
  ds_read_b128 v[220:223], v4 offset:7168
  ds_read_b32 v120, v121
  s_add_u32 s49, s49, 1
  s_cmp_le_u32 s49, 8
  s_cbranch_scc1 FF_LOOP2
  s_waitcnt lgkmcnt(0)
  v_readfirstlane_b32 s47, v120
  s_cmp_lg_u32 s47, 0
  s_cbranch_scc1 M_EXIT
  s_add_u32 s34, s31, 18432
  s_nop 4
  s_cmp_eq_u32 s28, 1
  s_cbranch_scc1 FF_EPI1
  s_cmp_eq_u32 s28, 2
  s_cbranch_scc1 FF_EPI2
  s_cmp_eq_u32 s28, 3
  s_cbranch_scc1 FF_EPI3
FF_EPI0:
  v_cvt_pk_bf16_f32 v88, v40, v41
  v_cvt_pk_bf16_f32 v89, v42, v43
  v_cvt_pk_bf16_f32 v90, v44, v45
  v_cvt_pk_bf16_f32 v91, v46, v47
  s_add_u32 s33, s58, 0
  buffer_store_dwordx4 v[88:91], v1, s[24:27], s33 offen offset:3072 sc1
  v_cvt_pk_bf16_f32 v92, v48, v49
  v_cvt_pk_bf16_f32 v93, v50, v51
  v_cvt_pk_bf16_f32 v94, v52, v53
  v_cvt_pk_bf16_f32 v95, v54, v55
  s_add_u32 s33, s58, 4096
  buffer_store_dwordx4 v[92:95], v1, s[24:27], s33 offen offset:0 sc1
  v_cvt_pk_bf16_f32 v96, v56, v57
  v_cvt_pk_bf16_f32 v97, v58, v59
  v_cvt_pk_bf16_f32 v98, v60, v61
  v_cvt_pk_bf16_f32 v99, v62, v63
  s_add_u32 s33, s58, 4096
  buffer_store_dwordx4 v[96:99], v1, s[24:27], s33 offen offset:1024 sc1
  v_cvt_pk_bf16_f32 v100, v64, v65
  v_cvt_pk_bf16_f32 v101, v66, v67
  v_cvt_pk_bf16_f32 v102, v68, v69
  v_cvt_pk_bf16_f32 v103, v70, v71
  s_add_u32 s33, s58, 4096
  buffer_store_dwordx4 v[100:103], v1, s[24:27], s33 offen offset:2048 sc1
  v_cvt_pk_bf16_f32 v104, v72, v73
  v_cvt_pk_bf16_f32 v105, v74, v75
  v_cvt_pk_bf16_f32 v106, v76, v77
  v_cvt_pk_bf16_f32 v107, v78, v79
  s_add_u32 s33, s58, 4096
  buffer_store_dwordx4 v[104:107], v1, s[24:27], s33 offen offset:3072 sc1
  v_cvt_pk_bf16_f32 v108, v80, v81
  v_cvt_pk_bf16_f32 v109, v82, v83
  v_cvt_pk_bf16_f32 v110, v84, v85
  v_cvt_pk_bf16_f32 v111, v86, v87
  s_add_u32 s33, s58, 8192
  buffer_store_dwordx4 v[108:111], v1, s[24:27], s33 offen offset:0 sc1
  v_lshlrev_b32 v124, 16, v160
  v_and_b32 v125, 0xffff0000, v160
  v_lshlrev_b32 v126, 16, v161
  v_and_b32 v127, 0xffff0000, v161
  v_fma_f32 v124, v16, v14, v124
  v_fma_f32 v125, v17, v14, v125
  v_fma_f32 v126, v18, v14, v126
  v_fma_f32 v127, v19, v14, v127
  v_lshlrev_b32 v128, 16, v162
  v_and_b32 v129, 0xffff0000, v162
  v_lshlrev_b32 v130, 16, v163
  v_and_b32 v131, 0xffff0000, v163
  v_fma_f32 v128, v20, v15, v128
  v_fma_f32 v129, v21, v15, v129
  v_fma_f32 v130, v22, v15, v130
  v_fma_f32 v131, v23, v15, v131
  v_lshlrev_b32 v132, 16, v164
  v_and_b32 v133, 0xffff0000, v164
  v_lshlrev_b32 v134, 16, v165
  v_and_b32 v135, 0xffff0000, v165
  v_fma_f32 v132, v24, v14, v132
  v_fma_f32 v133, v25, v14, v133
  v_fma_f32 v134, v26, v14, v134
  v_fma_f32 v135, v27, v14, v135
  v_lshlrev_b32 v136, 16, v166
  v_and_b32 v137, 0xffff0000, v166
  v_lshlrev_b32 v138, 16, v167
  v_and_b32 v139, 0xffff0000, v167
  v_fma_f32 v136, v28, v15, v136
  v_fma_f32 v137, v29, v15, v137
  v_fma_f32 v138, v30, v15, v138
  v_fma_f32 v139, v31, v15, v139
  v_lshlrev_b32 v140, 16, v168
  v_and_b32 v141, 0xffff0000, v168
  v_lshlrev_b32 v142, 16, v169
  v_and_b32 v143, 0xffff0000, v169
  v_fma_f32 v140, v32, v14, v140
  v_fma_f32 v141, v33, v14, v141
  v_fma_f32 v142, v34, v14, v142
  v_fma_f32 v143, v35, v14, v143
  v_lshlrev_b32 v144, 16, v170
  v_and_b32 v145, 0xffff0000, v170
  v_lshlrev_b32 v146, 16, v171
  v_and_b32 v147, 0xffff0000, v171
  v_fma_f32 v144, v36, v15, v144
  v_fma_f32 v145, v37, v15, v145
  v_fma_f32 v146, v38, v15, v146
  v_fma_f32 v147, v39, v15, v147
  v_mov_b32 v156, 0x00003f80
  v_mov_b32 v157, 0x3f800000
  v_lshrrev_b32 v159, 8, v1
  v_lshlrev_b32 v158, 3, v159
  v_sub_u32 v158, v11, v158
  v_lshrrev_b32 v148, 1, v159
  v_lshl_add_u32 v158, v148, 4, v158
  v_and_b32 v159, 1, v159
  v_lshl_add_u32 v158, v159, 5, v158
  s_waitcnt vmcnt(0)
  v_mov_b32 v13, 1
  s_mov_b64 exec, 1
  buffer_atomic_add v13, off, s[60:63], s57 sc0 sc1
  s_waitcnt vmcnt(0)
  s_mov_b64 exec, -1
  v_readfirstlane_b32 s6, v13
  s_mov_b32 s8, 0
  s_and_b32 s7, s6, 7
  s_cmp_eq_u32 s7, 3
  s_cbranch_scc0 FF_POLL0
  s_lshr_b32 s8, s6, 4
  s_branch FF_GO0
FF_POLL0:
  s_mov_b32 s9, 200000
FF_PL0:
  s_cmp_eq_u32 s9, 0
  s_cbranch_scc1 FF_TMO0
  s_sub_u32 s9, s9, 1
  buffer_load_dword v13, off, s[60:63], s57 sc0 sc1
  s_waitcnt vmcnt(0)
  v_readfirstlane_b32 s6, v13
  s_and_b32 s7, s6, 7
  s_cmp_eq_u32 s7, 4
  s_cbranch_scc0 FF_PL0
  s_branch FF_GO0
FF_TMO0:
  v_cvt_pk_bf16_f32 v88, v16, v17
  v_cvt_pk_bf16_f32 v89, v18, v19
  v_cvt_pk_bf16_f32 v90, v20, v21
  v_cvt_pk_bf16_f32 v91, v22, v23
  s_add_u32 s33, s58, 0
  buffer_store_dwordx4 v[88:91], v1, s[24:27], s33 offen offset:0 sc1
  v_cvt_pk_bf16_f32 v92, v24, v25
  v_cvt_pk_bf16_f32 v93, v26, v27
  v_cvt_pk_bf16_f32 v94, v28, v29
  v_cvt_pk_bf16_f32 v95, v30, v31
  s_add_u32 s33, s58, 0
  buffer_store_dwordx4 v[92:95], v1, s[24:27], s33 offen offset:1024 sc1
  v_cvt_pk_bf16_f32 v96, v32, v33
  v_cvt_pk_bf16_f32 v97, v34, v35
  v_cvt_pk_bf16_f32 v98, v36, v37
  v_cvt_pk_bf16_f32 v99, v38, v39
  s_add_u32 s33, s58, 0
  buffer_store_dwordx4 v[96:99], v1, s[24:27], s33 offen offset:2048 sc1
  s_waitcnt vmcnt(0)
  v_mov_b32 v13, 16
  s_mov_b64 exec, 1
  buffer_atomic_or v13, off, s[60:63], s57 sc0 sc1
  s_waitcnt vmcnt(0)
  s_mov_b64 exec, -1
  v_readfirstlane_b32 s6, v13
  s_and_b32 s7, s6, 7
  s_cmp_eq_u32 s7, 4
  s_cbranch_scc1 FF_GO0
  s_branch M_EXIT
FF_GO0:
  s_add_u32 s33, s58, 8192
  buffer_load_dwordx4 v[88:91], v1, s[24:27], s33 offen offset:1024 sc1
  s_add_u32 s33, s58, 16384
  buffer_load_dwordx4 v[92:95], v1, s[24:27], s33 offen offset:2048 sc1
  s_add_u32 s33, s58, 24576
  buffer_load_dwordx4 v[96:99], v1, s[24:27], s33 offen offset:3072 sc1
  s_add_u32 s33, s58, 8192
  buffer_load_dwordx4 v[100:103], v1, s[24:27], s33 offen offset:2048 sc1
  s_add_u32 s33, s58, 16384
  buffer_load_dwordx4 v[104:107], v1, s[24:27], s33 offen offset:3072 sc1
  s_add_u32 s33, s58, 28672
  buffer_load_dwordx4 v[108:111], v1, s[24:27], s33 offen offset:0 sc1
  s_add_u32 s33, s58, 8192
  buffer_load_dwordx4 v[112:115], v1, s[24:27], s33 offen offset:3072 sc1
  s_add_u32 s33, s58, 20480
  buffer_load_dwordx4 v[116:119], v1, s[24:27], s33 offen offset:0 sc1
  s_add_u32 s33, s58, 28672
  buffer_load_dwordx4 v[120:123], v1, s[24:27], s33 offen offset:1024 sc1
  s_waitcnt vmcnt(8)
  v_dot2_f32_bf16 v148, v88, v156, 0
  v_dot2_f32_bf16 v149, v88, v157, 0
  v_dot2_f32_bf16 v150, v89, v156, 0
  v_dot2_f32_bf16 v151, v89, v157, 0
  s_waitcnt vmcnt(7)
  v_dot2_f32_bf16 v148, v92, v156, v148
  v_dot2_f32_bf16 v149, v92, v157, v149
  v_dot2_f32_bf16 v150, v93, v156, v150
  v_dot2_f32_bf16 v151, v93, v157, v151
  s_waitcnt vmcnt(6)
  v_dot2_f32_bf16 v148, v96, v156, v148
  v_dot2_f32_bf16 v149, v96, v157, v149
  v_dot2_f32_bf16 v150, v97, v156, v150
  v_dot2_f32_bf16 v151, v97, v157, v151
  v_fma_f32 v124, v148, v14, v124
  v_fma_f32 v125, v149, v14, v125
  v_fma_f32 v126, v150, v14, v126
  v_fma_f32 v127, v151, v14, v127
  v_cvt_pk_bf16_f32 v124, v124, v125
  v_cvt_pk_bf16_f32 v125, v126, v127
  s_waitcnt vmcnt(5)
  v_dot2_f32_bf16 v152, v100, v156, 0
  v_dot2_f32_bf16 v153, v100, v157, 0
  v_dot2_f32_bf16 v154, v101, v156, 0
  v_dot2_f32_bf16 v155, v101, v157, 0
  s_waitcnt vmcnt(4)
  v_dot2_f32_bf16 v152, v104, v156, v152
  v_dot2_f32_bf16 v153, v104, v157, v153
  v_dot2_f32_bf16 v154, v105, v156, v154
  v_dot2_f32_bf16 v155, v105, v157, v155
  s_waitcnt vmcnt(3)
  v_dot2_f32_bf16 v152, v108, v156, v152
  v_dot2_f32_bf16 v153, v108, v157, v153
  v_dot2_f32_bf16 v154, v109, v156, v154
  v_dot2_f32_bf16 v155, v109, v157, v155
  v_fma_f32 v132, v152, v14, v132
  v_fma_f32 v133, v153, v14, v133
  v_fma_f32 v134, v154, v14, v134
  v_fma_f32 v135, v155, v14, v135
  v_cvt_pk_bf16_f32 v126, v132, v133
  v_cvt_pk_bf16_f32 v127, v134, v135
  s_nop 0
  v_permlane16_swap_b32 v124, v126
  v_permlane16_swap_b32 v125, v127
  s_add_u32 s33, s59, 0
  buffer_store_dwordx4 v[124:127], v158, s[52:55], s33 offen
  v_dot2_f32_bf16 v148, v90, v156, 0
  v_dot2_f32_bf16 v149, v90, v157, 0
  v_dot2_f32_bf16 v150, v91, v156, 0
  v_dot2_f32_bf16 v151, v91, v157, 0
  v_dot2_f32_bf16 v148, v94, v156, v148
  v_dot2_f32_bf16 v149, v94, v157, v149
  v_dot2_f32_bf16 v150, v95, v156, v150
  v_dot2_f32_bf16 v151, v95, v157, v151
  v_dot2_f32_bf16 v148, v98, v156, v148
  v_dot2_f32_bf16 v149, v98, v157, v149
  v_dot2_f32_bf16 v150, v99, v156, v150
  v_dot2_f32_bf16 v151, v99, v157, v151
  v_fma_f32 v128, v148, v15, v128
  v_fma_f32 v129, v149, v15, v129
  v_fma_f32 v130, v150, v15, v130
  v_fma_f32 v131, v151, v15, v131
  v_cvt_pk_bf16_f32 v128, v128, v129
  v_cvt_pk_bf16_f32 v129, v130, v131
  v_dot2_f32_bf16 v152, v102, v156, 0
  v_dot2_f32_bf16 v153, v102, v157, 0
  v_dot2_f32_bf16 v154, v103, v156, 0
  v_dot2_f32_bf16 v155, v103, v157, 0
  v_dot2_f32_bf16 v152, v106, v156, v152
  v_dot2_f32_bf16 v153, v106, v157, v153
  v_dot2_f32_bf16 v154, v107, v156, v154
  v_dot2_f32_bf16 v155, v107, v157, v155
  v_dot2_f32_bf16 v152, v110, v156, v152
  v_dot2_f32_bf16 v153, v110, v157, v153
  v_dot2_f32_bf16 v154, v111, v156, v154
  v_dot2_f32_bf16 v155, v111, v157, v155
  v_fma_f32 v136, v152, v15, v136
  v_fma_f32 v137, v153, v15, v137
  v_fma_f32 v138, v154, v15, v138
  v_fma_f32 v139, v155, v15, v139
  v_cvt_pk_bf16_f32 v130, v136, v137
  v_cvt_pk_bf16_f32 v131, v138, v139
  s_nop 0
  v_permlane16_swap_b32 v128, v130
  v_permlane16_swap_b32 v129, v131
  s_add_u32 s33, s59, 18432
  buffer_store_dwordx4 v[128:131], v158, s[52:55], s33 offen
  s_waitcnt vmcnt(4)
  v_dot2_f32_bf16 v148, v112, v156, 0
  v_dot2_f32_bf16 v149, v112, v157, 0
  v_dot2_f32_bf16 v150, v113, v156, 0
  v_dot2_f32_bf16 v151, v113, v157, 0
  s_waitcnt vmcnt(3)
  v_dot2_f32_bf16 v148, v116, v156, v148
  v_dot2_f32_bf16 v149, v116, v157, v149
  v_dot2_f32_bf16 v150, v117, v156, v150
  v_dot2_f32_bf16 v151, v117, v157, v151
  s_waitcnt vmcnt(2)
  v_dot2_f32_bf16 v148, v120, v156, v148
  v_dot2_f32_bf16 v149, v120, v157, v149
  v_dot2_f32_bf16 v150, v121, v156, v150
  v_dot2_f32_bf16 v151, v121, v157, v151
  v_fma_f32 v140, v148, v14, v140
  v_fma_f32 v141, v149, v14, v141
  v_fma_f32 v142, v150, v14, v142
  v_fma_f32 v143, v151, v14, v143
  v_cvt_pk_bf16_f32 v140, v140, v141
  v_cvt_pk_bf16_f32 v141, v142, v143
  s_add_u32 s33, s59, 64
  buffer_store_dwordx2 v[140:141], v11, s[52:55], s33 offen
  v_dot2_f32_bf16 v152, v114, v156, 0
  v_dot2_f32_bf16 v153, v114, v157, 0
  v_dot2_f32_bf16 v154, v115, v156, 0
  v_dot2_f32_bf16 v155, v115, v157, 0
  v_dot2_f32_bf16 v152, v118, v156, v152
  v_dot2_f32_bf16 v153, v118, v157, v153
  v_dot2_f32_bf16 v154, v119, v156, v154
  v_dot2_f32_bf16 v155, v119, v157, v155
  v_dot2_f32_bf16 v152, v122, v156, v152
  v_dot2_f32_bf16 v153, v122, v157, v153
  v_dot2_f32_bf16 v154, v123, v156, v154
  v_dot2_f32_bf16 v155, v123, v157, v155
  v_fma_f32 v144, v152, v15, v144
  v_fma_f32 v145, v153, v15, v145
  v_fma_f32 v146, v154, v15, v146
  v_fma_f32 v147, v155, v15, v147
  v_cvt_pk_bf16_f32 v144, v144, v145
  v_cvt_pk_bf16_f32 v145, v146, v147
  s_add_u32 s33, s59, 18496
  buffer_store_dwordx2 v[144:145], v11, s[52:55], s33 offen
  s_cmp_lg_u32 s8, 0
  s_cbranch_scc1 FF_RESCUE
  s_branch M_EXIT
FF_EPI1:
  v_cvt_pk_bf16_f32 v88, v16, v17
  v_cvt_pk_bf16_f32 v89, v18, v19
  v_cvt_pk_bf16_f32 v90, v20, v21
  v_cvt_pk_bf16_f32 v91, v22, v23
  s_add_u32 s33, s58, 8192
  buffer_store_dwordx4 v[88:91], v1, s[24:27], s33 offen offset:1024 sc1
  v_cvt_pk_bf16_f32 v92, v24, v25
  v_cvt_pk_bf16_f32 v93, v26, v27
  v_cvt_pk_bf16_f32 v94, v28, v29
  v_cvt_pk_bf16_f32 v95, v30, v31
  s_add_u32 s33, s58, 8192
  buffer_store_dwordx4 v[92:95], v1, s[24:27], s33 offen offset:2048 sc1
  v_cvt_pk_bf16_f32 v96, v32, v33
  v_cvt_pk_bf16_f32 v97, v34, v35
  v_cvt_pk_bf16_f32 v98, v36, v37
  v_cvt_pk_bf16_f32 v99, v38, v39
  s_add_u32 s33, s58, 8192
  buffer_store_dwordx4 v[96:99], v1, s[24:27], s33 offen offset:3072 sc1
  v_cvt_pk_bf16_f32 v100, v56, v57
  v_cvt_pk_bf16_f32 v101, v58, v59
  v_cvt_pk_bf16_f32 v102, v60, v61
  v_cvt_pk_bf16_f32 v103, v62, v63
  s_add_u32 s33, s58, 12288
  buffer_store_dwordx4 v[100:103], v1, s[24:27], s33 offen offset:2048 sc1
  v_cvt_pk_bf16_f32 v104, v64, v65
  v_cvt_pk_bf16_f32 v105, v66, v67
  v_cvt_pk_bf16_f32 v106, v68, v69
  v_cvt_pk_bf16_f32 v107, v70, v71
  s_add_u32 s33, s58, 12288
  buffer_store_dwordx4 v[104:107], v1, s[24:27], s33 offen offset:3072 sc1
  v_cvt_pk_bf16_f32 v108, v72, v73
  v_cvt_pk_bf16_f32 v109, v74, v75
  v_cvt_pk_bf16_f32 v110, v76, v77
  v_cvt_pk_bf16_f32 v111, v78, v79
  s_add_u32 s33, s58, 16384
  buffer_store_dwordx4 v[108:111], v1, s[24:27], s33 offen offset:0 sc1
  v_cvt_pk_bf16_f32 v112, v80, v81
  v_cvt_pk_bf16_f32 v113, v82, v83
  v_cvt_pk_bf16_f32 v114, v84, v85
  v_cvt_pk_bf16_f32 v115, v86, v87
  s_add_u32 s33, s58, 16384
  buffer_store_dwordx4 v[112:115], v1, s[24:27], s33 offen offset:1024 sc1
  v_lshlrev_b32 v124, 16, v160
  v_and_b32 v125, 0xffff0000, v160
  v_lshlrev_b32 v126, 16, v161
  v_and_b32 v127, 0xffff0000, v161
  v_fma_f32 v124, v40, v14, v124
  v_fma_f32 v125, v41, v14, v125
  v_fma_f32 v126, v42, v14, v126
  v_fma_f32 v127, v43, v14, v127
  v_lshlrev_b32 v128, 16, v162
  v_and_b32 v129, 0xffff0000, v162
  v_lshlrev_b32 v130, 16, v163
  v_and_b32 v131, 0xffff0000, v163
  v_fma_f32 v128, v44, v15, v128
  v_fma_f32 v129, v45, v15, v129
  v_fma_f32 v130, v46, v15, v130
  v_fma_f32 v131, v47, v15, v131
  v_lshlrev_b32 v132, 16, v164
  v_and_b32 v133, 0xffff0000, v164
  v_lshlrev_b32 v134, 16, v165
  v_and_b32 v135, 0xffff0000, v165
  v_fma_f32 v132, v48, v14, v132
  v_fma_f32 v133, v49, v14, v133
  v_fma_f32 v134, v50, v14, v134
  v_fma_f32 v135, v51, v14, v135
  v_lshlrev_b32 v136, 16, v166
  v_and_b32 v137, 0xffff0000, v166
  v_lshlrev_b32 v138, 16, v167
  v_and_b32 v139, 0xffff0000, v167
  v_fma_f32 v136, v52, v15, v136
  v_fma_f32 v137, v53, v15, v137
  v_fma_f32 v138, v54, v15, v138
  v_fma_f32 v139, v55, v15, v139
  v_mov_b32 v156, 0x00003f80
  v_mov_b32 v157, 0x3f800000
  v_lshrrev_b32 v159, 8, v1
  v_lshlrev_b32 v158, 3, v159
  v_sub_u32 v158, v11, v158
  v_lshrrev_b32 v148, 1, v159
  v_lshl_add_u32 v158, v148, 4, v158
  v_and_b32 v159, 1, v159
  v_lshl_add_u32 v158, v159, 5, v158
  s_waitcnt vmcnt(0)
  v_mov_b32 v13, 1
  s_mov_b64 exec, 1
  buffer_atomic_add v13, off, s[60:63], s57 sc0 sc1
  s_waitcnt vmcnt(0)
  s_mov_b64 exec, -1
  v_readfirstlane_b32 s6, v13
  s_mov_b32 s8, 0
  s_and_b32 s7, s6, 7
  s_cmp_eq_u32 s7, 3
  s_cbranch_scc0 FF_POLL1
  s_lshr_b32 s8, s6, 4
  s_branch FF_GO1
FF_POLL1:
  s_mov_b32 s9, 200000
FF_PL1:
  s_cmp_eq_u32 s9, 0
  s_cbranch_scc1 FF_TMO1
  s_sub_u32 s9, s9, 1
  buffer_load_dword v13, off, s[60:63], s57 sc0 sc1
  s_waitcnt vmcnt(0)
  v_readfirstlane_b32 s6, v13
  s_and_b32 s7, s6, 7
  s_cmp_eq_u32 s7, 4
  s_cbranch_scc0 FF_PL1
  s_branch FF_GO1
FF_TMO1:
  v_cvt_pk_bf16_f32 v88, v40, v41
  v_cvt_pk_bf16_f32 v89, v42, v43
  v_cvt_pk_bf16_f32 v90, v44, v45
  v_cvt_pk_bf16_f32 v91, v46, v47
  s_add_u32 s33, s58, 12288
  buffer_store_dwordx4 v[88:91], v1, s[24:27], s33 offen offset:0 sc1
  v_cvt_pk_bf16_f32 v92, v48, v49
  v_cvt_pk_bf16_f32 v93, v50, v51
  v_cvt_pk_bf16_f32 v94, v52, v53
  v_cvt_pk_bf16_f32 v95, v54, v55
  s_add_u32 s33, s58, 12288
  buffer_store_dwordx4 v[92:95], v1, s[24:27], s33 offen offset:1024 sc1
  s_waitcnt vmcnt(0)
  v_mov_b32 v13, 32
  s_mov_b64 exec, 1
  buffer_atomic_or v13, off, s[60:63], s57 sc0 sc1
  s_waitcnt vmcnt(0)
  s_mov_b64 exec, -1
  v_readfirstlane_b32 s6, v13
  s_and_b32 s7, s6, 7
  s_cmp_eq_u32 s7, 4
  s_cbranch_scc1 FF_GO1
  s_branch M_EXIT
FF_GO1:
  s_add_u32 s33, s58, 0
  buffer_load_dwordx4 v[88:91], v1, s[24:27], s33 offen offset:3072 sc1
  s_add_u32 s33, s58, 20480
  buffer_load_dwordx4 v[92:95], v1, s[24:27], s33 offen offset:1024 sc1
  s_add_u32 s33, s58, 28672
  buffer_load_dwordx4 v[96:99], v1, s[24:27], s33 offen offset:2048 sc1
  s_add_u32 s33, s58, 4096
  buffer_load_dwordx4 v[100:103], v1, s[24:27], s33 offen offset:0 sc1
  s_add_u32 s33, s58, 20480
  buffer_load_dwordx4 v[104:107], v1, s[24:27], s33 offen offset:2048 sc1
  s_add_u32 s33, s58, 28672
  buffer_load_dwordx4 v[108:111], v1, s[24:27], s33 offen offset:3072 sc1
  s_waitcnt vmcnt(5)
  v_dot2_f32_bf16 v148, v88, v156, 0
  v_dot2_f32_bf16 v149, v88, v157, 0
  v_dot2_f32_bf16 v150, v89, v156, 0
  v_dot2_f32_bf16 v151, v89, v157, 0
  s_waitcnt vmcnt(4)
  v_dot2_f32_bf16 v148, v92, v156, v148
  v_dot2_f32_bf16 v149, v92, v157, v149
  v_dot2_f32_bf16 v150, v93, v156, v150
  v_dot2_f32_bf16 v151, v93, v157, v151
  s_waitcnt vmcnt(3)
  v_dot2_f32_bf16 v148, v96, v156, v148
  v_dot2_f32_bf16 v149, v96, v157, v149
  v_dot2_f32_bf16 v150, v97, v156, v150
  v_dot2_f32_bf16 v151, v97, v157, v151
  v_fma_f32 v124, v148, v14, v124
  v_fma_f32 v125, v149, v14, v125
  v_fma_f32 v126, v150, v14, v126
  v_fma_f32 v127, v151, v14, v127
  v_cvt_pk_bf16_f32 v124, v124, v125
  v_cvt_pk_bf16_f32 v125, v126, v127
  s_waitcnt vmcnt(2)
  v_dot2_f32_bf16 v152, v100, v156, 0
  v_dot2_f32_bf16 v153, v100, v157, 0
  v_dot2_f32_bf16 v154, v101, v156, 0
  v_dot2_f32_bf16 v155, v101, v157, 0
  s_waitcnt vmcnt(1)
  v_dot2_f32_bf16 v152, v104, v156, v152
  v_dot2_f32_bf16 v153, v104, v157, v153
  v_dot2_f32_bf16 v154, v105, v156, v154
  v_dot2_f32_bf16 v155, v105, v157, v155
  s_waitcnt vmcnt(0)
  v_dot2_f32_bf16 v152, v108, v156, v152
  v_dot2_f32_bf16 v153, v108, v157, v153
  v_dot2_f32_bf16 v154, v109, v156, v154
  v_dot2_f32_bf16 v155, v109, v157, v155
  v_fma_f32 v132, v152, v14, v132
  v_fma_f32 v133, v153, v14, v133
  v_fma_f32 v134, v154, v14, v134
  v_fma_f32 v135, v155, v14, v135
  v_cvt_pk_bf16_f32 v126, v132, v133
  v_cvt_pk_bf16_f32 v127, v134, v135
  s_nop 0
  v_permlane16_swap_b32 v124, v126
  v_permlane16_swap_b32 v125, v127
  s_add_u32 s33, s59, 96
  buffer_store_dwordx4 v[124:127], v158, s[52:55], s33 offen
  v_dot2_f32_bf16 v148, v90, v156, 0
  v_dot2_f32_bf16 v149, v90, v157, 0
  v_dot2_f32_bf16 v150, v91, v156, 0
  v_dot2_f32_bf16 v151, v91, v157, 0
  v_dot2_f32_bf16 v148, v94, v156, v148
  v_dot2_f32_bf16 v149, v94, v157, v149
  v_dot2_f32_bf16 v150, v95, v156, v150
  v_dot2_f32_bf16 v151, v95, v157, v151
  v_dot2_f32_bf16 v148, v98, v156, v148
  v_dot2_f32_bf16 v149, v98, v157, v149
  v_dot2_f32_bf16 v150, v99, v156, v150
  v_dot2_f32_bf16 v151, v99, v157, v151
  v_fma_f32 v128, v148, v15, v128
  v_fma_f32 v129, v149, v15, v129
  v_fma_f32 v130, v150, v15, v130
  v_fma_f32 v131, v151, v15, v131
  v_cvt_pk_bf16_f32 v128, v128, v129
  v_cvt_pk_bf16_f32 v129, v130, v131
  v_dot2_f32_bf16 v152, v102, v156, 0
  v_dot2_f32_bf16 v153, v102, v157, 0
  v_dot2_f32_bf16 v154, v103, v156, 0
  v_dot2_f32_bf16 v155, v103, v157, 0
  v_dot2_f32_bf16 v152, v106, v156, v152
  v_dot2_f32_bf16 v153, v106, v157, v153
  v_dot2_f32_bf16 v154, v107, v156, v154
  v_dot2_f32_bf16 v155, v107, v157, v155
  v_dot2_f32_bf16 v152, v110, v156, v152
  v_dot2_f32_bf16 v153, v110, v157, v153
  v_dot2_f32_bf16 v154, v111, v156, v154
  v_dot2_f32_bf16 v155, v111, v157, v155
  v_fma_f32 v136, v152, v15, v136
  v_fma_f32 v137, v153, v15, v137
  v_fma_f32 v138, v154, v15, v138
  v_fma_f32 v139, v155, v15, v139
  v_cvt_pk_bf16_f32 v130, v136, v137
  v_cvt_pk_bf16_f32 v131, v138, v139
  s_nop 0
  v_permlane16_swap_b32 v128, v130
  v_permlane16_swap_b32 v129, v131
  s_add_u32 s33, s59, 18528
  buffer_store_dwordx4 v[128:131], v158, s[52:55], s33 offen
  s_cmp_lg_u32 s8, 0
  s_cbranch_scc1 FF_RESCUE
  s_branch M_EXIT
FF_EPI2:
  v_cvt_pk_bf16_f32 v88, v16, v17
  v_cvt_pk_bf16_f32 v89, v18, v19
  v_cvt_pk_bf16_f32 v90, v20, v21
  v_cvt_pk_bf16_f32 v91, v22, v23
  s_add_u32 s33, s58, 16384
  buffer_store_dwordx4 v[88:91], v1, s[24:27], s33 offen offset:2048 sc1
  v_cvt_pk_bf16_f32 v92, v24, v25
  v_cvt_pk_bf16_f32 v93, v26, v27
  v_cvt_pk_bf16_f32 v94, v28, v29
  v_cvt_pk_bf16_f32 v95, v30, v31
  s_add_u32 s33, s58, 16384
  buffer_store_dwordx4 v[92:95], v1, s[24:27], s33 offen offset:3072 sc1
  v_cvt_pk_bf16_f32 v96, v32, v33
  v_cvt_pk_bf16_f32 v97, v34, v35
  v_cvt_pk_bf16_f32 v98, v36, v37
  v_cvt_pk_bf16_f32 v99, v38, v39
  s_add_u32 s33, s58, 20480
  buffer_store_dwordx4 v[96:99], v1, s[24:27], s33 offen offset:0 sc1
  v_cvt_pk_bf16_f32 v100, v40, v41
  v_cvt_pk_bf16_f32 v101, v42, v43
  v_cvt_pk_bf16_f32 v102, v44, v45
  v_cvt_pk_bf16_f32 v103, v46, v47
  s_add_u32 s33, s58, 20480
  buffer_store_dwordx4 v[100:103], v1, s[24:27], s33 offen offset:1024 sc1
  v_cvt_pk_bf16_f32 v104, v48, v49
  v_cvt_pk_bf16_f32 v105, v50, v51
  v_cvt_pk_bf16_f32 v106, v52, v53
  v_cvt_pk_bf16_f32 v107, v54, v55
  s_add_u32 s33, s58, 20480
  buffer_store_dwordx4 v[104:107], v1, s[24:27], s33 offen offset:2048 sc1
  v_cvt_pk_bf16_f32 v108, v72, v73
  v_cvt_pk_bf16_f32 v109, v74, v75
  v_cvt_pk_bf16_f32 v110, v76, v77
  v_cvt_pk_bf16_f32 v111, v78, v79
  s_add_u32 s33, s58, 24576
  buffer_store_dwordx4 v[108:111], v1, s[24:27], s33 offen offset:1024 sc1
  v_cvt_pk_bf16_f32 v112, v80, v81
  v_cvt_pk_bf16_f32 v113, v82, v83
  v_cvt_pk_bf16_f32 v114, v84, v85
  v_cvt_pk_bf16_f32 v115, v86, v87
  s_add_u32 s33, s58, 24576
  buffer_store_dwordx4 v[112:115], v1, s[24:27], s33 offen offset:2048 sc1
  v_lshlrev_b32 v124, 16, v160
  v_and_b32 v125, 0xffff0000, v160
  v_lshlrev_b32 v126, 16, v161
  v_and_b32 v127, 0xffff0000, v161
  v_fma_f32 v124, v56, v14, v124
  v_fma_f32 v125, v57, v14, v125
  v_fma_f32 v126, v58, v14, v126
  v_fma_f32 v127, v59, v14, v127
  v_lshlrev_b32 v128, 16, v162
  v_and_b32 v129, 0xffff0000, v162
  v_lshlrev_b32 v130, 16, v163
  v_and_b32 v131, 0xffff0000, v163
  v_fma_f32 v128, v60, v15, v128
  v_fma_f32 v129, v61, v15, v129
  v_fma_f32 v130, v62, v15, v130
  v_fma_f32 v131, v63, v15, v131
  v_lshlrev_b32 v132, 16, v164
  v_and_b32 v133, 0xffff0000, v164
  v_lshlrev_b32 v134, 16, v165
  v_and_b32 v135, 0xffff0000, v165
  v_fma_f32 v132, v64, v14, v132
  v_fma_f32 v133, v65, v14, v133
  v_fma_f32 v134, v66, v14, v134
  v_fma_f32 v135, v67, v14, v135
  v_lshlrev_b32 v136, 16, v166
  v_and_b32 v137, 0xffff0000, v166
  v_lshlrev_b32 v138, 16, v167
  v_and_b32 v139, 0xffff0000, v167
  v_fma_f32 v136, v68, v15, v136
  v_fma_f32 v137, v69, v15, v137
  v_fma_f32 v138, v70, v15, v138
  v_fma_f32 v139, v71, v15, v139
  v_mov_b32 v156, 0x00003f80
  v_mov_b32 v157, 0x3f800000
  v_lshrrev_b32 v159, 8, v1
  v_lshlrev_b32 v158, 3, v159
  v_sub_u32 v158, v11, v158
  v_lshrrev_b32 v148, 1, v159
  v_lshl_add_u32 v158, v148, 4, v158
  v_and_b32 v159, 1, v159
  v_lshl_add_u32 v158, v159, 5, v158
  s_waitcnt vmcnt(0)
  v_mov_b32 v13, 1
  s_mov_b64 exec, 1
  buffer_atomic_add v13, off, s[60:63], s57 sc0 sc1
  s_waitcnt vmcnt(0)
  s_mov_b64 exec, -1
  v_readfirstlane_b32 s6, v13
  s_mov_b32 s8, 0
  s_and_b32 s7, s6, 7
  s_cmp_eq_u32 s7, 3
  s_cbranch_scc0 FF_POLL2
  s_lshr_b32 s8, s6, 4
  s_branch FF_GO2
FF_POLL2:
  s_mov_b32 s9, 200000
FF_PL2:
  s_cmp_eq_u32 s9, 0
  s_cbranch_scc1 FF_TMO2
  s_sub_u32 s9, s9, 1
  buffer_load_dword v13, off, s[60:63], s57 sc0 sc1
  s_waitcnt vmcnt(0)
  v_readfirstlane_b32 s6, v13
  s_and_b32 s7, s6, 7
  s_cmp_eq_u32 s7, 4
  s_cbranch_scc0 FF_PL2
  s_branch FF_GO2
FF_TMO2:
  v_cvt_pk_bf16_f32 v88, v56, v57
  v_cvt_pk_bf16_f32 v89, v58, v59
  v_cvt_pk_bf16_f32 v90, v60, v61
  v_cvt_pk_bf16_f32 v91, v62, v63
  s_add_u32 s33, s58, 20480
  buffer_store_dwordx4 v[88:91], v1, s[24:27], s33 offen offset:3072 sc1
  v_cvt_pk_bf16_f32 v92, v64, v65
  v_cvt_pk_bf16_f32 v93, v66, v67
  v_cvt_pk_bf16_f32 v94, v68, v69
  v_cvt_pk_bf16_f32 v95, v70, v71
  s_add_u32 s33, s58, 24576
  buffer_store_dwordx4 v[92:95], v1, s[24:27], s33 offen offset:0 sc1
  s_waitcnt vmcnt(0)
  v_mov_b32 v13, 64
  s_mov_b64 exec, 1
  buffer_atomic_or v13, off, s[60:63], s57 sc0 sc1
  s_waitcnt vmcnt(0)
  s_mov_b64 exec, -1
  v_readfirstlane_b32 s6, v13
  s_and_b32 s7, s6, 7
  s_cmp_eq_u32 s7, 4
  s_cbranch_scc1 FF_GO2
  s_branch M_EXIT
FF_GO2:
  s_add_u32 s33, s58, 4096
  buffer_load_dwordx4 v[88:91], v1, s[24:27], s33 offen offset:1024 sc1
  s_add_u32 s33, s58, 12288
  buffer_load_dwordx4 v[92:95], v1, s[24:27], s33 offen offset:2048 sc1
  s_add_u32 s33, s58, 32768
  buffer_load_dwordx4 v[96:99], v1, s[24:27], s33 offen offset:0 sc1
  s_add_u32 s33, s58, 4096
  buffer_load_dwordx4 v[100:103], v1, s[24:27], s33 offen offset:2048 sc1
  s_add_u32 s33, s58, 12288
  buffer_load_dwordx4 v[104:107], v1, s[24:27], s33 offen offset:3072 sc1
  s_add_u32 s33, s58, 32768
  buffer_load_dwordx4 v[108:111], v1, s[24:27], s33 offen offset:1024 sc1
  s_waitcnt vmcnt(5)
  v_dot2_f32_bf16 v148, v88, v156, 0
  v_dot2_f32_bf16 v149, v88, v157, 0
  v_dot2_f32_bf16 v150, v89, v156, 0
  v_dot2_f32_bf16 v151, v89, v157, 0
  s_waitcnt vmcnt(4)
  v_dot2_f32_bf16 v148, v92, v156, v148
  v_dot2_f32_bf16 v149, v92, v157, v149
  v_dot2_f32_bf16 v150, v93, v156, v150
  v_dot2_f32_bf16 v151, v93, v157, v151
  s_waitcnt vmcnt(3)
  v_dot2_f32_bf16 v148, v96, v156, v148
  v_dot2_f32_bf16 v149, v96, v157, v149
  v_dot2_f32_bf16 v150, v97, v156, v150
  v_dot2_f32_bf16 v151, v97, v157, v151
  v_fma_f32 v124, v148, v14, v124
  v_fma_f32 v125, v149, v14, v125
  v_fma_f32 v126, v150, v14, v126
  v_fma_f32 v127, v151, v14, v127
  v_cvt_pk_bf16_f32 v124, v124, v125
  v_cvt_pk_bf16_f32 v125, v126, v127
  s_waitcnt vmcnt(2)
  v_dot2_f32_bf16 v152, v100, v156, 0
  v_dot2_f32_bf16 v153, v100, v157, 0
  v_dot2_f32_bf16 v154, v101, v156, 0
  v_dot2_f32_bf16 v155, v101, v157, 0
  s_waitcnt vmcnt(1)
  v_dot2_f32_bf16 v152, v104, v156, v152
  v_dot2_f32_bf16 v153, v104, v157, v153
  v_dot2_f32_bf16 v154, v105, v156, v154
  v_dot2_f32_bf16 v155, v105, v157, v155
  s_waitcnt vmcnt(0)
  v_dot2_f32_bf16 v152, v108, v156, v152
  v_dot2_f32_bf16 v153, v108, v157, v153
  v_dot2_f32_bf16 v154, v109, v156, v154
  v_dot2_f32_bf16 v155, v109, v157, v155
  v_fma_f32 v132, v152, v14, v132
  v_fma_f32 v133, v153, v14, v133
  v_fma_f32 v134, v154, v14, v134
  v_fma_f32 v135, v155, v14, v135
  v_cvt_pk_bf16_f32 v126, v132, v133
  v_cvt_pk_bf16_f32 v127, v134, v135
  s_nop 0
  v_permlane16_swap_b32 v124, v126
  v_permlane16_swap_b32 v125, v127
  s_add_u32 s33, s59, 160
  buffer_store_dwordx4 v[124:127], v158, s[52:55], s33 offen
  v_dot2_f32_bf16 v148, v90, v156, 0
  v_dot2_f32_bf16 v149, v90, v157, 0
  v_dot2_f32_bf16 v150, v91, v156, 0
  v_dot2_f32_bf16 v151, v91, v157, 0
  v_dot2_f32_bf16 v148, v94, v156, v148
  v_dot2_f32_bf16 v149, v94, v157, v149
  v_dot2_f32_bf16 v150, v95, v156, v150
  v_dot2_f32_bf16 v151, v95, v157, v151
  v_dot2_f32_bf16 v148, v98, v156, v148
  v_dot2_f32_bf16 v149, v98, v157, v149
  v_dot2_f32_bf16 v150, v99, v156, v150
  v_dot2_f32_bf16 v151, v99, v157, v151
  v_fma_f32 v128, v148, v15, v128
  v_fma_f32 v129, v149, v15, v129
  v_fma_f32 v130, v150, v15, v130
  v_fma_f32 v131, v151, v15, v131
  v_cvt_pk_bf16_f32 v128, v128, v129
  v_cvt_pk_bf16_f32 v129, v130, v131
  v_dot2_f32_bf16 v152, v102, v156, 0
  v_dot2_f32_bf16 v153, v102, v157, 0
  v_dot2_f32_bf16 v154, v103, v156, 0
  v_dot2_f32_bf16 v155, v103, v157, 0
  v_dot2_f32_bf16 v152, v106, v156, v152
  v_dot2_f32_bf16 v153, v106, v157, v153
  v_dot2_f32_bf16 v154, v107, v156, v154
  v_dot2_f32_bf16 v155, v107, v157, v155
  v_dot2_f32_bf16 v152, v110, v156, v152
  v_dot2_f32_bf16 v153, v110, v157, v153
  v_dot2_f32_bf16 v154, v111, v156, v154
  v_dot2_f32_bf16 v155, v111, v157, v155
  v_fma_f32 v136, v152, v15, v136
  v_fma_f32 v137, v153, v15, v137
  v_fma_f32 v138, v154, v15, v138
  v_fma_f32 v139, v155, v15, v139
  v_cvt_pk_bf16_f32 v130, v136, v137
  v_cvt_pk_bf16_f32 v131, v138, v139
  s_nop 0
  v_permlane16_swap_b32 v128, v130
  v_permlane16_swap_b32 v129, v131
  s_add_u32 s33, s59, 18592
  buffer_store_dwordx4 v[128:131], v158, s[52:55], s33 offen
  s_cmp_lg_u32 s8, 0
  s_cbranch_scc1 FF_RESCUE
  s_branch M_EXIT
FF_EPI3:
  v_cvt_pk_bf16_f32 v88, v16, v17
  v_cvt_pk_bf16_f32 v89, v18, v19
  v_cvt_pk_bf16_f32 v90, v20, v21
  v_cvt_pk_bf16_f32 v91, v22, v23
  s_add_u32 s33, s58, 24576
  buffer_store_dwordx4 v[88:91], v1, s[24:27], s33 offen offset:3072 sc1
  v_cvt_pk_bf16_f32 v92, v24, v25
  v_cvt_pk_bf16_f32 v93, v26, v27
  v_cvt_pk_bf16_f32 v94, v28, v29
  v_cvt_pk_bf16_f32 v95, v30, v31
  s_add_u32 s33, s58, 28672
  buffer_store_dwordx4 v[92:95], v1, s[24:27], s33 offen offset:0 sc1
  v_cvt_pk_bf16_f32 v96, v32, v33
  v_cvt_pk_bf16_f32 v97, v34, v35
  v_cvt_pk_bf16_f32 v98, v36, v37
  v_cvt_pk_bf16_f32 v99, v38, v39
  s_add_u32 s33, s58, 28672
  buffer_store_dwordx4 v[96:99], v1, s[24:27], s33 offen offset:1024 sc1
  v_cvt_pk_bf16_f32 v100, v40, v41
  v_cvt_pk_bf16_f32 v101, v42, v43
  v_cvt_pk_bf16_f32 v102, v44, v45
  v_cvt_pk_bf16_f32 v103, v46, v47
  s_add_u32 s33, s58, 28672
  buffer_store_dwordx4 v[100:103], v1, s[24:27], s33 offen offset:2048 sc1
  v_cvt_pk_bf16_f32 v104, v48, v49
  v_cvt_pk_bf16_f32 v105, v50, v51
  v_cvt_pk_bf16_f32 v106, v52, v53
  v_cvt_pk_bf16_f32 v107, v54, v55
  s_add_u32 s33, s58, 28672
  buffer_store_dwordx4 v[104:107], v1, s[24:27], s33 offen offset:3072 sc1
  v_cvt_pk_bf16_f32 v108, v56, v57
  v_cvt_pk_bf16_f32 v109, v58, v59
  v_cvt_pk_bf16_f32 v110, v60, v61
  v_cvt_pk_bf16_f32 v111, v62, v63
  s_add_u32 s33, s58, 32768
  buffer_store_dwordx4 v[108:111], v1, s[24:27], s33 offen offset:0 sc1
  v_cvt_pk_bf16_f32 v112, v64, v65
  v_cvt_pk_bf16_f32 v113, v66, v67
  v_cvt_pk_bf16_f32 v114, v68, v69
  v_cvt_pk_bf16_f32 v115, v70, v71
  s_add_u32 s33, s58, 32768
  buffer_store_dwordx4 v[112:115], v1, s[24:27], s33 offen offset:1024 sc1
  v_lshlrev_b32 v124, 16, v160
  v_and_b32 v125, 0xffff0000, v160
  v_lshlrev_b32 v126, 16, v161
  v_and_b32 v127, 0xffff0000, v161
  v_fma_f32 v124, v72, v14, v124
  v_fma_f32 v125, v73, v14, v125
  v_fma_f32 v126, v74, v14, v126
  v_fma_f32 v127, v75, v14, v127
  v_lshlrev_b32 v128, 16, v162
  v_and_b32 v129, 0xffff0000, v162
  v_lshlrev_b32 v130, 16, v163
  v_and_b32 v131, 0xffff0000, v163
  v_fma_f32 v128, v76, v15, v128
  v_fma_f32 v129, v77, v15, v129
  v_fma_f32 v130, v78, v15, v130
  v_fma_f32 v131, v79, v15, v131
  v_lshlrev_b32 v132, 16, v164
  v_and_b32 v133, 0xffff0000, v164
  v_lshlrev_b32 v134, 16, v165
  v_and_b32 v135, 0xffff0000, v165
  v_fma_f32 v132, v80, v14, v132
  v_fma_f32 v133, v81, v14, v133
  v_fma_f32 v134, v82, v14, v134
  v_fma_f32 v135, v83, v14, v135
  v_lshlrev_b32 v136, 16, v166
  v_and_b32 v137, 0xffff0000, v166
  v_lshlrev_b32 v138, 16, v167
  v_and_b32 v139, 0xffff0000, v167
  v_fma_f32 v136, v84, v15, v136
  v_fma_f32 v137, v85, v15, v137
  v_fma_f32 v138, v86, v15, v138
  v_fma_f32 v139, v87, v15, v139
  v_mov_b32 v156, 0x00003f80
  v_mov_b32 v157, 0x3f800000
  v_lshrrev_b32 v159, 8, v1
  v_lshlrev_b32 v158, 3, v159
  v_sub_u32 v158, v11, v158
  v_lshrrev_b32 v148, 1, v159
  v_lshl_add_u32 v158, v148, 4, v158
  v_and_b32 v159, 1, v159
  v_lshl_add_u32 v158, v159, 5, v158
  s_waitcnt vmcnt(0)
  v_mov_b32 v13, 1
  s_mov_b64 exec, 1
  buffer_atomic_add v13, off, s[60:63], s57 sc0 sc1
  s_waitcnt vmcnt(0)
  s_mov_b64 exec, -1
  v_readfirstlane_b32 s6, v13
  s_mov_b32 s8, 0
  s_and_b32 s7, s6, 7
  s_cmp_eq_u32 s7, 3
  s_cbranch_scc0 FF_POLL3
  s_lshr_b32 s8, s6, 4
  s_branch FF_GO3
FF_POLL3:
  s_mov_b32 s9, 200000
FF_PL3:
  s_cmp_eq_u32 s9, 0
  s_cbranch_scc1 FF_TMO3
  s_sub_u32 s9, s9, 1
  buffer_load_dword v13, off, s[60:63], s57 sc0 sc1
  s_waitcnt vmcnt(0)
  v_readfirstlane_b32 s6, v13
  s_and_b32 s7, s6, 7
  s_cmp_eq_u32 s7, 4
  s_cbranch_scc0 FF_PL3
  s_branch FF_GO3
FF_TMO3:
  v_cvt_pk_bf16_f32 v88, v72, v73
  v_cvt_pk_bf16_f32 v89, v74, v75
  v_cvt_pk_bf16_f32 v90, v76, v77
  v_cvt_pk_bf16_f32 v91, v78, v79
  s_add_u32 s33, s58, 32768
  buffer_store_dwordx4 v[88:91], v1, s[24:27], s33 offen offset:2048 sc1
  v_cvt_pk_bf16_f32 v92, v80, v81
  v_cvt_pk_bf16_f32 v93, v82, v83
  v_cvt_pk_bf16_f32 v94, v84, v85
  v_cvt_pk_bf16_f32 v95, v86, v87
  s_add_u32 s33, s58, 32768
  buffer_store_dwordx4 v[92:95], v1, s[24:27], s33 offen offset:3072 sc1
  s_waitcnt vmcnt(0)
  v_mov_b32 v13, 128
  s_mov_b64 exec, 1
  buffer_atomic_or v13, off, s[60:63], s57 sc0 sc1
  s_waitcnt vmcnt(0)
  s_mov_b64 exec, -1
  v_readfirstlane_b32 s6, v13
  s_and_b32 s7, s6, 7
  s_cmp_eq_u32 s7, 4
  s_cbranch_scc1 FF_GO3
  s_branch M_EXIT
FF_GO3:
  s_add_u32 s33, s58, 4096
  buffer_load_dwordx4 v[88:91], v1, s[24:27], s33 offen offset:3072 sc1
  s_add_u32 s33, s58, 16384
  buffer_load_dwordx4 v[92:95], v1, s[24:27], s33 offen offset:0 sc1
  s_add_u32 s33, s58, 24576
  buffer_load_dwordx4 v[96:99], v1, s[24:27], s33 offen offset:1024 sc1
  s_add_u32 s33, s58, 8192
  buffer_load_dwordx4 v[100:103], v1, s[24:27], s33 offen offset:0 sc1
  s_add_u32 s33, s58, 16384
  buffer_load_dwordx4 v[104:107], v1, s[24:27], s33 offen offset:1024 sc1
  s_add_u32 s33, s58, 24576
  buffer_load_dwordx4 v[108:111], v1, s[24:27], s33 offen offset:2048 sc1
  s_waitcnt vmcnt(5)
  v_dot2_f32_bf16 v148, v88, v156, 0
  v_dot2_f32_bf16 v149, v88, v157, 0
  v_dot2_f32_bf16 v150, v89, v156, 0
  v_dot2_f32_bf16 v151, v89, v157, 0
  s_waitcnt vmcnt(4)
  v_dot2_f32_bf16 v148, v92, v156, v148
  v_dot2_f32_bf16 v149, v92, v157, v149
  v_dot2_f32_bf16 v150, v93, v156, v150
  v_dot2_f32_bf16 v151, v93, v157, v151
  s_waitcnt vmcnt(3)
  v_dot2_f32_bf16 v148, v96, v156, v148
  v_dot2_f32_bf16 v149, v96, v157, v149
  v_dot2_f32_bf16 v150, v97, v156, v150
  v_dot2_f32_bf16 v151, v97, v157, v151
  v_fma_f32 v124, v148, v14, v124
  v_fma_f32 v125, v149, v14, v125
  v_fma_f32 v126, v150, v14, v126
  v_fma_f32 v127, v151, v14, v127
  v_cvt_pk_bf16_f32 v124, v124, v125
  v_cvt_pk_bf16_f32 v125, v126, v127
  s_waitcnt vmcnt(2)
  v_dot2_f32_bf16 v152, v100, v156, 0
  v_dot2_f32_bf16 v153, v100, v157, 0
  v_dot2_f32_bf16 v154, v101, v156, 0
  v_dot2_f32_bf16 v155, v101, v157, 0
  s_waitcnt vmcnt(1)
  v_dot2_f32_bf16 v152, v104, v156, v152
  v_dot2_f32_bf16 v153, v104, v157, v153
  v_dot2_f32_bf16 v154, v105, v156, v154
  v_dot2_f32_bf16 v155, v105, v157, v155
  s_waitcnt vmcnt(0)
  v_dot2_f32_bf16 v152, v108, v156, v152
  v_dot2_f32_bf16 v153, v108, v157, v153
  v_dot2_f32_bf16 v154, v109, v156, v154
  v_dot2_f32_bf16 v155, v109, v157, v155
  v_fma_f32 v132, v152, v14, v132
  v_fma_f32 v133, v153, v14, v133
  v_fma_f32 v134, v154, v14, v134
  v_fma_f32 v135, v155, v14, v135
  v_cvt_pk_bf16_f32 v126, v132, v133
  v_cvt_pk_bf16_f32 v127, v134, v135
  s_nop 0
  v_permlane16_swap_b32 v124, v126
  v_permlane16_swap_b32 v125, v127
  s_add_u32 s33, s59, 224
  buffer_store_dwordx4 v[124:127], v158, s[52:55], s33 offen
  v_dot2_f32_bf16 v148, v90, v156, 0
  v_dot2_f32_bf16 v149, v90, v157, 0
  v_dot2_f32_bf16 v150, v91, v156, 0
  v_dot2_f32_bf16 v151, v91, v157, 0
  v_dot2_f32_bf16 v148, v94, v156, v148
  v_dot2_f32_bf16 v149, v94, v157, v149
  v_dot2_f32_bf16 v150, v95, v156, v150
  v_dot2_f32_bf16 v151, v95, v157, v151
  v_dot2_f32_bf16 v148, v98, v156, v148
  v_dot2_f32_bf16 v149, v98, v157, v149
  v_dot2_f32_bf16 v150, v99, v156, v150
  v_dot2_f32_bf16 v151, v99, v157, v151
  v_fma_f32 v128, v148, v15, v128
  v_fma_f32 v129, v149, v15, v129
  v_fma_f32 v130, v150, v15, v130
  v_fma_f32 v131, v151, v15, v131
  v_cvt_pk_bf16_f32 v128, v128, v129
  v_cvt_pk_bf16_f32 v129, v130, v131
  v_dot2_f32_bf16 v152, v102, v156, 0
  v_dot2_f32_bf16 v153, v102, v157, 0
  v_dot2_f32_bf16 v154, v103, v156, 0
  v_dot2_f32_bf16 v155, v103, v157, 0
  v_dot2_f32_bf16 v152, v106, v156, v152
  v_dot2_f32_bf16 v153, v106, v157, v153
  v_dot2_f32_bf16 v154, v107, v156, v154
  v_dot2_f32_bf16 v155, v107, v157, v155
  v_dot2_f32_bf16 v152, v110, v156, v152
  v_dot2_f32_bf16 v153, v110, v157, v153
  v_dot2_f32_bf16 v154, v111, v156, v154
  v_dot2_f32_bf16 v155, v111, v157, v155
  v_fma_f32 v136, v152, v15, v136
  v_fma_f32 v137, v153, v15, v137
  v_fma_f32 v138, v154, v15, v138
  v_fma_f32 v139, v155, v15, v139
  v_cvt_pk_bf16_f32 v130, v136, v137
  v_cvt_pk_bf16_f32 v131, v138, v139
  s_nop 0
  v_permlane16_swap_b32 v128, v130
  v_permlane16_swap_b32 v129, v131
  s_add_u32 s33, s59, 18656
  buffer_store_dwordx4 v[128:131], v158, s[52:55], s33 offen
  s_cmp_lg_u32 s8, 0
  s_cbranch_scc1 FF_RESCUE
  s_branch M_EXIT
FF_RESCUE:
  s_mov_b32 s9, 0
  s_bitcmp1_b32 s8, 0
  s_cselect_b32 s7, 7, 0
  s_or_b32 s9, s9, s7
  s_bitcmp1_b32 s8, 1
  s_cselect_b32 s7, 24, 0
  s_or_b32 s9, s9, s7
  s_bitcmp1_b32 s8, 2
  s_cselect_b32 s7, 96, 0
  s_or_b32 s9, s9, s7
  s_bitcmp1_b32 s8, 3
  s_cselect_b32 s7, 384, 0
  s_or_b32 s9, s9, s7
  s_mov_b32 s48, 0
FF_RL:
  s_bitcmp1_b32 s9, s48
  s_cbranch_scc0 FF_RN
  s_lshl_b32 s33, s48, 10
  s_add_u32 s33, s33, s58
  buffer_load_dwordx4 v[88:91], v1, s[24:27], s33 offen sc1
  s_add_u32 s33, s33, 9216
  buffer_load_dwordx4 v[92:95], v1, s[24:27], s33 offen sc1
  s_add_u32 s33, s33, 9216
  buffer_load_dwordx4 v[96:99], v1, s[24:27], s33 offen sc1
  s_add_u32 s33, s33, 9216
  buffer_load_dwordx4 v[100:103], v1, s[24:27], s33 offen sc1
  s_add_u32 s33, s33, 9216
  s_lshl_b32 s33, s48, 9
  s_add_u32 s33, s33, s30
  buffer_load_dwordx2 v[104:105], v12, s[36:39], s33 offen sc0 sc1
  s_add_u32 s33, s33, 18432
  buffer_load_dwordx2 v[106:107], v12, s[36:39], s33 offen sc0 sc1
  s_waitcnt vmcnt(0)
  v_lshlrev_b32 v128, 16, v88
  v_and_b32 v129, 0xffff0000, v88
  v_lshlrev_b32 v130, 16, v89
  v_and_b32 v131, 0xffff0000, v89
  v_mov_b32 v132, v128
  v_mov_b32 v133, v129
  v_mov_b32 v134, v130
  v_mov_b32 v135, v131
  v_lshlrev_b32 v128, 16, v92
  v_and_b32 v129, 0xffff0000, v92
  v_lshlrev_b32 v130, 16, v93
  v_and_b32 v131, 0xffff0000, v93
  v_add_f32 v132, v132, v128
  v_add_f32 v133, v133, v129
  v_add_f32 v134, v134, v130
  v_add_f32 v135, v135, v131
  v_lshlrev_b32 v128, 16, v96
  v_and_b32 v129, 0xffff0000, v96
  v_lshlrev_b32 v130, 16, v97
  v_and_b32 v131, 0xffff0000, v97
  v_add_f32 v132, v132, v128
  v_add_f32 v133, v133, v129
  v_add_f32 v134, v134, v130
  v_add_f32 v135, v135, v131
  v_lshlrev_b32 v128, 16, v100
  v_and_b32 v129, 0xffff0000, v100
  v_lshlrev_b32 v130, 16, v101
  v_and_b32 v131, 0xffff0000, v101
  v_add_f32 v132, v132, v128
  v_add_f32 v133, v133, v129
  v_add_f32 v134, v134, v130
  v_add_f32 v135, v135, v131
  v_lshlrev_b32 v128, 16, v104
  v_and_b32 v129, 0xffff0000, v104
  v_lshlrev_b32 v130, 16, v105
  v_and_b32 v131, 0xffff0000, v105
  v_fma_f32 v128, v132, v14, v128
  v_fma_f32 v129, v133, v14, v129
  v_fma_f32 v130, v134, v14, v130
  v_fma_f32 v131, v135, v14, v131
  v_cvt_pk_bf16_f32 v128, v128, v129
  v_cvt_pk_bf16_f32 v129, v130, v131
  s_lshl_b32 s33, s48, 5
  s_add_u32 s33, s33, s59
  s_add_u32 s33, s33, 0
  buffer_store_dwordx2 v[128:129], v11, s[52:55], s33 offen
  v_lshlrev_b32 v136, 16, v90
  v_and_b32 v137, 0xffff0000, v90
  v_lshlrev_b32 v138, 16, v91
  v_and_b32 v139, 0xffff0000, v91
  v_mov_b32 v140, v136
  v_mov_b32 v141, v137
  v_mov_b32 v142, v138
  v_mov_b32 v143, v139
  v_lshlrev_b32 v136, 16, v94
  v_and_b32 v137, 0xffff0000, v94
  v_lshlrev_b32 v138, 16, v95
  v_and_b32 v139, 0xffff0000, v95
  v_add_f32 v140, v140, v136
  v_add_f32 v141, v141, v137
  v_add_f32 v142, v142, v138
  v_add_f32 v143, v143, v139
  v_lshlrev_b32 v136, 16, v98
  v_and_b32 v137, 0xffff0000, v98
  v_lshlrev_b32 v138, 16, v99
  v_and_b32 v139, 0xffff0000, v99
  v_add_f32 v140, v140, v136
  v_add_f32 v141, v141, v137
  v_add_f32 v142, v142, v138
  v_add_f32 v143, v143, v139
  v_lshlrev_b32 v136, 16, v102
  v_and_b32 v137, 0xffff0000, v102
  v_lshlrev_b32 v138, 16, v103
  v_and_b32 v139, 0xffff0000, v103
  v_add_f32 v140, v140, v136
  v_add_f32 v141, v141, v137
  v_add_f32 v142, v142, v138
  v_add_f32 v143, v143, v139
  v_lshlrev_b32 v136, 16, v106
  v_and_b32 v137, 0xffff0000, v106
  v_lshlrev_b32 v138, 16, v107
  v_and_b32 v139, 0xffff0000, v107
  v_fma_f32 v136, v140, v15, v136
  v_fma_f32 v137, v141, v15, v137
  v_fma_f32 v138, v142, v15, v138
  v_fma_f32 v139, v143, v15, v139
  v_cvt_pk_bf16_f32 v136, v136, v137
  v_cvt_pk_bf16_f32 v137, v138, v139
  s_lshl_b32 s33, s48, 5
  s_add_u32 s33, s33, s59
  s_add_u32 s33, s33, 18432
  buffer_store_dwordx2 v[136:137], v11, s[52:55], s33 offen
  s_waitcnt vmcnt(0)
FF_RN:
  s_add_u32 s48, s48, 1
  s_cmp_lt_u32 s48, 9
  s_cbranch_scc1 FF_RL
  s_branch M_EXIT
FF_PUB1:
  s_waitcnt vmcnt(2)
  s_mov_b64 exec, 1
  v_mov_b32 v13, 0x1
  buffer_atomic_add v13, off, s[60:63], s56 sc1
  s_mov_b64 exec, -1
  s_branch FF_PUB1_B
FF_PUB3:
  s_waitcnt vmcnt(0)
  s_mov_b64 exec, 1
  v_mov_b32 v13, 0x10000
  buffer_atomic_add v13, off, s[60:63], s56 sc1
  s_mov_b64 exec, -1
  s_branch FF_PUB3_B
FF_XSLOW:
  s_mov_b32 s8, s96
FF_XSL:
  s_mul_i32 s35, s46, 36864
  s_add_u32 s45, s35, 18432
  buffer_load_dwordx4 v[16:19], v1, s[36:39], s35 offen offset:0 sc0 sc1
  buffer_load_dwordx4 v[20:23], v1, s[36:39], s45 offen offset:0 sc0 sc1
  buffer_load_dwordx4 v[24:27], v1, s[36:39], s35 offen offset:1024 sc0 sc1
  buffer_load_dwordx4 v[28:31], v1, s[36:39], s45 offen offset:1024 sc0 sc1
  buffer_load_dwordx4 v[32:35], v1, s[36:39], s35 offen offset:2048 sc0 sc1
  buffer_load_dwordx4 v[36:39], v1, s[36:39], s45 offen offset:2048 sc0 sc1
  buffer_load_dwordx4 v[40:43], v1, s[36:39], s35 offen offset:3072 sc0 sc1
  buffer_load_dwordx4 v[44:47], v1, s[36:39], s45 offen offset:3072 sc0 sc1
  s_add_u32 s35, s35, 4096
  s_add_u32 s45, s45, 4096
  buffer_load_dwordx4 v[48:51], v1, s[36:39], s35 offen offset:0 sc0 sc1
  buffer_load_dwordx4 v[52:55], v1, s[36:39], s45 offen offset:0 sc0 sc1
  buffer_load_dwordx4 v[56:59], v1, s[36:39], s35 offen offset:1024 sc0 sc1
  buffer_load_dwordx4 v[60:63], v1, s[36:39], s45 offen offset:1024 sc0 sc1
  buffer_load_dwordx4 v[64:67], v1, s[36:39], s35 offen offset:2048 sc0 sc1
  buffer_load_dwordx4 v[68:71], v1, s[36:39], s45 offen offset:2048 sc0 sc1
  buffer_load_dwordx4 v[72:75], v1, s[36:39], s35 offen offset:3072 sc0 sc1
  buffer_load_dwordx4 v[76:79], v1, s[36:39], s45 offen offset:3072 sc0 sc1
  s_add_u32 s35, s35, 4096
  s_add_u32 s45, s45, 4096
  buffer_load_dwordx4 v[80:83], v1, s[36:39], s35 offen offset:0 sc0 sc1
  buffer_load_dwordx4 v[84:87], v1, s[36:39], s45 offen offset:0 sc0 sc1
  buffer_load_dwordx4 v[88:91], v1, s[36:39], s35 offen offset:1024 sc0 sc1
  buffer_load_dwordx4 v[92:95], v1, s[36:39], s45 offen offset:1024 sc0 sc1
  buffer_load_dwordx4 v[96:99], v1, s[36:39], s35 offen offset:2048 sc0 sc1
  buffer_load_dwordx4 v[100:103], v1, s[36:39], s45 offen offset:2048 sc0 sc1
  buffer_load_dwordx4 v[104:107], v1, s[36:39], s35 offen offset:3072 sc0 sc1
  buffer_load_dwordx4 v[108:111], v1, s[36:39], s45 offen offset:3072 sc0 sc1
  s_add_u32 s35, s35, 4096
  s_add_u32 s45, s45, 4096
  buffer_load_dwordx4 v[112:115], v1, s[36:39], s35 offen offset:0 sc0 sc1
  buffer_load_dwordx4 v[116:119], v1, s[36:39], s45 offen offset:0 sc0 sc1
  buffer_load_dwordx4 v[120:123], v1, s[36:39], s35 offen offset:1024 sc0 sc1
  buffer_load_dwordx4 v[124:127], v1, s[36:39], s45 offen offset:1024 sc0 sc1
  buffer_load_dwordx4 v[128:131], v1, s[36:39], s35 offen offset:2048 sc0 sc1
  buffer_load_dwordx4 v[132:135], v1, s[36:39], s45 offen offset:2048 sc0 sc1
  buffer_load_dwordx4 v[136:139], v1, s[36:39], s35 offen offset:3072 sc0 sc1
  buffer_load_dwordx4 v[140:143], v1, s[36:39], s45 offen offset:3072 sc0 sc1
  s_add_u32 s35, s35, 4096
  s_add_u32 s45, s45, 4096
  buffer_load_dwordx4 v[144:147], v1, s[36:39], s35 offen offset:0 sc0 sc1
  buffer_load_dwordx4 v[148:151], v1, s[36:39], s45 offen offset:0 sc0 sc1
  buffer_load_dwordx4 v[152:155], v1, s[36:39], s35 offen offset:1024 sc0 sc1
  buffer_load_dwordx4 v[156:159], v1, s[36:39], s45 offen offset:1024 sc0 sc1
  s_mov_b32 s35, 0x240000
  buffer_load_dwordx2 v[176:177], v8, s[36:39], s35 offen offset:0 sc0 sc1
  buffer_load_dwordx2 v[182:183], v8, s[36:39], s35 offen offset:128 sc0 sc1
  s_add_u32 s35, s35, 16384
  buffer_load_dwordx2 v[178:179], v8, s[36:39], s35 offen offset:0 sc0 sc1
  buffer_load_dwordx2 v[184:185], v8, s[36:39], s35 offen offset:128 sc0 sc1
  s_add_u32 s35, s35, 16384
  buffer_load_dwordx2 v[180:181], v8, s[36:39], s35 offen offset:0 sc0 sc1
  buffer_load_dwordx2 v[186:187], v8, s[36:39], s35 offen offset:128 sc0 sc1
  s_waitcnt vmcnt(0)
  v_mov_b32 v253, 0
  v_max3_u32 v253, v16, v20, v253
  v_max3_u32 v253, v24, v28, v253
  v_max3_u32 v253, v32, v36, v253
  v_max3_u32 v253, v40, v44, v253
  v_max3_u32 v253, v48, v52, v253
  v_max3_u32 v253, v56, v60, v253
  v_max3_u32 v253, v64, v68, v253
  v_max3_u32 v253, v72, v76, v253
  v_max3_u32 v253, v80, v84, v253
  v_max3_u32 v253, v88, v92, v253
  v_max3_u32 v253, v96, v100, v253
  v_max3_u32 v253, v104, v108, v253
  v_max3_u32 v253, v112, v116, v253
  v_max3_u32 v253, v120, v124, v253
  v_max3_u32 v253, v128, v132, v253
  v_max3_u32 v253, v136, v140, v253
  v_max3_u32 v253, v144, v148, v253
  v_max3_u32 v253, v152, v156, v253
  v_max3_u32 v253, v176, v177, v253
  v_max3_u32 v253, v178, v179, v253
  v_max3_u32 v253, v180, v181, v253
  v_max3_u32 v253, v182, v183, v253
  v_max3_u32 v253, v184, v185, v253
  v_max3_u32 v253, v186, v187, v253
  v_cmp_eq_u32 s[6:7], -1, v253
  s_cmp_eq_u64 s[6:7], 0
  s_cbranch_scc1 FF_XSL_OK
  s_sub_u32 s8, s8, 1
  s_cmp_lg_u32 s8, 0
  s_cbranch_scc1 FF_XSL
  s_cmp_lg_u32 s97, 0
  s_cbranch_scc1 M_FL7
  s_mov_b32 s97, 1
  s_mov_b32 s96, 1
  s_mov_b64 exec, 1
  v_mov_b32 v254, 1
  s_mov_b32 s6, 98432
  buffer_atomic_add v254, off, s[60:63], s6 sc0 sc1
  s_waitcnt vmcnt(0)
  v_readfirstlane_b32 s6, v254
  s_cmp_eq_u32 s6, 0
  s_cselect_b32 s6, 1, 0
  v_mov_b32 v254, 163832
  v_mov_b32 v255, 1
  ds_write_b32 v254, v255
  v_mov_b32 v255, s6
  ds_or_b32 v254, v255 offset:4
  s_waitcnt lgkmcnt(0)
  s_mov_b64 exec, -1
M_FL7:
  s_mov_b32 s42, 0
  s_mov_b32 s62, 0
FF_XSL_OK:
  ds_read_b128 v[248:251], v4 offset:0
  s_waitcnt lgkmcnt(0)
  v_mfma_f32_16x16x32_bf16 v[160:163], v[248:251], v[16:19], 0
  v_mfma_f32_16x16x32_bf16 v[164:167], v[248:251], v[20:23], 0
  s_nop 7
  ds_read_b128 v[248:251], v4 offset:1024
  s_waitcnt lgkmcnt(0)
  v_mfma_f32_16x16x32_bf16 v[168:171], v[248:251], v[16:19], 0
  v_mfma_f32_16x16x32_bf16 v[172:175], v[248:251], v[20:23], 0
  s_nop 7
  ds_read_b128 v[248:251], v4 offset:2048
  s_waitcnt lgkmcnt(0)
  v_mfma_f32_16x16x32_bf16 v[160:163], v[248:251], v[24:27], v[160:163]
  v_mfma_f32_16x16x32_bf16 v[164:167], v[248:251], v[28:31], v[164:167]
  s_nop 7
  ds_read_b128 v[248:251], v4 offset:3072
  s_waitcnt lgkmcnt(0)
  v_mfma_f32_16x16x32_bf16 v[168:171], v[248:251], v[24:27], v[168:171]
  v_mfma_f32_16x16x32_bf16 v[172:175], v[248:251], v[28:31], v[172:175]
  s_nop 7
  ds_read_b128 v[248:251], v4 offset:4096
  s_waitcnt lgkmcnt(0)
  v_mfma_f32_16x16x32_bf16 v[160:163], v[248:251], v[32:35], v[160:163]
  v_mfma_f32_16x16x32_bf16 v[164:167], v[248:251], v[36:39], v[164:167]
  s_nop 7
  ds_read_b128 v[248:251], v4 offset:5120
  s_waitcnt lgkmcnt(0)
  v_mfma_f32_16x16x32_bf16 v[168:171], v[248:251], v[32:35], v[168:171]
  v_mfma_f32_16x16x32_bf16 v[172:175], v[248:251], v[36:39], v[172:175]
  s_nop 7
  ds_read_b128 v[248:251], v4 offset:6144
  s_waitcnt lgkmcnt(0)
  v_mfma_f32_16x16x32_bf16 v[160:163], v[248:251], v[40:43], v[160:163]
  v_mfma_f32_16x16x32_bf16 v[164:167], v[248:251], v[44:47], v[164:167]
  s_nop 7
  ds_read_b128 v[248:251], v4 offset:7168
  s_waitcnt lgkmcnt(0)
  v_mfma_f32_16x16x32_bf16 v[168:171], v[248:251], v[40:43], v[168:171]
  v_mfma_f32_16x16x32_bf16 v[172:175], v[248:251], v[44:47], v[172:175]
  s_nop 7
  ds_read_b128 v[248:251], v4 offset:8192
  s_waitcnt lgkmcnt(0)
  v_mfma_f32_16x16x32_bf16 v[160:163], v[248:251], v[48:51], v[160:163]
  v_mfma_f32_16x16x32_bf16 v[164:167], v[248:251], v[52:55], v[164:167]
  s_nop 7
  ds_read_b128 v[248:251], v4 offset:9216
  s_waitcnt lgkmcnt(0)
  v_mfma_f32_16x16x32_bf16 v[168:171], v[248:251], v[48:51], v[168:171]
  v_mfma_f32_16x16x32_bf16 v[172:175], v[248:251], v[52:55], v[172:175]
  s_nop 7
  ds_read_b128 v[248:251], v4 offset:10240
  s_waitcnt lgkmcnt(0)
  v_mfma_f32_16x16x32_bf16 v[160:163], v[248:251], v[56:59], v[160:163]
  v_mfma_f32_16x16x32_bf16 v[164:167], v[248:251], v[60:63], v[164:167]
  s_nop 7
  ds_read_b128 v[248:251], v4 offset:11264
  s_waitcnt lgkmcnt(0)
  v_mfma_f32_16x16x32_bf16 v[168:171], v[248:251], v[56:59], v[168:171]
  v_mfma_f32_16x16x32_bf16 v[172:175], v[248:251], v[60:63], v[172:175]
  s_nop 7
  ds_read_b128 v[248:251], v4 offset:12288
  s_waitcnt lgkmcnt(0)
  v_mfma_f32_16x16x32_bf16 v[160:163], v[248:251], v[64:67], v[160:163]
  v_mfma_f32_16x16x32_bf16 v[164:167], v[248:251], v[68:71], v[164:167]
  s_nop 7
  ds_read_b128 v[248:251], v4 offset:13312
  s_waitcnt lgkmcnt(0)
  v_mfma_f32_16x16x32_bf16 v[168:171], v[248:251], v[64:67], v[168:171]
  v_mfma_f32_16x16x32_bf16 v[172:175], v[248:251], v[68:71], v[172:175]
  s_nop 7
  ds_read_b128 v[248:251], v4 offset:14336
  s_waitcnt lgkmcnt(0)
  v_mfma_f32_16x16x32_bf16 v[160:163], v[248:251], v[72:75], v[160:163]
  v_mfma_f32_16x16x32_bf16 v[164:167], v[248:251], v[76:79], v[164:167]
  s_nop 7
  ds_read_b128 v[248:251], v4 offset:15360
  s_waitcnt lgkmcnt(0)
  v_mfma_f32_16x16x32_bf16 v[168:171], v[248:251], v[72:75], v[168:171]
  v_mfma_f32_16x16x32_bf16 v[172:175], v[248:251], v[76:79], v[172:175]
  s_nop 7
  ds_read_b128 v[248:251], v4 offset:16384
  s_waitcnt lgkmcnt(0)
  v_mfma_f32_16x16x32_bf16 v[160:163], v[248:251], v[80:83], v[160:163]
  v_mfma_f32_16x16x32_bf16 v[164:167], v[248:251], v[84:87], v[164:167]
  s_nop 7
  ds_read_b128 v[248:251], v4 offset:17408
  s_waitcnt lgkmcnt(0)
  v_mfma_f32_16x16x32_bf16 v[168:171], v[248:251], v[80:83], v[168:171]
  v_mfma_f32_16x16x32_bf16 v[172:175], v[248:251], v[84:87], v[172:175]
  s_nop 7
  ds_read_b128 v[248:251], v4 offset:18432
  s_waitcnt lgkmcnt(0)
  v_mfma_f32_16x16x32_bf16 v[160:163], v[248:251], v[88:91], v[160:163]
  v_mfma_f32_16x16x32_bf16 v[164:167], v[248:251], v[92:95], v[164:167]
  s_nop 7
  ds_read_b128 v[248:251], v4 offset:19456
  s_waitcnt lgkmcnt(0)
  v_mfma_f32_16x16x32_bf16 v[168:171], v[248:251], v[88:91], v[168:171]
  v_mfma_f32_16x16x32_bf16 v[172:175], v[248:251], v[92:95], v[172:175]
  s_nop 7
  ds_read_b128 v[248:251], v4 offset:20480
  s_waitcnt lgkmcnt(0)
  v_mfma_f32_16x16x32_bf16 v[160:163], v[248:251], v[96:99], v[160:163]
  v_mfma_f32_16x16x32_bf16 v[164:167], v[248:251], v[100:103], v[164:167]
  s_nop 7
  ds_read_b128 v[248:251], v4 offset:21504
  s_waitcnt lgkmcnt(0)
  v_mfma_f32_16x16x32_bf16 v[168:171], v[248:251], v[96:99], v[168:171]
  v_mfma_f32_16x16x32_bf16 v[172:175], v[248:251], v[100:103], v[172:175]
  s_nop 7
  ds_read_b128 v[248:251], v4 offset:22528
  s_waitcnt lgkmcnt(0)
  v_mfma_f32_16x16x32_bf16 v[160:163], v[248:251], v[104:107], v[160:163]
  v_mfma_f32_16x16x32_bf16 v[164:167], v[248:251], v[108:111], v[164:167]
  s_nop 7
  ds_read_b128 v[248:251], v4 offset:23552
  s_waitcnt lgkmcnt(0)
  v_mfma_f32_16x16x32_bf16 v[168:171], v[248:251], v[104:107], v[168:171]
  v_mfma_f32_16x16x32_bf16 v[172:175], v[248:251], v[108:111], v[172:175]
  s_nop 7
  ds_read_b128 v[248:251], v4 offset:24576
  s_waitcnt lgkmcnt(0)
  v_mfma_f32_16x16x32_bf16 v[160:163], v[248:251], v[112:115], v[160:163]
  v_mfma_f32_16x16x32_bf16 v[164:167], v[248:251], v[116:119], v[164:167]
  s_nop 7
  ds_read_b128 v[248:251], v4 offset:25600
  s_waitcnt lgkmcnt(0)
  v_mfma_f32_16x16x32_bf16 v[168:171], v[248:251], v[112:115], v[168:171]
  v_mfma_f32_16x16x32_bf16 v[172:175], v[248:251], v[116:119], v[172:175]
  s_nop 7
  ds_read_b128 v[248:251], v4 offset:26624
  s_waitcnt lgkmcnt(0)
  v_mfma_f32_16x16x32_bf16 v[160:163], v[248:251], v[120:123], v[160:163]
  v_mfma_f32_16x16x32_bf16 v[164:167], v[248:251], v[124:127], v[164:167]
  s_nop 7
  ds_read_b128 v[248:251], v4 offset:27648
  s_waitcnt lgkmcnt(0)
  v_mfma_f32_16x16x32_bf16 v[168:171], v[248:251], v[120:123], v[168:171]
  v_mfma_f32_16x16x32_bf16 v[172:175], v[248:251], v[124:127], v[172:175]
  s_nop 7
  ds_read_b128 v[248:251], v4 offset:28672
  s_waitcnt lgkmcnt(0)
  v_mfma_f32_16x16x32_bf16 v[160:163], v[248:251], v[128:131], v[160:163]
  v_mfma_f32_16x16x32_bf16 v[164:167], v[248:251], v[132:135], v[164:167]
  s_nop 7
  ds_read_b128 v[248:251], v4 offset:29696
  s_waitcnt lgkmcnt(0)
  v_mfma_f32_16x16x32_bf16 v[168:171], v[248:251], v[128:131], v[168:171]
  v_mfma_f32_16x16x32_bf16 v[172:175], v[248:251], v[132:135], v[172:175]
  s_nop 7
  ds_read_b128 v[248:251], v4 offset:30720
  s_waitcnt lgkmcnt(0)
  v_mfma_f32_16x16x32_bf16 v[160:163], v[248:251], v[136:139], v[160:163]
  v_mfma_f32_16x16x32_bf16 v[164:167], v[248:251], v[140:143], v[164:167]
  s_nop 7
  ds_read_b128 v[248:251], v4 offset:31744
  s_waitcnt lgkmcnt(0)
  v_mfma_f32_16x16x32_bf16 v[168:171], v[248:251], v[136:139], v[168:171]
  v_mfma_f32_16x16x32_bf16 v[172:175], v[248:251], v[140:143], v[172:175]
  s_nop 7
  ds_read_b128 v[248:251], v4 offset:32768
  s_waitcnt lgkmcnt(0)
  v_mfma_f32_16x16x32_bf16 v[160:163], v[248:251], v[144:147], v[160:163]
  v_mfma_f32_16x16x32_bf16 v[164:167], v[248:251], v[148:151], v[164:167]
  s_nop 7
  ds_read_b128 v[248:251], v4 offset:33792
  s_waitcnt lgkmcnt(0)
  v_mfma_f32_16x16x32_bf16 v[168:171], v[248:251], v[144:147], v[168:171]
  v_mfma_f32_16x16x32_bf16 v[172:175], v[248:251], v[148:151], v[172:175]
  s_nop 7
  ds_read_b128 v[248:251], v4 offset:34816
  s_waitcnt lgkmcnt(0)
  v_mfma_f32_16x16x32_bf16 v[160:163], v[248:251], v[152:155], v[160:163]
  v_mfma_f32_16x16x32_bf16 v[164:167], v[248:251], v[156:159], v[164:167]
  s_nop 7
  ds_read_b128 v[248:251], v4 offset:35840
  s_waitcnt lgkmcnt(0)
  v_mfma_f32_16x16x32_bf16 v[168:171], v[248:251], v[152:155], v[168:171]
  v_mfma_f32_16x16x32_bf16 v[172:175], v[248:251], v[156:159], v[172:175]
  s_nop 7
  v_add_f32 v2, v176, v178
  v_add_f32 v14, v177, v179
  v_add_f32 v2, v2, v180
  v_add_f32 v14, v14, v181
  v_mov_b32 v7, v2
  s_nop 1
  v_permlane16_swap_b32 v2, v7
  v_add_f32 v2, v2, v7
  v_mov_b32 v7, v2
  s_nop 1
  v_permlane32_swap_b32 v2, v7
  v_add_f32 v2, v2, v7
  v_mul_f32 v2, 0xbae38e39, v2
  v_add_f32 v3, v182, v184
  v_add_f32 v15, v183, v185
  v_add_f32 v3, v3, v186
  v_add_f32 v15, v15, v187
  v_mov_b32 v7, v3
  s_nop 1
  v_permlane16_swap_b32 v3, v7
  v_add_f32 v3, v3, v7
  v_mov_b32 v7, v3
  s_nop 1
  v_permlane32_swap_b32 v3, v7
  v_add_f32 v3, v3, v7
  v_mul_f32 v3, 0xbae38e39, v3
  s_nop 7
  s_branch FF_XSLOW_B
FF_PROD:
  s_mul_i32 s23, s16, 9216
  s_add_u32 s21, s21, s23
  s_add_u32 s36, s12, 0x800000
  s_addc_u32 s37, s13, 0
  s_mov_b32 s38, 0x1200000
  s_mov_b32 s39, 0x00020000
  s_and_b32 s33, s16, 1
  s_mul_i32 s33, s33, 36
  v_add_u32 v16, s33, v7
  v_lshlrev_b32 v17, 4, v16
  s_lshr_b32 s34, s16, 1
  s_mul_i32 s33, s34, 165888
  s_mul_i32 s35, s20, 1152
  s_add_u32 s33, s33, s35
  s_add_u32 s33, s33, 0x1100000
  v_lshrrev_b32 v18, 2, v16
  v_lshlrev_b32 v18, 7, v18
  v_and_b32 v19, 3, v16
  v_lshl_add_u32 v18, v19, 4, v18
  s_lshl_b32 s34, s34, 6
  s_add_u32 s34, s34, 147456
  v_add_u32 v18, s34, v18
  s_mov_b32 exec_hi, 0xf
  buffer_load_dwordx4 v[24:27], v17, s[24:27], s33 offen
  s_add_u32 s33, s33, 18432
  buffer_load_dwordx4 v[28:31], v17, s[24:27], s33 offen
  s_add_u32 s33, s33, 18432
  buffer_load_dwordx4 v[32:35], v17, s[24:27], s33 offen
  s_add_u32 s33, s33, 18432
  buffer_load_dwordx4 v[36:39], v17, s[24:27], s33 offen
  s_add_u32 s33, s33, 18432
  buffer_load_dwordx4 v[40:43], v17, s[24:27], s33 offen
  s_add_u32 s33, s33, 18432
  buffer_load_dwordx4 v[44:47], v17, s[24:27], s33 offen
  s_add_u32 s33, s33, 18432
  buffer_load_dwordx4 v[48:51], v17, s[24:27], s33 offen
  s_add_u32 s33, s33, 18432
  buffer_load_dwordx4 v[52:55], v17, s[24:27], s33 offen
  s_add_u32 s33, s33, 18432
  buffer_load_dwordx4 v[56:59], v17, s[24:27], s33 offen
  s_add_u32 s33, s33, 18432
  s_mov_b32 exec_hi, -1
  s_add_u32 s21, s21, 36864
  s_add_u32 s33, s23, 36864
  s_add_u32 m0, s33, 0
  s_add_u32 s34, s21, 0
  buffer_load_dwordx4 v1, s[24:27], s34 offen offset:0 lds
  buffer_load_dwordx4 v1, s[24:27], s34 offen offset:1024 lds
  buffer_load_dwordx4 v1, s[24:27], s34 offen offset:2048 lds
  buffer_load_dwordx4 v1, s[24:27], s34 offen offset:3072 lds
  s_add_u32 m0, s33, 4096
  s_add_u32 s34, s21, 4096
  buffer_load_dwordx4 v1, s[24:27], s34 offen offset:0 lds
  buffer_load_dwordx4 v1, s[24:27], s34 offen offset:1024 lds
  buffer_load_dwordx4 v1, s[24:27], s34 offen offset:2048 lds
  buffer_load_dwordx4 v1, s[24:27], s34 offen offset:3072 lds
  s_add_u32 m0, s33, 8192
  s_add_u32 s34, s21, 8192
  buffer_load_dwordx4 v1, s[24:27], s34 offen offset:0 lds
  s_waitcnt vmcnt(16)
  v_add_f32 v24, v24, v28
  v_add_f32 v25, v25, v29
  v_add_f32 v26, v26, v30
  v_add_f32 v27, v27, v31
  s_waitcnt vmcnt(15)
  v_add_f32 v24, v24, v32
  v_add_f32 v25, v25, v33
  v_add_f32 v26, v26, v34
  v_add_f32 v27, v27, v35
  s_waitcnt vmcnt(14)
  v_add_f32 v24, v24, v36
  v_add_f32 v25, v25, v37
  v_add_f32 v26, v26, v38
  v_add_f32 v27, v27, v39
  s_waitcnt vmcnt(13)
  v_add_f32 v24, v24, v40
  v_add_f32 v25, v25, v41
  v_add_f32 v26, v26, v42
  v_add_f32 v27, v27, v43
  s_waitcnt vmcnt(12)
  v_add_f32 v24, v24, v44
  v_add_f32 v25, v25, v45
  v_add_f32 v26, v26, v46
  v_add_f32 v27, v27, v47
  s_waitcnt vmcnt(11)
  v_add_f32 v24, v24, v48
  v_add_f32 v25, v25, v49
  v_add_f32 v26, v26, v50
  v_add_f32 v27, v27, v51
  s_waitcnt vmcnt(10)
  v_add_f32 v24, v24, v52
  v_add_f32 v25, v25, v53
  v_add_f32 v26, v26, v54
  v_add_f32 v27, v27, v55
  s_waitcnt vmcnt(9)
  v_add_f32 v24, v24, v56
  v_add_f32 v25, v25, v57
  v_add_f32 v26, v26, v58
  v_add_f32 v27, v27, v59
  s_mov_b32 exec_hi, 0xf
  ds_write_b128 v18, v[24:27]
  s_mov_b32 exec_hi, -1
  s_waitcnt lgkmcnt(0)
  s_barrier
  s_mov_b32 s22, 0
  s_mov_b32 s49, 0
  s_waitcnt vmcnt(0)
  s_barrier
  s_add_u32 s21, s21, 36864
  s_add_u32 s33, s23, 73728
  s_add_u32 m0, s33, 0
  s_add_u32 s34, s21, 0
  buffer_load_dwordx4 v1, s[24:27], s34 offen offset:0 lds
  buffer_load_dwordx4 v1, s[24:27], s34 offen offset:1024 lds
  buffer_load_dwordx4 v1, s[24:27], s34 offen offset:2048 lds
  buffer_load_dwordx4 v1, s[24:27], s34 offen offset:3072 lds
  s_add_u32 m0, s33, 4096
  s_add_u32 s34, s21, 4096
  buffer_load_dwordx4 v1, s[24:27], s34 offen offset:0 lds
  buffer_load_dwordx4 v1, s[24:27], s34 offen offset:1024 lds
  buffer_load_dwordx4 v1, s[24:27], s34 offen offset:2048 lds
  buffer_load_dwordx4 v1, s[24:27], s34 offen offset:3072 lds
  s_add_u32 m0, s33, 8192
  s_add_u32 s34, s21, 8192
  buffer_load_dwordx4 v1, s[24:27], s34 offen offset:0 lds
  s_xor_b32 s22, s22, 73728
  s_add_u32 s33, s22, 36864
  s_add_u32 s33, s33, s23
  s_add_u32 s21, s21, 36864
  s_add_u32 m0, s33, 0
  s_add_u32 s34, s21, 0
  buffer_load_dwordx4 v1, s[24:27], s34 offen offset:0 lds
  buffer_load_dwordx4 v1, s[24:27], s34 offen offset:1024 lds
  buffer_load_dwordx4 v1, s[24:27], s34 offen offset:2048 lds
  buffer_load_dwordx4 v1, s[24:27], s34 offen offset:3072 lds
  s_add_u32 m0, s33, 4096
  s_add_u32 s34, s21, 4096
  buffer_load_dwordx4 v1, s[24:27], s34 offen offset:0 lds
  buffer_load_dwordx4 v1, s[24:27], s34 offen offset:1024 lds
  buffer_load_dwordx4 v1, s[24:27], s34 offen offset:2048 lds
  buffer_load_dwordx4 v1, s[24:27], s34 offen offset:3072 lds
  s_add_u32 m0, s33, 8192
  s_add_u32 s34, s21, 8192
  buffer_load_dwordx4 v1, s[24:27], s34 offen offset:0 lds
  s_waitcnt vmcnt(9)
  s_barrier
  s_xor_b32 s33, s22, 73728
  s_add_u32 s33, s33, s23
  s_add_u32 s21, s21, 36864
  s_add_u32 m0, s33, 0
  s_add_u32 s34, s21, 0
  buffer_load_dwordx4 v1, s[24:27], s34 offen offset:0 lds
  buffer_load_dwordx4 v1, s[24:27], s34 offen offset:1024 lds
  buffer_load_dwordx4 v1, s[24:27], s34 offen offset:2048 lds
  buffer_load_dwordx4 v1, s[24:27], s34 offen offset:3072 lds
  s_add_u32 m0, s33, 4096
  s_add_u32 s34, s21, 4096
  buffer_load_dwordx4 v1, s[24:27], s34 offen offset:0 lds
  buffer_load_dwordx4 v1, s[24:27], s34 offen offset:1024 lds
  buffer_load_dwordx4 v1, s[24:27], s34 offen offset:2048 lds
  buffer_load_dwordx4 v1, s[24:27], s34 offen offset:3072 lds
  s_add_u32 m0, s33, 8192
  s_add_u32 s34, s21, 8192
  buffer_load_dwordx4 v1, s[24:27], s34 offen offset:0 lds
  s_mov_b32 s49, 1
FF_PLOOP1:
  s_waitcnt vmcnt(9)
  s_barrier
  s_xor_b32 s22, s22, 73728
  s_add_u32 s33, s22, 36864
  s_add_u32 s33, s33, s23
  s_add_u32 s21, s21, 36864
  s_add_u32 m0, s33, 0
  s_add_u32 s34, s21, 0
  buffer_load_dwordx4 v1, s[24:27], s34 offen offset:0 lds
  buffer_load_dwordx4 v1, s[24:27], s34 offen offset:1024 lds
  buffer_load_dwordx4 v1, s[24:27], s34 offen offset:2048 lds
  buffer_load_dwordx4 v1, s[24:27], s34 offen offset:3072 lds
  s_add_u32 m0, s33, 4096
  s_add_u32 s34, s21, 4096
  buffer_load_dwordx4 v1, s[24:27], s34 offen offset:0 lds
  buffer_load_dwordx4 v1, s[24:27], s34 offen offset:1024 lds
  buffer_load_dwordx4 v1, s[24:27], s34 offen offset:2048 lds
  buffer_load_dwordx4 v1, s[24:27], s34 offen offset:3072 lds
  s_add_u32 m0, s33, 8192
  s_add_u32 s34, s21, 8192
  buffer_load_dwordx4 v1, s[24:27], s34 offen offset:0 lds
  s_waitcnt vmcnt(9)
  s_barrier
  s_xor_b32 s33, s22, 73728
  s_add_u32 s33, s33, s23
  s_add_u32 s21, s21, 36864
  s_add_u32 m0, s33, 0
  s_add_u32 s34, s21, 0
  buffer_load_dwordx4 v1, s[24:27], s34 offen offset:0 lds
  buffer_load_dwordx4 v1, s[24:27], s34 offen offset:1024 lds
  buffer_load_dwordx4 v1, s[24:27], s34 offen offset:2048 lds
  buffer_load_dwordx4 v1, s[24:27], s34 offen offset:3072 lds
  s_add_u32 m0, s33, 4096
  s_add_u32 s34, s21, 4096
  buffer_load_dwordx4 v1, s[24:27], s34 offen offset:0 lds
  buffer_load_dwordx4 v1, s[24:27], s34 offen offset:1024 lds
  buffer_load_dwordx4 v1, s[24:27], s34 offen offset:2048 lds
  buffer_load_dwordx4 v1, s[24:27], s34 offen offset:3072 lds
  s_add_u32 m0, s33, 8192
  s_add_u32 s34, s21, 8192
  buffer_load_dwordx4 v1, s[24:27], s34 offen offset:0 lds
  s_add_u32 s49, s49, 1
  s_cmp_le_u32 s49, 6
  s_cbranch_scc1 FF_PLOOP1
  buffer_load_dword v20, off, s[60:63], s56 sc0 sc1
  s_waitcnt vmcnt(10)
  s_barrier
  s_add_u32 s33, s23, 36864
  s_add_u32 s21, s21, 36864
  s_add_u32 m0, s33, 0
  s_add_u32 s34, s21, 0
  buffer_load_dwordx4 v1, s[24:27], s34 offen offset:0 lds
  buffer_load_dwordx4 v1, s[24:27], s34 offen offset:1024 lds
  buffer_load_dwordx4 v1, s[24:27], s34 offen offset:2048 lds
  buffer_load_dwordx4 v1, s[24:27], s34 offen offset:3072 lds
  s_add_u32 m0, s33, 4096
  s_add_u32 s34, s21, 4096
  buffer_load_dwordx4 v1, s[24:27], s34 offen offset:0 lds
  buffer_load_dwordx4 v1, s[24:27], s34 offen offset:1024 lds
  buffer_load_dwordx4 v1, s[24:27], s34 offen offset:2048 lds
  buffer_load_dwordx4 v1, s[24:27], s34 offen offset:3072 lds
  s_add_u32 m0, s33, 8192
  s_add_u32 s34, s21, 8192
  buffer_load_dwordx4 v1, s[24:27], s34 offen offset:0 lds
  s_mov_b32 s35, s29
  s_mul_i32 s47, s16, 5
  s_cmp_eq_u32 s16, 3
  s_cselect_b32 s33, 1, 0
  s_sub_u32 s47, s47, s33
  s_lshl_b32 s47, s47, 10
  s_lshl_b32 s48, s16, 12
  s_add_u32 s48, s48, 18432
  s_mul_i32 s21, s20, 331776
  s_add_u32 s21, s21, s47
  s_add_u32 s21, s21, 0xb00000
  s_waitcnt vmcnt(10)
  s_waitcnt vmcnt(9)
  s_barrier
  v_readfirstlane_b32 s55, v20
  s_bfe_u32 s55, s55, 0x80000
  s_cmp_eq_u32 s55, 4
  s_cbranch_scc0 FF_SP1
FF_SP1_B:
  s_mov_b32 s33, 73728
  s_add_u32 m0, s33, s47
  s_nop 0
  buffer_load_dwordx4 v1, s[24:27], s21 offen offset:0 lds
  buffer_load_dwordx4 v1, s[24:27], s21 offen offset:1024 lds
  buffer_load_dwordx4 v1, s[24:27], s21 offen offset:2048 lds
  buffer_load_dwordx4 v1, s[24:27], s21 offen offset:3072 lds
  s_add_u32 m0, s33, s48
  s_nop 0
  buffer_load_dwordx4 v1, s[36:39], s35 offen offset:0 lds
  buffer_load_dwordx4 v1, s[36:39], s35 offen offset:1024 lds
  buffer_load_dwordx4 v1, s[36:39], s35 offen offset:2048 lds
  buffer_load_dwordx4 v1, s[36:39], s35 offen offset:3072 lds
  s_cmp_ge_u32 s16, 2
  s_cbranch_scc1 FF_D0
  s_add_u32 s34, s33, s47
  s_add_u32 m0, s34, 4096
  s_add_u32 s34, s21, 4096
  buffer_load_dwordx4 v1, s[24:27], s34 offen lds
FF_D0:
  s_add_u32 s21, s21, 18432
  s_add_u32 s35, s35, 4096
  s_waitcnt vmcnt(8)
  s_barrier
  s_mov_b32 s33, 110592
  s_add_u32 m0, s33, s47
  s_nop 0
  buffer_load_dwordx4 v1, s[24:27], s21 offen offset:0 lds
  buffer_load_dwordx4 v1, s[24:27], s21 offen offset:1024 lds
  buffer_load_dwordx4 v1, s[24:27], s21 offen offset:2048 lds
  buffer_load_dwordx4 v1, s[24:27], s21 offen offset:3072 lds
  s_add_u32 m0, s33, s48
  s_nop 0
  buffer_load_dwordx4 v1, s[36:39], s35 offen offset:0 lds
  buffer_load_dwordx4 v1, s[36:39], s35 offen offset:1024 lds
  buffer_load_dwordx4 v1, s[36:39], s35 offen offset:2048 lds
  buffer_load_dwordx4 v1, s[36:39], s35 offen offset:3072 lds
  s_cmp_ge_u32 s16, 2
  s_cbranch_scc1 FF_D1
  s_add_u32 s34, s33, s47
  s_add_u32 m0, s34, 4096
  s_add_u32 s34, s21, 4096
  buffer_load_dwordx4 v1, s[24:27], s34 offen lds
FF_D1:
  s_add_u32 s21, s21, 18432
  s_add_u32 s35, s35, 4096
  s_waitcnt vmcnt(8)
  s_barrier
  s_mov_b32 s33, 0
  s_add_u32 m0, s33, s47
  s_nop 0
  buffer_load_dwordx4 v1, s[24:27], s21 offen offset:0 lds
  buffer_load_dwordx4 v1, s[24:27], s21 offen offset:1024 lds
  buffer_load_dwordx4 v1, s[24:27], s21 offen offset:2048 lds
  buffer_load_dwordx4 v1, s[24:27], s21 offen offset:3072 lds
  s_add_u32 m0, s33, s48
  s_nop 0
  buffer_load_dwordx4 v1, s[36:39], s35 offen offset:0 lds
  buffer_load_dwordx4 v1, s[36:39], s35 offen offset:1024 lds
  buffer_load_dwordx4 v1, s[36:39], s35 offen offset:2048 lds
  buffer_load_dwordx4 v1, s[36:39], s35 offen offset:3072 lds
  s_cmp_ge_u32 s16, 2
  s_cbranch_scc1 FF_D2
  s_add_u32 s34, s33, s47
  s_add_u32 m0, s34, 4096
  s_add_u32 s34, s21, 4096
  buffer_load_dwordx4 v1, s[24:27], s34 offen lds
FF_D2:
  s_add_u32 s21, s21, 18432
  s_add_u32 s35, s35, 4096
  s_barrier
  s_mov_b32 s33, 36864
  s_add_u32 m0, s33, s47
  s_nop 0
  buffer_load_dwordx4 v1, s[24:27], s21 offen offset:0 lds
  buffer_load_dwordx4 v1, s[24:27], s21 offen offset:1024 lds
  buffer_load_dwordx4 v1, s[24:27], s21 offen offset:2048 lds
  buffer_load_dwordx4 v1, s[24:27], s21 offen offset:3072 lds
  s_add_u32 m0, s33, s48
  s_nop 0
  buffer_load_dwordx4 v1, s[36:39], s35 offen offset:0 lds
  buffer_load_dwordx4 v1, s[36:39], s35 offen offset:1024 lds
  buffer_load_dwordx4 v1, s[36:39], s35 offen offset:2048 lds
  buffer_load_dwordx4 v1, s[36:39], s35 offen offset:3072 lds
  s_cmp_ge_u32 s16, 2
  s_cbranch_scc1 FF_D3
  s_add_u32 s34, s33, s47
  s_add_u32 m0, s34, 4096
  s_add_u32 s34, s21, 4096
  buffer_load_dwordx4 v1, s[24:27], s34 offen lds
FF_D3:
  s_add_u32 s21, s21, 18432
  s_add_u32 s35, s35, 4096
  s_mov_b32 s33, 73728
  s_mov_b32 s49, 0
  s_mov_b32 s50, 0x1200000
  s_mov_b32 s51, 0x1200000
  s_cmp_lg_u32 s97, 0
  s_cselect_b32 s51, 0, s51
FF_PLOOP2:
  s_waitcnt vmcnt(16)
  s_barrier
  s_cmp_eq_u32 s49, 4
  s_cbranch_scc1 FF_CK2
FF_CK2_B:
  s_cmp_eq_u32 s49, 10
  s_cbranch_scc1 FF_CK3
FF_CK3_B:
  s_cmp_eq_u32 s49, 2
  s_cbranch_scc1 FF_FL
  s_cmp_eq_u32 s49, 8
  s_cbranch_scc1 FF_FL
FF_FL_B:
  s_cmp_le_u32 s49, 13
  s_cselect_b32 s26, s50, 0
  s_cselect_b32 s38, s51, 0
  s_add_u32 m0, s33, s47
  s_nop 0
  buffer_load_dwordx4 v1, s[24:27], s21 offen offset:0 lds
  buffer_load_dwordx4 v1, s[24:27], s21 offen offset:1024 lds
  buffer_load_dwordx4 v1, s[24:27], s21 offen offset:2048 lds
  buffer_load_dwordx4 v1, s[24:27], s21 offen offset:3072 lds
  s_add_u32 m0, s33, s48
  s_nop 0
  buffer_load_dwordx4 v1, s[36:39], s35 offen offset:0 lds
  buffer_load_dwordx4 v1, s[36:39], s35 offen offset:1024 lds
  buffer_load_dwordx4 v1, s[36:39], s35 offen offset:2048 lds
  buffer_load_dwordx4 v1, s[36:39], s35 offen offset:3072 lds
  s_cmp_ge_u32 s16, 2
  s_cbranch_scc1 FF_D4
  s_add_u32 s34, s33, s47
  s_add_u32 m0, s34, 4096
  s_add_u32 s34, s21, 4096
  buffer_load_dwordx4 v1, s[24:27], s34 offen lds
FF_D4:
  s_add_u32 s21, s21, 18432
  s_add_u32 s35, s35, 4096
  s_add_u32 s33, s33, 36864
  s_cmp_eq_u32 s33, 147456
  s_cselect_b32 s33, 0, s33
  s_add_u32 s49, s49, 1
  s_cmp_le_u32 s49, 17
  s_cbranch_scc1 FF_PLOOP2
  s_waitcnt vmcnt(0)
  s_branch M_EXIT
FF_FL:
  buffer_load_dword v20, off, s[60:63], s56 sc0 sc1
  s_branch FF_FL_B
FF_CK2:
  s_waitcnt vmcnt(0)
  v_readfirstlane_b32 s55, v20
  s_bfe_u32 s55, s55, 0x80008
  s_cmp_eq_u32 s55, 4
  s_cbranch_scc1 FF_CK2_B
  s_branch FF_SP2
FF_CK3:
  v_readfirstlane_b32 s55, v20
  s_bfe_u32 s55, s55, 0x80010
  s_cmp_eq_u32 s55, 4
  s_cbranch_scc1 FF_CK3_B
  s_branch FF_SP3
FF_SP1:
  s_mov_b32 s8, s96
FF_SPL1:
  buffer_load_dword v20, off, s[60:63], s56 sc0 sc1
  s_waitcnt vmcnt(0)
  v_readfirstlane_b32 s55, v20
  s_bfe_u32 s55, s55, 0x80000
  s_cmp_eq_u32 s55, 4
  s_cbranch_scc1 FF_SPL1_OK
  s_sub_u32 s8, s8, 1
  s_cmp_lg_u32 s8, 0
  s_cbranch_scc1 FF_SPL1
  s_cmp_lg_u32 s97, 0
  s_cbranch_scc1 M_FL8
  s_mov_b32 s97, 1
  s_mov_b32 s96, 1
  s_mov_b64 exec, 1
  v_mov_b32 v254, 1
  s_mov_b32 s6, 98432
  buffer_atomic_add v254, off, s[60:63], s6 sc0 sc1
  s_waitcnt vmcnt(0)
  v_readfirstlane_b32 s6, v254
  s_cmp_eq_u32 s6, 0
  s_cselect_b32 s6, 1, 0
  v_mov_b32 v254, 163832
  v_mov_b32 v255, 1
  ds_write_b32 v254, v255
  v_mov_b32 v255, s6
  ds_or_b32 v254, v255 offset:4
  s_waitcnt lgkmcnt(0)
  s_mov_b64 exec, -1
M_FL8:
  s_mov_b32 s38, 0
  s_mov_b32 s51, 0
FF_SPL1_OK:
  s_branch FF_SP1_B
FF_SP2:
  s_mov_b32 s8, s96
FF_SPL2:
  buffer_load_dword v20, off, s[60:63], s56 sc0 sc1
  s_waitcnt vmcnt(0)
  v_readfirstlane_b32 s55, v20
  s_bfe_u32 s55, s55, 0x80008
  s_cmp_eq_u32 s55, 4
  s_cbranch_scc1 FF_SPL2_OK
  s_sub_u32 s8, s8, 1
  s_cmp_lg_u32 s8, 0
  s_cbranch_scc1 FF_SPL2
  s_cmp_lg_u32 s97, 0
  s_cbranch_scc1 M_FL9
  s_mov_b32 s97, 1
  s_mov_b32 s96, 1
  s_mov_b64 exec, 1
  v_mov_b32 v254, 1
  s_mov_b32 s6, 98432
  buffer_atomic_add v254, off, s[60:63], s6 sc0 sc1
  s_waitcnt vmcnt(0)
  v_readfirstlane_b32 s6, v254
  s_cmp_eq_u32 s6, 0
  s_cselect_b32 s6, 1, 0
  v_mov_b32 v254, 163832
  v_mov_b32 v255, 1
  ds_write_b32 v254, v255
  v_mov_b32 v255, s6
  ds_or_b32 v254, v255 offset:4
  s_waitcnt lgkmcnt(0)
  s_mov_b64 exec, -1
M_FL9:
  s_mov_b32 s38, 0
  s_mov_b32 s51, 0
FF_SPL2_OK:
  s_branch FF_CK2_B
FF_SP3:
  s_mov_b32 s8, s96
FF_SPL3:
  buffer_load_dword v20, off, s[60:63], s56 sc0 sc1
  s_waitcnt vmcnt(0)
  v_readfirstlane_b32 s55, v20
  s_bfe_u32 s55, s55, 0x80010
  s_cmp_eq_u32 s55, 4
  s_cbranch_scc1 FF_SPL3_OK
  s_sub_u32 s8, s8, 1
  s_cmp_lg_u32 s8, 0
  s_cbranch_scc1 FF_SPL3
  s_cmp_lg_u32 s97, 0
  s_cbranch_scc1 M_FL10
  s_mov_b32 s97, 1
  s_mov_b32 s96, 1
  s_mov_b64 exec, 1
  v_mov_b32 v254, 1
  s_mov_b32 s6, 98432
  buffer_atomic_add v254, off, s[60:63], s6 sc0 sc1
  s_waitcnt vmcnt(0)
  v_readfirstlane_b32 s6, v254
  s_cmp_eq_u32 s6, 0
  s_cselect_b32 s6, 1, 0
  v_mov_b32 v254, 163832
  v_mov_b32 v255, 1
  ds_write_b32 v254, v255
  v_mov_b32 v255, s6
  ds_or_b32 v254, v255 offset:4
  s_waitcnt lgkmcnt(0)
  s_mov_b64 exec, -1
M_FL10:
  s_mov_b32 s38, 0
  s_mov_b32 s51, 0
FF_SPL3_OK:
  s_branch FF_CK3_B
M_EXIT:
  s_waitcnt lgkmcnt(0)
  s_barrier
  v_mov_b32 v254, 163836
  ds_read_b32 v254, v254
  s_waitcnt lgkmcnt(0)
  v_readfirstlane_b32 s6, v254
  s_cmp_lg_u32 s6, 0
  s_cbranch_scc1 M_SERIAL
M_END:
  s_endpgm
M_SERIAL:
  s_mov_b32 s99, s17
  s_setprio 0
  s_add_u32 s60, s12, 0x730000
  s_addc_u32 s61, s13, 0
  s_mov_b32 s62, 0x20400
  s_mov_b32 s63, 0x00020000
  v_and_b32 v20, 63, v0
  v_lshlrev_b32 v20, 7, v20
  s_mov_b32 s33, 65536
  s_mov_b32 s8, 2000000
M_SW:
  buffer_load_dword v24, v20, s[60:63], s33 offen sc0 sc1
  v_add_u32 v20, 8192, v20
  buffer_load_dword v25, v20, s[60:63], s33 offen sc0 sc1
  v_add_u32 v20, 8192, v20
  buffer_load_dword v26, v20, s[60:63], s33 offen sc0 sc1
  v_add_u32 v20, 8192, v20
  buffer_load_dword v27, v20, s[60:63], s33 offen sc0 sc1
  v_add_u32 v20, 4294942720, v20
  s_waitcnt vmcnt(0)
  v_min_u32 v24, v24, v25
  v_min_u32 v26, v26, v27
  v_min_u32 v24, v24, v26
  v_cmp_eq_u32 s[6:7], 0, v24
  s_cmp_eq_u64 s[6:7], 0
  s_cbranch_scc1 M_SW_OK
  s_sub_u32 s8, s8, 1
  s_cmp_lg_u32 s8, 0
  s_cbranch_scc1 M_SW
  s_endpgm
M_SW_OK:
  s_mov_b32 s100, 0
  s_mov_b32 s101, 0
  s_branch FB_GO
FB_NEXT:
  s_mov_b64 exec, -1
  s_waitcnt vmcnt(0) lgkmcnt(0)
  s_barrier
  s_add_u32 s101, s101, 1
  s_cmp_eq_u32 s100, 0
  s_mov_b32 s6, 256
  s_cselect_b32 s6, 206, s6
  s_cmp_lt_u32 s101, s6
  s_cbranch_scc1 FB_GO
  s_add_u32 s100, s100, 1
  s_mov_b32 s101, 0
  s_cmp_lt_u32 s100, 3
  s_cbranch_scc1 FB_GO
  s_endpgm
FB_GO:
  s_mov_b32 s2, s101
  v_mbcnt_lo_u32_b32 v0, -1, 0
  v_mbcnt_hi_u32_b32 v0, -1, v0
  s_lshl_b32 s6, s99, 6
  v_add_u32 v0, s6, v0
  s_cmp_eq_u32 s100, 0
  s_cbranch_scc1 FB_K3
  s_cmp_eq_u32 s100, 1
  s_cbranch_scc1 FB_F1
  s_branch FB_F2
FB_K3:
  s_load_dwordx2 s[4:5], s[0:1], 0
  s_load_dwordx2 s[12:13], s[0:1], 88
  s_cmp_ge_u32 s2, 192
  s_cbranch_scc1 K3_CT
  v_and_b32 v1, 63, v0
  v_lshrrev_b32 v10, 6, v0
  s_nop 0
  v_readfirstlane_b32 s16, v10
  s_and_b32 s19, s16, 3
  s_lshr_b32 s20, s16, 2
  s_and_b32 s21, s2, 7
  s_lshr_b32 s22, s2, 3
  s_and_b32 s22, s22, 3
  s_lshl_b32 s22, s22, 3
  s_add_u32 s17, s21, s22
  s_lshr_b32 s18, s2, 5
  v_and_b32 v3, 15, v1
  v_lshrrev_b32 v2, 4, v1
  s_lshl_b32 s23, s17, 2
  s_add_u32 s23, s23, s19
  s_lshl_b32 s33, s23, 4
  v_add_u32 v4, s33, v3
  v_lshlrev_b32 v5, 4, v1
  s_mul_i32 s34, s23, 18432
  s_mul_i32 s33, s20, 9216
  s_add_u32 s34, s34, s33
  s_add_u32 s33, s16, 0
  s_cmp_ge_u32 s33, 18
  s_cselect_b32 s35, 1, 0
  s_mul_i32 s36, s35, 18
  s_sub_u32 s33, s33, s36
  s_mul_i32 s36, s33, 43
  s_lshr_b32 s36, s36, 7
  s_mul_i32 s37, s36, 3
  s_sub_u32 s33, s33, s37
  s_mul_i32 s35, s35, 9
  s_add_u32 s33, s33, s35
  s_lshl_b32 s33, s33, 10
  s_mul_i32 s36, s36, 18432
  s_add_u32 s44, s33, s36
  s_add_u32 s33, s16, 8
  s_cmp_ge_u32 s33, 18
  s_cselect_b32 s35, 1, 0
  s_mul_i32 s36, s35, 18
  s_sub_u32 s33, s33, s36
  s_mul_i32 s36, s33, 43
  s_lshr_b32 s36, s36, 7
  s_mul_i32 s37, s36, 3
  s_sub_u32 s33, s33, s37
  s_mul_i32 s35, s35, 9
  s_add_u32 s33, s33, s35
  s_lshl_b32 s33, s33, 10
  s_mul_i32 s36, s36, 18432
  s_add_u32 s45, s33, s36
  s_add_u32 s33, s16, 16
  s_cmp_ge_u32 s33, 18
  s_cselect_b32 s35, 1, 0
  s_mul_i32 s36, s35, 18
  s_sub_u32 s33, s33, s36
  s_mul_i32 s36, s33, 43
  s_lshr_b32 s36, s36, 7
  s_mul_i32 s37, s36, 3
  s_sub_u32 s33, s33, s37
  s_mul_i32 s35, s35, 9
  s_add_u32 s33, s33, s35
  s_lshl_b32 s33, s33, 10
  s_mul_i32 s36, s36, 18432
  s_add_u32 s46, s33, s36
  s_add_u32 s33, s16, 24
  s_cmp_ge_u32 s33, 18
  s_cselect_b32 s35, 1, 0
  s_mul_i32 s36, s35, 18
  s_sub_u32 s33, s33, s36
  s_mul_i32 s36, s33, 43
  s_lshr_b32 s36, s36, 7
  s_mul_i32 s37, s36, 3
  s_sub_u32 s33, s33, s37
  s_mul_i32 s35, s35, 9
  s_add_u32 s33, s33, s35
  s_lshl_b32 s33, s33, 10
  s_mul_i32 s36, s36, 18432
  s_add_u32 s47, s33, s36
  s_add_u32 s33, s16, 32
  s_cmp_ge_u32 s33, 36
  s_cselect_b32 s33, s16, s33
  s_cmp_ge_u32 s33, 18
  s_cselect_b32 s35, 1, 0
  s_mul_i32 s36, s35, 18
  s_sub_u32 s33, s33, s36
  s_mul_i32 s36, s33, 43
  s_lshr_b32 s36, s36, 7
  s_mul_i32 s37, s36, 3
  s_sub_u32 s33, s33, s37
  s_mul_i32 s35, s35, 9
  s_add_u32 s33, s33, s35
  s_lshl_b32 s33, s33, 10
  s_mul_i32 s36, s36, 18432
  s_add_u32 s48, s33, s36
  s_mul_i32 s49, s18, 110592
  s_add_u32 s49, s49, 0x1040000
  s_waitcnt lgkmcnt(0)
  s_mov_b32 s24, s4
  s_mov_b32 s25, s5
  s_mov_b32 s26, 0x240000
  s_mov_b32 s27, 0x00020000
  s_add_u32 s28, s12, 0x4000000
  s_addc_u32 s29, s13, 0
  s_mov_b32 s30, 0x1200000
  s_mov_b32 s31, 0x00020000
  s_add_u32 s36, s12, 0x280000
  s_addc_u32 s37, s13, 0
  s_mov_b32 s38, 0x240000
  s_mov_b32 s39, 0x00020000
  s_add_u32 s40, s12, 0x64c0000
  s_addc_u32 s41, s13, 0
  s_mov_b32 s42, 0x340000
  s_mov_b32 s43, 0x00020000
  buffer_load_dwordx4 v[32:35], v5, s[36:39], s34 offen offset:0 sc0 sc1
  buffer_load_dwordx4 v[36:39], v5, s[36:39], s34 offen offset:1024 sc0 sc1
  buffer_load_dwordx4 v[40:43], v5, s[36:39], s34 offen offset:2048 sc0 sc1
  s_add_u32 s34, s34, 3072
  s_add_u32 m0, s44, 0
  s_add_u32 s33, m0, s49
  buffer_load_dwordx4 v5, s[28:31], s33 offen sc0 sc1 lds
  s_add_u32 m0, s45, 0
  s_add_u32 s33, m0, s49
  buffer_load_dwordx4 v5, s[28:31], s33 offen sc0 sc1 lds
  s_add_u32 m0, s46, 0
  s_add_u32 s33, m0, s49
  buffer_load_dwordx4 v5, s[28:31], s33 offen sc0 sc1 lds
  s_add_u32 m0, s47, 0
  s_add_u32 s33, m0, s49
  buffer_load_dwordx4 v5, s[28:31], s33 offen sc0 sc1 lds
  s_add_u32 m0, s48, 0
  s_add_u32 s33, m0, s49
  buffer_load_dwordx4 v5, s[28:31], s33 offen sc0 sc1 lds
  s_barrier
  buffer_load_dwordx4 v[44:47], v5, s[36:39], s34 offen offset:0 sc0 sc1
  buffer_load_dwordx4 v[48:51], v5, s[36:39], s34 offen offset:1024 sc0 sc1
  buffer_load_dwordx4 v[52:55], v5, s[36:39], s34 offen offset:2048 sc0 sc1
  s_add_u32 s34, s34, 3072
  s_add_u32 m0, s44, 3072
  s_add_u32 s33, m0, s49
  buffer_load_dwordx4 v5, s[28:31], s33 offen sc0 sc1 lds
  s_add_u32 m0, s45, 3072
  s_add_u32 s33, m0, s49
  buffer_load_dwordx4 v5, s[28:31], s33 offen sc0 sc1 lds
  s_add_u32 m0, s46, 3072
  s_add_u32 s33, m0, s49
  buffer_load_dwordx4 v5, s[28:31], s33 offen sc0 sc1 lds
  s_add_u32 m0, s47, 3072
  s_add_u32 s33, m0, s49
  buffer_load_dwordx4 v5, s[28:31], s33 offen sc0 sc1 lds
  s_add_u32 m0, s48, 3072
  s_add_u32 s33, m0, s49
  buffer_load_dwordx4 v5, s[28:31], s33 offen sc0 sc1 lds
  s_mul_i32 s33, s18, 192
  s_mul_i32 s35, s20, 96
  s_add_u32 s50, s33, s35
  v_mul_u32_u24 v10, 1152, v4
  v_lshl_add_u32 v11, v2, 3, v10
  s_mul_i32 s33, s20, 9216
  v_add_u32 v6, s33, v5
  s_mul_i32 s33, s19, 6144
  s_add_u32 s33, s33, 110592
  v_add_u32 v7, s33, v5
  v_mov_b32 v30, 0x3f803f80
  s_mul_i32 s51, s23, 18432
  s_mul_i32 s33, s18, 6
  s_mul_i32 s35, s20, 3
  s_add_u32 s33, s33, s35
  s_lshl_b32 s33, s33, 9
  s_add_u32 s51, s51, s33
  v_lshrrev_b32 v12, 1, v2
  v_lshlrev_b32 v12, 8, v12
  v_lshl_add_u32 v13, v3, 4, v12
  v_and_b32 v12, 1, v2
  v_lshl_add_u32 v8, v12, 3, v13
  s_waitcnt vmcnt(8)
  s_barrier
  buffer_load_dwordx4 v[56:59], v5, s[36:39], s34 offen offset:0 sc0 sc1
  buffer_load_dwordx4 v[60:63], v5, s[36:39], s34 offen offset:1024 sc0 sc1
  buffer_load_dwordx4 v[64:67], v5, s[36:39], s34 offen offset:2048 sc0 sc1
  s_add_u32 s34, s34, 3072
  s_add_u32 m0, s44, 6144
  s_add_u32 s33, m0, s49
  buffer_load_dwordx4 v5, s[28:31], s33 offen sc0 sc1 lds
  s_add_u32 m0, s45, 6144
  s_add_u32 s33, m0, s49
  buffer_load_dwordx4 v5, s[28:31], s33 offen sc0 sc1 lds
  s_add_u32 m0, s46, 6144
  s_add_u32 s33, m0, s49
  buffer_load_dwordx4 v5, s[28:31], s33 offen sc0 sc1 lds
  s_add_u32 m0, s47, 6144
  s_add_u32 s33, m0, s49
  buffer_load_dwordx4 v5, s[28:31], s33 offen sc0 sc1 lds
  s_add_u32 m0, s48, 6144
  s_add_u32 s33, m0, s49
  buffer_load_dwordx4 v5, s[28:31], s33 offen sc0 sc1 lds
  buffer_load_dwordx2 v[128:129], v11, s[24:27], s50 offen offset:0 sc0 sc1
  buffer_load_dwordx2 v[130:131], v11, s[24:27], s50 offen offset:32 sc0 sc1
  buffer_load_dwordx2 v[132:133], v11, s[24:27], s50 offen offset:64 sc0 sc1
  v_add_u32 v9, 55296, v6
  ds_read_b128 v[72:75], v6 offset:0
  ds_read_b128 v[76:79], v6 offset:18432
  ds_read_b128 v[80:83], v6 offset:36864
  ds_read_b128 v[84:87], v6 offset:55296
  ds_read_b128 v[88:91], v9 offset:18432
  ds_read_b128 v[92:95], v9 offset:36864
  ds_read_b128 v[96:99], v6 offset:1024
  s_waitcnt lgkmcnt(6)
  v_mfma_f32_16x16x32_bf16 v[104:107], v[72:75], v[32:35], 0
  ds_read_b128 v[100:103], v6 offset:19456
  s_waitcnt lgkmcnt(6)
  v_mfma_f32_16x16x32_bf16 v[108:111], v[76:79], v[32:35], 0
  ds_read_b128 v[72:75], v6 offset:37888
  s_waitcnt lgkmcnt(6)
  v_mfma_f32_16x16x32_bf16 v[112:115], v[80:83], v[32:35], 0
  ds_read_b128 v[76:79], v6 offset:56320
  s_waitcnt lgkmcnt(6)
  v_mfma_f32_16x16x32_bf16 v[116:119], v[84:87], v[32:35], 0
  ds_read_b128 v[80:83], v9 offset:19456
  s_waitcnt lgkmcnt(6)
  v_mfma_f32_16x16x32_bf16 v[120:123], v[88:91], v[32:35], 0
  ds_read_b128 v[84:87], v9 offset:37888
  s_waitcnt lgkmcnt(6)
  v_mfma_f32_16x16x32_bf16 v[124:127], v[92:95], v[32:35], 0
  ds_read_b128 v[88:91], v6 offset:2048
  s_waitcnt lgkmcnt(6)
  v_mfma_f32_16x16x32_bf16 v[104:107], v[96:99], v[36:39], v[104:107]
  ds_read_b128 v[92:95], v6 offset:20480
  s_waitcnt lgkmcnt(6)
  v_mfma_f32_16x16x32_bf16 v[108:111], v[100:103], v[36:39], v[108:111]
  ds_read_b128 v[96:99], v6 offset:38912
  s_waitcnt lgkmcnt(6)
  v_mfma_f32_16x16x32_bf16 v[112:115], v[72:75], v[36:39], v[112:115]
  ds_read_b128 v[100:103], v6 offset:57344
  s_waitcnt lgkmcnt(6)
  v_mfma_f32_16x16x32_bf16 v[116:119], v[76:79], v[36:39], v[116:119]
  ds_read_b128 v[72:75], v9 offset:20480
  s_waitcnt lgkmcnt(6)
  v_mfma_f32_16x16x32_bf16 v[120:123], v[80:83], v[36:39], v[120:123]
  ds_read_b128 v[76:79], v9 offset:38912
  s_waitcnt lgkmcnt(6)
  v_mfma_f32_16x16x32_bf16 v[124:127], v[84:87], v[36:39], v[124:127]
  s_waitcnt lgkmcnt(5)
  v_mfma_f32_16x16x32_bf16 v[104:107], v[88:91], v[40:43], v[104:107]
  s_waitcnt lgkmcnt(4)
  v_mfma_f32_16x16x32_bf16 v[108:111], v[92:95], v[40:43], v[108:111]
  s_waitcnt lgkmcnt(3)
  v_mfma_f32_16x16x32_bf16 v[112:115], v[96:99], v[40:43], v[112:115]
  s_waitcnt lgkmcnt(2)
  v_mfma_f32_16x16x32_bf16 v[116:119], v[100:103], v[40:43], v[116:119]
  s_waitcnt lgkmcnt(1)
  v_mfma_f32_16x16x32_bf16 v[120:123], v[72:75], v[40:43], v[120:123]
  s_waitcnt lgkmcnt(0)
  v_mfma_f32_16x16x32_bf16 v[124:127], v[76:79], v[40:43], v[124:127]
  s_waitcnt vmcnt(11)
  s_barrier
  ds_read_b128 v[72:75], v6 offset:3072
  ds_read_b128 v[76:79], v6 offset:21504
  ds_read_b128 v[80:83], v6 offset:39936
  ds_read_b128 v[84:87], v6 offset:58368
  ds_read_b128 v[88:91], v9 offset:21504
  ds_read_b128 v[92:95], v9 offset:39936
  ds_read_b128 v[96:99], v6 offset:4096
  s_waitcnt lgkmcnt(6)
  v_mfma_f32_16x16x32_bf16 v[104:107], v[72:75], v[44:47], v[104:107]
  ds_read_b128 v[100:103], v6 offset:22528
  s_waitcnt lgkmcnt(6)
  v_mfma_f32_16x16x32_bf16 v[108:111], v[76:79], v[44:47], v[108:111]
  ds_read_b128 v[72:75], v6 offset:40960
  s_waitcnt lgkmcnt(6)
  v_mfma_f32_16x16x32_bf16 v[112:115], v[80:83], v[44:47], v[112:115]
  ds_read_b128 v[76:79], v6 offset:59392
  s_waitcnt lgkmcnt(6)
  v_mfma_f32_16x16x32_bf16 v[116:119], v[84:87], v[44:47], v[116:119]
  ds_read_b128 v[80:83], v9 offset:22528
  s_waitcnt lgkmcnt(6)
  v_mfma_f32_16x16x32_bf16 v[120:123], v[88:91], v[44:47], v[120:123]
  ds_read_b128 v[84:87], v9 offset:40960
  s_waitcnt lgkmcnt(6)
  v_mfma_f32_16x16x32_bf16 v[124:127], v[92:95], v[44:47], v[124:127]
  ds_read_b128 v[88:91], v6 offset:5120
  s_waitcnt lgkmcnt(6)
  v_mfma_f32_16x16x32_bf16 v[104:107], v[96:99], v[48:51], v[104:107]
  ds_read_b128 v[92:95], v6 offset:23552
  s_waitcnt lgkmcnt(6)
  v_mfma_f32_16x16x32_bf16 v[108:111], v[100:103], v[48:51], v[108:111]
  ds_read_b128 v[96:99], v6 offset:41984
  s_waitcnt lgkmcnt(6)
  v_mfma_f32_16x16x32_bf16 v[112:115], v[72:75], v[48:51], v[112:115]
  ds_read_b128 v[100:103], v6 offset:60416
  s_waitcnt lgkmcnt(6)
  v_mfma_f32_16x16x32_bf16 v[116:119], v[76:79], v[48:51], v[116:119]
  ds_read_b128 v[72:75], v9 offset:23552
  s_waitcnt lgkmcnt(6)
  v_mfma_f32_16x16x32_bf16 v[120:123], v[80:83], v[48:51], v[120:123]
  ds_read_b128 v[76:79], v9 offset:41984
  s_waitcnt lgkmcnt(6)
  v_mfma_f32_16x16x32_bf16 v[124:127], v[84:87], v[48:51], v[124:127]
  s_waitcnt lgkmcnt(5)
  v_mfma_f32_16x16x32_bf16 v[104:107], v[88:91], v[52:55], v[104:107]
  s_waitcnt lgkmcnt(4)
  v_mfma_f32_16x16x32_bf16 v[108:111], v[92:95], v[52:55], v[108:111]
  s_waitcnt lgkmcnt(3)
  v_mfma_f32_16x16x32_bf16 v[112:115], v[96:99], v[52:55], v[112:115]
  s_waitcnt lgkmcnt(2)
  v_mfma_f32_16x16x32_bf16 v[116:119], v[100:103], v[52:55], v[116:119]
  s_waitcnt lgkmcnt(1)
  v_mfma_f32_16x16x32_bf16 v[120:123], v[72:75], v[52:55], v[120:123]
  s_waitcnt lgkmcnt(0)
  v_mfma_f32_16x16x32_bf16 v[124:127], v[76:79], v[52:55], v[124:127]
  s_waitcnt vmcnt(0)
  s_barrier
  ds_read_b128 v[72:75], v6 offset:6144
  ds_read_b128 v[76:79], v6 offset:24576
  ds_read_b128 v[80:83], v6 offset:43008
  ds_read_b128 v[84:87], v6 offset:61440
  ds_read_b128 v[88:91], v9 offset:24576
  ds_read_b128 v[92:95], v9 offset:43008
  ds_read_b128 v[96:99], v6 offset:7168
  s_waitcnt lgkmcnt(6)
  v_mfma_f32_16x16x32_bf16 v[104:107], v[72:75], v[56:59], v[104:107]
  ds_read_b128 v[100:103], v6 offset:25600
  s_waitcnt lgkmcnt(6)
  v_mfma_f32_16x16x32_bf16 v[108:111], v[76:79], v[56:59], v[108:111]
  ds_read_b128 v[72:75], v6 offset:44032
  s_waitcnt lgkmcnt(6)
  v_mfma_f32_16x16x32_bf16 v[112:115], v[80:83], v[56:59], v[112:115]
  ds_read_b128 v[76:79], v6 offset:62464
  s_waitcnt lgkmcnt(6)
  v_mfma_f32_16x16x32_bf16 v[116:119], v[84:87], v[56:59], v[116:119]
  ds_read_b128 v[80:83], v9 offset:25600
  s_waitcnt lgkmcnt(6)
  v_mfma_f32_16x16x32_bf16 v[120:123], v[88:91], v[56:59], v[120:123]
  ds_read_b128 v[84:87], v9 offset:44032
  s_waitcnt lgkmcnt(6)
  v_mfma_f32_16x16x32_bf16 v[124:127], v[92:95], v[56:59], v[124:127]
  ds_read_b128 v[88:91], v6 offset:8192
  s_waitcnt lgkmcnt(6)
  v_mfma_f32_16x16x32_bf16 v[104:107], v[96:99], v[60:63], v[104:107]
  ds_read_b128 v[92:95], v6 offset:26624
  s_waitcnt lgkmcnt(6)
  v_mfma_f32_16x16x32_bf16 v[108:111], v[100:103], v[60:63], v[108:111]
  ds_read_b128 v[96:99], v6 offset:45056
  s_waitcnt lgkmcnt(6)
  v_mfma_f32_16x16x32_bf16 v[112:115], v[72:75], v[60:63], v[112:115]
  ds_read_b128 v[100:103], v6 offset:63488
  s_waitcnt lgkmcnt(6)
  v_mfma_f32_16x16x32_bf16 v[116:119], v[76:79], v[60:63], v[116:119]
  ds_read_b128 v[72:75], v9 offset:26624
  s_waitcnt lgkmcnt(6)
  v_mfma_f32_16x16x32_bf16 v[120:123], v[80:83], v[60:63], v[120:123]
  ds_read_b128 v[76:79], v9 offset:45056
  s_waitcnt lgkmcnt(6)
  v_mfma_f32_16x16x32_bf16 v[124:127], v[84:87], v[60:63], v[124:127]
  s_waitcnt lgkmcnt(5)
  v_mfma_f32_16x16x32_bf16 v[104:107], v[88:91], v[64:67], v[104:107]
  s_waitcnt lgkmcnt(4)
  v_mfma_f32_16x16x32_bf16 v[108:111], v[92:95], v[64:67], v[108:111]
  s_waitcnt lgkmcnt(3)
  v_mfma_f32_16x16x32_bf16 v[112:115], v[96:99], v[64:67], v[112:115]
  s_waitcnt lgkmcnt(2)
  v_mfma_f32_16x16x32_bf16 v[116:119], v[100:103], v[64:67], v[116:119]
  s_waitcnt lgkmcnt(1)
  v_mfma_f32_16x16x32_bf16 v[120:123], v[72:75], v[64:67], v[120:123]
  s_waitcnt lgkmcnt(0)
  v_mfma_f32_16x16x32_bf16 v[124:127], v[76:79], v[64:67], v[124:127]
  s_cmp_lg_u32 s20, 0
  s_cbranch_scc1 K3_H1
  s_nop 7
  ds_write_b128 v7, v[116:119] offset:3072
  ds_write_b128 v7, v[120:123] offset:4096
  ds_write_b128 v7, v[124:127] offset:5120
  s_waitcnt lgkmcnt(0)
  s_barrier
  v_mov_b32 v28, 0
  v_mov_b32 v29, 0
  ds_read_b128 v[136:139], v7 offset:0
  ds_read_b128 v[140:143], v7 offset:1024
  ds_read_b128 v[144:147], v7 offset:2048
  v_lshlrev_b32 v14, 16, v128
  v_and_b32 v15, 0xffff0000, v128
  v_lshlrev_b32 v16, 16, v129
  v_and_b32 v17, 0xffff0000, v129
  s_waitcnt lgkmcnt(2)
  v_add_f32 v104, v104, v136
  v_add_f32 v105, v105, v137
  v_add_f32 v106, v106, v138
  v_add_f32 v107, v107, v139
  v_add_f32 v14, v14, v104
  v_add_f32 v15, v15, v105
  v_add_f32 v16, v16, v106
  v_add_f32 v17, v17, v107
  v_cvt_pk_bf16_f32 v128, v14, v15
  v_cvt_pk_bf16_f32 v129, v16, v17
  buffer_store_dwordx2 v[128:129], v8, s[40:43], s51 offen offset:0 sc0 sc1
  v_dot2_f32_bf16 v28, v128, v30, v28
  v_dot2_f32_bf16 v29, v128, v128, v29
  v_dot2_f32_bf16 v28, v129, v30, v28
  v_dot2_f32_bf16 v29, v129, v129, v29
  v_lshlrev_b32 v14, 16, v130
  v_and_b32 v15, 0xffff0000, v130
  v_lshlrev_b32 v16, 16, v131
  v_and_b32 v17, 0xffff0000, v131
  s_waitcnt lgkmcnt(1)
  v_add_f32 v108, v108, v140
  v_add_f32 v109, v109, v141
  v_add_f32 v110, v110, v142
  v_add_f32 v111, v111, v143
  v_add_f32 v14, v14, v108
  v_add_f32 v15, v15, v109
  v_add_f32 v16, v16, v110
  v_add_f32 v17, v17, v111
  v_cvt_pk_bf16_f32 v130, v14, v15
  v_cvt_pk_bf16_f32 v131, v16, v17
  buffer_store_dwordx2 v[130:131], v8, s[40:43], s51 offen offset:512 sc0 sc1
  v_dot2_f32_bf16 v28, v130, v30, v28
  v_dot2_f32_bf16 v29, v130, v130, v29
  v_dot2_f32_bf16 v28, v131, v30, v28
  v_dot2_f32_bf16 v29, v131, v131, v29
  v_lshlrev_b32 v14, 16, v132
  v_and_b32 v15, 0xffff0000, v132
  v_lshlrev_b32 v16, 16, v133
  v_and_b32 v17, 0xffff0000, v133
  s_waitcnt lgkmcnt(0)
  v_add_f32 v112, v112, v144
  v_add_f32 v113, v113, v145
  v_add_f32 v114, v114, v146
  v_add_f32 v115, v115, v147
  v_add_f32 v14, v14, v112
  v_add_f32 v15, v15, v113
  v_add_f32 v16, v16, v114
  v_add_f32 v17, v17, v115
  v_cvt_pk_bf16_f32 v132, v14, v15
  v_cvt_pk_bf16_f32 v133, v16, v17
  buffer_store_dwordx2 v[132:133], v8, s[40:43], s51 offen offset:1024 sc0 sc1
  v_dot2_f32_bf16 v28, v132, v30, v28
  v_dot2_f32_bf16 v29, v132, v132, v29
  v_dot2_f32_bf16 v28, v133, v30, v28
  v_dot2_f32_bf16 v29, v133, v133, v29
  s_nop 1
  v_mov_b32 v10, v28
  s_nop 1
  v_permlane16_swap_b32 v28, v10
  v_add_f32 v28, v28, v10
  v_mov_b32 v10, v28
  s_nop 1
  v_permlane32_swap_b32 v28, v10
  v_add_f32 v28, v28, v10
  v_mov_b32 v10, v29
  s_nop 1
  v_permlane16_swap_b32 v29, v10
  v_add_f32 v29, v29, v10
  v_mov_b32 v10, v29
  s_nop 1
  v_permlane32_swap_b32 v29, v10
  v_add_f32 v29, v29, v10
  s_lshl_b32 s33, s18, 1
  s_add_u32 s33, s33, s20
  s_lshl_b32 s33, s33, 3
  s_add_u32 s33, s33, 0x240000
  v_mul_u32_u24 v10, 96, v4
  v_cmp_eq_u32 vcc, 0, v2
  s_and_saveexec_b64 s[44:45], vcc
  buffer_store_dwordx2 v[28:29], v10, s[40:43], s33 offen sc0 sc1
  s_branch FB_NEXT
K3_H1:
  s_nop 7
  ds_write_b128 v7, v[104:107] offset:0
  ds_write_b128 v7, v[108:111] offset:1024
  ds_write_b128 v7, v[112:115] offset:2048
  s_waitcnt lgkmcnt(0)
  s_barrier
  v_mov_b32 v28, 0
  v_mov_b32 v29, 0
  ds_read_b128 v[136:139], v7 offset:3072
  ds_read_b128 v[140:143], v7 offset:4096
  ds_read_b128 v[144:147], v7 offset:5120
  v_lshlrev_b32 v14, 16, v128
  v_and_b32 v15, 0xffff0000, v128
  v_lshlrev_b32 v16, 16, v129
  v_and_b32 v17, 0xffff0000, v129
  s_waitcnt lgkmcnt(2)
  v_add_f32 v116, v116, v136
  v_add_f32 v117, v117, v137
  v_add_f32 v118, v118, v138
  v_add_f32 v119, v119, v139
  v_add_f32 v14, v14, v116
  v_add_f32 v15, v15, v117
  v_add_f32 v16, v16, v118
  v_add_f32 v17, v17, v119
  v_cvt_pk_bf16_f32 v128, v14, v15
  v_cvt_pk_bf16_f32 v129, v16, v17
  buffer_store_dwordx2 v[128:129], v8, s[40:43], s51 offen offset:0 sc0 sc1
  v_dot2_f32_bf16 v28, v128, v30, v28
  v_dot2_f32_bf16 v29, v128, v128, v29
  v_dot2_f32_bf16 v28, v129, v30, v28
  v_dot2_f32_bf16 v29, v129, v129, v29
  v_lshlrev_b32 v14, 16, v130
  v_and_b32 v15, 0xffff0000, v130
  v_lshlrev_b32 v16, 16, v131
  v_and_b32 v17, 0xffff0000, v131
  s_waitcnt lgkmcnt(1)
  v_add_f32 v120, v120, v140
  v_add_f32 v121, v121, v141
  v_add_f32 v122, v122, v142
  v_add_f32 v123, v123, v143
  v_add_f32 v14, v14, v120
  v_add_f32 v15, v15, v121
  v_add_f32 v16, v16, v122
  v_add_f32 v17, v17, v123
  v_cvt_pk_bf16_f32 v130, v14, v15
  v_cvt_pk_bf16_f32 v131, v16, v17
  buffer_store_dwordx2 v[130:131], v8, s[40:43], s51 offen offset:512 sc0 sc1
  v_dot2_f32_bf16 v28, v130, v30, v28
  v_dot2_f32_bf16 v29, v130, v130, v29
  v_dot2_f32_bf16 v28, v131, v30, v28
  v_dot2_f32_bf16 v29, v131, v131, v29
  v_lshlrev_b32 v14, 16, v132
  v_and_b32 v15, 0xffff0000, v132
  v_lshlrev_b32 v16, 16, v133
  v_and_b32 v17, 0xffff0000, v133
  s_waitcnt lgkmcnt(0)
  v_add_f32 v124, v124, v144
  v_add_f32 v125, v125, v145
  v_add_f32 v126, v126, v146
  v_add_f32 v127, v127, v147
  v_add_f32 v14, v14, v124
  v_add_f32 v15, v15, v125
  v_add_f32 v16, v16, v126
  v_add_f32 v17, v17, v127
  v_cvt_pk_bf16_f32 v132, v14, v15
  v_cvt_pk_bf16_f32 v133, v16, v17
  buffer_store_dwordx2 v[132:133], v8, s[40:43], s51 offen offset:1024 sc0 sc1
  v_dot2_f32_bf16 v28, v132, v30, v28
  v_dot2_f32_bf16 v29, v132, v132, v29
  v_dot2_f32_bf16 v28, v133, v30, v28
  v_dot2_f32_bf16 v29, v133, v133, v29
  s_nop 1
  v_mov_b32 v10, v28
  s_nop 1
  v_permlane16_swap_b32 v28, v10
  v_add_f32 v28, v28, v10
  v_mov_b32 v10, v28
  s_nop 1
  v_permlane32_swap_b32 v28, v10
  v_add_f32 v28, v28, v10
  v_mov_b32 v10, v29
  s_nop 1
  v_permlane16_swap_b32 v29, v10
  v_add_f32 v29, v29, v10
  v_mov_b32 v10, v29
  s_nop 1
  v_permlane32_swap_b32 v29, v10
  v_add_f32 v29, v29, v10
  s_lshl_b32 s33, s18, 1
  s_add_u32 s33, s33, s20
  s_lshl_b32 s33, s33, 3
  s_add_u32 s33, s33, 0x240000
  v_mul_u32_u24 v10, 96, v4
  v_cmp_eq_u32 vcc, 0, v2
  s_and_saveexec_b64 s[44:45], vcc
  buffer_store_dwordx2 v[28:29], v10, s[40:43], s33 offen sc0 sc1
  s_branch FB_NEXT
K3_CT:
  v_and_b32 v1, 63, v0
  v_lshrrev_b32 v2, 6, v0
  s_nop 0
  v_readfirstlane_b32 s16, v2
  s_sub_u32 s17, s2, 192
  s_lshl_b32 s17, s17, 3
  s_add_u32 s17, s17, s16
  s_cmp_ge_u32 s17, 36
  s_cbranch_scc1 K3_ZF
  s_cmp_ge_u32 s17, 18
  s_cselect_b32 s18, 1, 0
  s_mul_i32 s19, s18, 18
  s_sub_u32 s19, s17, s19
  s_lshl_b32 s19, s19, 6
  v_add_u32 v3, s19, v1
  v_lshlrev_b32 v4, 4, v3
  s_mul_i32 s20, s18, 165888
  s_waitcnt lgkmcnt(0)
  s_add_u32 s40, s12, 0x5100000
  s_addc_u32 s41, s13, 0
  s_mov_b32 s42, 0x100000
  s_mov_b32 s43, 0x00020000
  buffer_load_dwordx4 v[8:11], v4, s[40:43], s20 offen sc0 sc1
  s_add_u32 s20, s20, 18432
  buffer_load_dwordx4 v[12:15], v4, s[40:43], s20 offen sc0 sc1
  s_add_u32 s20, s20, 18432
  buffer_load_dwordx4 v[16:19], v4, s[40:43], s20 offen sc0 sc1
  s_add_u32 s20, s20, 18432
  buffer_load_dwordx4 v[20:23], v4, s[40:43], s20 offen sc0 sc1
  s_add_u32 s20, s20, 18432
  buffer_load_dwordx4 v[24:27], v4, s[40:43], s20 offen sc0 sc1
  s_add_u32 s20, s20, 18432
  buffer_load_dwordx4 v[28:31], v4, s[40:43], s20 offen sc0 sc1
  s_add_u32 s20, s20, 18432
  buffer_load_dwordx4 v[32:35], v4, s[40:43], s20 offen sc0 sc1
  s_add_u32 s20, s20, 18432
  buffer_load_dwordx4 v[36:39], v4, s[40:43], s20 offen sc0 sc1
  s_add_u32 s20, s20, 18432
  buffer_load_dwordx4 v[40:43], v4, s[40:43], s20 offen sc0 sc1
  s_add_u32 s20, s20, 18432
  v_lshrrev_b32 v5, 2, v3
  v_lshlrev_b32 v5, 7, v5
  v_and_b32 v6, 3, v3
  v_lshl_add_u32 v5, v6, 4, v5
  s_lshl_b32 s21, s18, 6
  s_add_u32 s21, s21, 0x80000
  s_waitcnt vmcnt(7)
  v_add_f32 v8, v8, v12
  v_add_f32 v9, v9, v13
  v_add_f32 v10, v10, v14
  v_add_f32 v11, v11, v15
  s_waitcnt vmcnt(6)
  v_add_f32 v8, v8, v16
  v_add_f32 v9, v9, v17
  v_add_f32 v10, v10, v18
  v_add_f32 v11, v11, v19
  s_waitcnt vmcnt(5)
  v_add_f32 v8, v8, v20
  v_add_f32 v9, v9, v21
  v_add_f32 v10, v10, v22
  v_add_f32 v11, v11, v23
  s_waitcnt vmcnt(4)
  v_add_f32 v8, v8, v24
  v_add_f32 v9, v9, v25
  v_add_f32 v10, v10, v26
  v_add_f32 v11, v11, v27
  s_waitcnt vmcnt(3)
  v_add_f32 v8, v8, v28
  v_add_f32 v9, v9, v29
  v_add_f32 v10, v10, v30
  v_add_f32 v11, v11, v31
  s_waitcnt vmcnt(2)
  v_add_f32 v8, v8, v32
  v_add_f32 v9, v9, v33
  v_add_f32 v10, v10, v34
  v_add_f32 v11, v11, v35
  s_waitcnt vmcnt(1)
  v_add_f32 v8, v8, v36
  v_add_f32 v9, v9, v37
  v_add_f32 v10, v10, v38
  v_add_f32 v11, v11, v39
  s_waitcnt vmcnt(0)
  v_add_f32 v8, v8, v40
  v_add_f32 v9, v9, v41
  v_add_f32 v10, v10, v42
  v_add_f32 v11, v11, v43
  buffer_store_dwordx4 v[8:11], v5, s[40:43], s21 offen sc0 sc1
  s_branch FB_NEXT
K3_ZF:
  s_cmp_ge_u32 s17, 101
  s_cbranch_scc1 K3_END2
  s_sub_u32 s17, s17, 36
  s_lshl_b32 s17, s17, 10
  v_lshlrev_b32 v4, 4, v1
  v_mov_b32 v8, 0
  v_mov_b32 v9, 0
  v_mov_b32 v10, 0
  v_mov_b32 v11, 0
  s_waitcnt lgkmcnt(0)
  s_add_u32 s40, s12, 0x8c00000
  s_addc_u32 s41, s13, 0
  s_mov_b32 s42, 0x10400
  s_mov_b32 s43, 0x00020000
  buffer_store_dwordx4 v[8:11], v4, s[40:43], s17 offen sc0 sc1
K3_END2:
  s_branch FB_NEXT
FB_F1:
  s_load_dwordx2 s[12:13], s[0:1], 88
  s_cmp_ge_u32 s2, 256
  s_cbranch_scc1 F1_END
  v_and_b32 v7, 63, v0
  v_lshrrev_b32 v8, 6, v0
  s_nop 0
  v_readfirstlane_b32 s17, v8
  v_lshlrev_b32 v1, 4, v7
  s_and_b32 s16, s17, 3
  s_and_b32 s33, s2, 7
  s_lshr_b32 s34, s2, 3
  s_lshr_b32 s19, s33, 2
  s_lshl_b32 s19, s19, 3
  s_and_b32 s35, s34, 7
  s_add_u32 s19, s19, s35
  s_and_b32 s20, s33, 3
  s_lshl_b32 s20, s20, 2
  s_lshr_b32 s35, s34, 3
  s_add_u32 s20, s20, s35
  s_lshl_b32 s46, s19, 2
  s_add_u32 s46, s46, s16
  s_lshl_b32 s33, s16, 11
  s_add_u32 s33, s33, 150528
  v_lshlrev_b32 v12, 2, v7
  v_add_u32 v12, s33, v12
  s_mul_i32 s44, s46, 144
  s_lshr_b32 s33, s20, 2
  s_mul_i32 s33, s33, 36
  s_add_u32 s44, s44, s33
  s_and_b32 s33, s20, 3
  s_add_u32 s44, s44, s33
  s_lshl_b32 s44, s44, 11
  s_mul_i32 s21, s20, 663552
  s_lshl_b32 s33, s17, 12
  s_add_u32 s34, s21, s33
  s_mul_i32 s47, s20, 2304
  s_add_u32 s47, s47, 0x1180000
  s_sub_u32 s48, s17, 4
  s_min_u32 s48, s48, 2
  s_lshl_b32 s48, s48, 10
  s_lshl_b32 s35, s17, 10
  s_add_u32 s35, s35, 32768
  s_add_u32 s45, s21, s35
  s_add_u32 s47, s47, s48
  s_add_u32 s48, s48, 147456
  s_cmp_ge_u32 s17, 4
  s_cselect_b32 s45, s47, s45
  s_cselect_b32 s35, s48, s35
  s_waitcnt lgkmcnt(0)
  s_add_u32 s24, s12, 0x4000000
  s_addc_u32 s25, s13, 0
  s_mov_b32 s26, 0x1200000
  s_mov_b32 s27, 0x00020000
  s_mov_b32 m0, s33
  s_nop 0
  buffer_load_dwordx4 v1, s[24:27], s34 offen offset:0 sc0 sc1 lds
  buffer_load_dwordx4 v1, s[24:27], s34 offen offset:1024 sc0 sc1 lds
  buffer_load_dwordx4 v1, s[24:27], s34 offen offset:2048 sc0 sc1 lds
  buffer_load_dwordx4 v1, s[24:27], s34 offen offset:3072 sc0 sc1 lds
  s_mov_b32 m0, s35
  s_nop 0
  buffer_load_dwordx4 v1, s[24:27], s45 offen sc0 sc1 lds
  s_cmp_ge_u32 s17, 4
  s_cbranch_scc1 F1_PROD
  s_mul_i32 s35, s46, 36864
  s_add_u32 s45, s35, 18432
  v_and_b32 v8, 15, v7
  v_lshrrev_b32 v9, 4, v7
  s_lshl_b32 s33, s46, 5
  v_add_u32 v8, s33, v8
  v_mul_u32_u24 v8, 96, v8
  v_mul_u32_u24 v10, 24, v9
  v_add_u32 v8, v8, v10
  v_lshlrev_b32 v6, 4, v9
  v_add_u32 v6, 147328, v6
  v_mov_b32 v4, v1
  v_add_u32 v5, 36864, v1
  s_mov_b32 s22, 0
  s_waitcnt lgkmcnt(0)
  s_add_u32 s36, s12, 0x64c0000
  s_addc_u32 s37, s13, 0
  s_mov_b32 s38, 0x340000
  s_mov_b32 s39, 0x00020000
  s_add_u32 s40, s12, 0x6800000
  s_addc_u32 s41, s13, 0
  s_mov_b32 s42, 0x2400000
  s_mov_b32 s43, 0x00020000
  buffer_load_dwordx4 v[16:19], v1, s[36:39], s35 offen offset:0 sc0 sc1
  buffer_load_dwordx4 v[20:23], v1, s[36:39], s45 offen offset:0 sc0 sc1
  buffer_load_dwordx4 v[24:27], v1, s[36:39], s35 offen offset:1024 sc0 sc1
  buffer_load_dwordx4 v[28:31], v1, s[36:39], s45 offen offset:1024 sc0 sc1
  buffer_load_dwordx4 v[32:35], v1, s[36:39], s35 offen offset:2048 sc0 sc1
  buffer_load_dwordx4 v[36:39], v1, s[36:39], s45 offen offset:2048 sc0 sc1
  buffer_load_dwordx4 v[40:43], v1, s[36:39], s35 offen offset:3072 sc0 sc1
  buffer_load_dwordx4 v[44:47], v1, s[36:39], s45 offen offset:3072 sc0 sc1
  s_add_u32 s35, s35, 4096
  s_add_u32 s45, s45, 4096
  buffer_load_dwordx4 v[48:51], v1, s[36:39], s35 offen offset:0 sc0 sc1
  buffer_load_dwordx4 v[52:55], v1, s[36:39], s45 offen offset:0 sc0 sc1
  buffer_load_dwordx4 v[56:59], v1, s[36:39], s35 offen offset:1024 sc0 sc1
  buffer_load_dwordx4 v[60:63], v1, s[36:39], s45 offen offset:1024 sc0 sc1
  buffer_load_dwordx4 v[64:67], v1, s[36:39], s35 offen offset:2048 sc0 sc1
  buffer_load_dwordx4 v[68:71], v1, s[36:39], s45 offen offset:2048 sc0 sc1
  buffer_load_dwordx4 v[72:75], v1, s[36:39], s35 offen offset:3072 sc0 sc1
  buffer_load_dwordx4 v[76:79], v1, s[36:39], s45 offen offset:3072 sc0 sc1
  s_add_u32 s35, s35, 4096
  s_add_u32 s45, s45, 4096
  s_waitcnt vmcnt(16)
  s_barrier
  ds_read_b128 v[192:195], v4 offset:0
  ds_read_b128 v[196:199], v4 offset:1024
  ds_read_b128 v[200:203], v4 offset:2048
  ds_read_b128 v[204:207], v4 offset:3072
  ds_read_b128 v[208:211], v4 offset:4096
  ds_read_b128 v[212:215], v4 offset:5120
  ds_read_b128 v[216:219], v4 offset:6144
  ds_read_b128 v[220:223], v4 offset:7168
  ds_read_b128 v[224:227], v4 offset:8192
  ds_read_b128 v[228:231], v4 offset:9216
  s_waitcnt lgkmcnt(8)
  s_waitcnt vmcnt(15)
  v_mfma_f32_16x16x32_bf16 v[160:163], v[192:195], v[16:19], 0
  buffer_load_dwordx4 v[80:83], v1, s[36:39], s35 offen offset:0 sc0 sc1
  s_waitcnt vmcnt(15)
  v_mfma_f32_16x16x32_bf16 v[164:167], v[192:195], v[20:23], 0
  ds_read_b128 v[232:235], v4 offset:10240
  v_mfma_f32_16x16x32_bf16 v[168:171], v[196:199], v[16:19], 0
  s_waitcnt lgkmcnt(7)
  buffer_load_dwordx4 v[84:87], v1, s[36:39], s45 offen offset:0 sc0 sc1
  v_mfma_f32_16x16x32_bf16 v[172:175], v[196:199], v[20:23], 0
  ds_read_b128 v[236:239], v4 offset:11264
  s_waitcnt vmcnt(15)
  v_mfma_f32_16x16x32_bf16 v[160:163], v[200:203], v[24:27], v[160:163]
  buffer_load_dwordx4 v[88:91], v1, s[36:39], s35 offen offset:1024 sc0 sc1
  s_waitcnt vmcnt(15)
  v_mfma_f32_16x16x32_bf16 v[164:167], v[200:203], v[28:31], v[164:167]
  ds_read_b128 v[192:195], v4 offset:12288
  v_mfma_f32_16x16x32_bf16 v[168:171], v[204:207], v[24:27], v[168:171]
  s_waitcnt lgkmcnt(7)
  buffer_load_dwordx4 v[92:95], v1, s[36:39], s45 offen offset:1024 sc0 sc1
  v_mfma_f32_16x16x32_bf16 v[172:175], v[204:207], v[28:31], v[172:175]
  ds_read_b128 v[196:199], v4 offset:13312
  s_waitcnt vmcnt(15)
  v_mfma_f32_16x16x32_bf16 v[160:163], v[208:211], v[32:35], v[160:163]
  buffer_load_dwordx4 v[96:99], v1, s[36:39], s35 offen offset:2048 sc0 sc1
  s_waitcnt vmcnt(15)
  v_mfma_f32_16x16x32_bf16 v[164:167], v[208:211], v[36:39], v[164:167]
  ds_read_b128 v[200:203], v4 offset:14336
  v_mfma_f32_16x16x32_bf16 v[168:171], v[212:215], v[32:35], v[168:171]
  s_waitcnt lgkmcnt(7)
  buffer_load_dwordx4 v[100:103], v1, s[36:39], s45 offen offset:2048 sc0 sc1
  v_mfma_f32_16x16x32_bf16 v[172:175], v[212:215], v[36:39], v[172:175]
  ds_read_b128 v[204:207], v4 offset:15360
  s_waitcnt vmcnt(15)
  v_mfma_f32_16x16x32_bf16 v[160:163], v[216:219], v[40:43], v[160:163]
  buffer_load_dwordx4 v[104:107], v1, s[36:39], s35 offen offset:3072 sc0 sc1
  s_waitcnt vmcnt(15)
  v_mfma_f32_16x16x32_bf16 v[164:167], v[216:219], v[44:47], v[164:167]
  ds_read_b128 v[208:211], v4 offset:16384
  v_mfma_f32_16x16x32_bf16 v[168:171], v[220:223], v[40:43], v[168:171]
  s_waitcnt lgkmcnt(7)
  buffer_load_dwordx4 v[108:111], v1, s[36:39], s45 offen offset:3072 sc0 sc1
  s_add_u32 s35, s35, 4096
  s_add_u32 s45, s45, 4096
  v_mfma_f32_16x16x32_bf16 v[172:175], v[220:223], v[44:47], v[172:175]
  ds_read_b128 v[212:215], v4 offset:17408
  s_waitcnt vmcnt(15)
  v_mfma_f32_16x16x32_bf16 v[160:163], v[224:227], v[48:51], v[160:163]
  buffer_load_dwordx4 v[112:115], v1, s[36:39], s35 offen offset:0 sc0 sc1
  s_waitcnt vmcnt(15)
  v_mfma_f32_16x16x32_bf16 v[164:167], v[224:227], v[52:55], v[164:167]
  ds_read_b128 v[216:219], v4 offset:18432
  v_mfma_f32_16x16x32_bf16 v[168:171], v[228:231], v[48:51], v[168:171]
  s_waitcnt lgkmcnt(7)
  buffer_load_dwordx4 v[116:119], v1, s[36:39], s45 offen offset:0 sc0 sc1
  v_mfma_f32_16x16x32_bf16 v[172:175], v[228:231], v[52:55], v[172:175]
  ds_read_b128 v[220:223], v4 offset:19456
  s_waitcnt vmcnt(15)
  v_mfma_f32_16x16x32_bf16 v[160:163], v[232:235], v[56:59], v[160:163]
  buffer_load_dwordx4 v[120:123], v1, s[36:39], s35 offen offset:1024 sc0 sc1
  s_waitcnt vmcnt(15)
  v_mfma_f32_16x16x32_bf16 v[164:167], v[232:235], v[60:63], v[164:167]
  ds_read_b128 v[224:227], v4 offset:20480
  v_mfma_f32_16x16x32_bf16 v[168:171], v[236:239], v[56:59], v[168:171]
  s_waitcnt lgkmcnt(7)
  buffer_load_dwordx4 v[124:127], v1, s[36:39], s45 offen offset:1024 sc0 sc1
  v_mfma_f32_16x16x32_bf16 v[172:175], v[236:239], v[60:63], v[172:175]
  ds_read_b128 v[228:231], v4 offset:21504
  s_waitcnt vmcnt(15)
  v_mfma_f32_16x16x32_bf16 v[160:163], v[192:195], v[64:67], v[160:163]
  buffer_load_dwordx4 v[128:131], v1, s[36:39], s35 offen offset:2048 sc0 sc1
  s_waitcnt vmcnt(15)
  v_mfma_f32_16x16x32_bf16 v[164:167], v[192:195], v[68:71], v[164:167]
  ds_read_b128 v[232:235], v4 offset:22528
  v_mfma_f32_16x16x32_bf16 v[168:171], v[196:199], v[64:67], v[168:171]
  s_waitcnt lgkmcnt(7)
  buffer_load_dwordx4 v[132:135], v1, s[36:39], s45 offen offset:2048 sc0 sc1
  v_mfma_f32_16x16x32_bf16 v[172:175], v[196:199], v[68:71], v[172:175]
  ds_read_b128 v[236:239], v4 offset:23552
  s_waitcnt vmcnt(15)
  v_mfma_f32_16x16x32_bf16 v[160:163], v[200:203], v[72:75], v[160:163]
  buffer_load_dwordx4 v[136:139], v1, s[36:39], s35 offen offset:3072 sc0 sc1
  s_waitcnt vmcnt(15)
  v_mfma_f32_16x16x32_bf16 v[164:167], v[200:203], v[76:79], v[164:167]
  ds_read_b128 v[192:195], v4 offset:24576
  v_mfma_f32_16x16x32_bf16 v[168:171], v[204:207], v[72:75], v[168:171]
  s_waitcnt lgkmcnt(7)
  buffer_load_dwordx4 v[140:143], v1, s[36:39], s45 offen offset:3072 sc0 sc1
  s_add_u32 s35, s35, 4096
  s_add_u32 s45, s45, 4096
  v_mfma_f32_16x16x32_bf16 v[172:175], v[204:207], v[76:79], v[172:175]
  ds_read_b128 v[196:199], v4 offset:25600
  s_waitcnt vmcnt(15)
  v_mfma_f32_16x16x32_bf16 v[160:163], v[208:211], v[80:83], v[160:163]
  buffer_load_dwordx4 v[144:147], v1, s[36:39], s35 offen offset:0 sc0 sc1
  s_waitcnt vmcnt(15)
  v_mfma_f32_16x16x32_bf16 v[164:167], v[208:211], v[84:87], v[164:167]
  ds_read_b128 v[200:203], v4 offset:26624
  v_mfma_f32_16x16x32_bf16 v[168:171], v[212:215], v[80:83], v[168:171]
  s_waitcnt lgkmcnt(7)
  buffer_load_dwordx4 v[148:151], v1, s[36:39], s45 offen offset:0 sc0 sc1
  v_mfma_f32_16x16x32_bf16 v[172:175], v[212:215], v[84:87], v[172:175]
  ds_read_b128 v[204:207], v4 offset:27648
  s_waitcnt vmcnt(15)
  v_mfma_f32_16x16x32_bf16 v[160:163], v[216:219], v[88:91], v[160:163]
  buffer_load_dwordx4 v[152:155], v1, s[36:39], s35 offen offset:1024 sc0 sc1
  s_waitcnt vmcnt(15)
  v_mfma_f32_16x16x32_bf16 v[164:167], v[216:219], v[92:95], v[164:167]
  ds_read_b128 v[208:211], v4 offset:28672
  v_mfma_f32_16x16x32_bf16 v[168:171], v[220:223], v[88:91], v[168:171]
  s_waitcnt lgkmcnt(7)
  buffer_load_dwordx4 v[156:159], v1, s[36:39], s45 offen offset:1024 sc0 sc1
  v_mfma_f32_16x16x32_bf16 v[172:175], v[220:223], v[92:95], v[172:175]
  ds_read_b128 v[212:215], v4 offset:29696
  s_waitcnt vmcnt(15)
  v_mfma_f32_16x16x32_bf16 v[160:163], v[224:227], v[96:99], v[160:163]
  s_mov_b32 s35, 0x240000
  s_waitcnt vmcnt(14)
  v_mfma_f32_16x16x32_bf16 v[164:167], v[224:227], v[100:103], v[164:167]
  ds_read_b128 v[216:219], v4 offset:30720
  v_mfma_f32_16x16x32_bf16 v[168:171], v[228:231], v[96:99], v[168:171]
  s_waitcnt lgkmcnt(7)
  buffer_load_dwordx4 v[176:179], v8, s[36:39], s35 offen offset:0 sc0 sc1
  v_mfma_f32_16x16x32_bf16 v[172:175], v[228:231], v[100:103], v[172:175]
  ds_read_b128 v[220:223], v4 offset:31744
  s_waitcnt vmcnt(14)
  v_mfma_f32_16x16x32_bf16 v[160:163], v[232:235], v[104:107], v[160:163]
  buffer_load_dwordx2 v[180:181], v8, s[36:39], s35 offen offset:16 sc0 sc1
  s_waitcnt vmcnt(14)
  v_mfma_f32_16x16x32_bf16 v[164:167], v[232:235], v[108:111], v[164:167]
  ds_read_b128 v[224:227], v4 offset:32768
  v_mfma_f32_16x16x32_bf16 v[168:171], v[236:239], v[104:107], v[168:171]
  s_waitcnt lgkmcnt(7)
  buffer_load_dwordx4 v[182:185], v8, s[36:39], s35 offen offset:1536 sc0 sc1
  v_mfma_f32_16x16x32_bf16 v[172:175], v[236:239], v[108:111], v[172:175]
  ds_read_b128 v[228:231], v4 offset:33792
  s_waitcnt vmcnt(14)
  v_mfma_f32_16x16x32_bf16 v[160:163], v[192:195], v[112:115], v[160:163]
  buffer_load_dwordx2 v[186:187], v8, s[36:39], s35 offen offset:1552 sc0 sc1
  s_waitcnt vmcnt(14)
  v_mfma_f32_16x16x32_bf16 v[164:167], v[192:195], v[116:119], v[164:167]
  ds_read_b128 v[232:235], v4 offset:34816
  v_mfma_f32_16x16x32_bf16 v[168:171], v[196:199], v[112:115], v[168:171]
  s_waitcnt lgkmcnt(7)
  v_mfma_f32_16x16x32_bf16 v[172:175], v[196:199], v[116:119], v[172:175]
  ds_read_b128 v[236:239], v4 offset:35840
  s_barrier
  s_waitcnt vmcnt(13)
  v_mfma_f32_16x16x32_bf16 v[160:163], v[200:203], v[120:123], v[160:163]
  s_waitcnt vmcnt(12)
  v_mfma_f32_16x16x32_bf16 v[164:167], v[200:203], v[124:127], v[164:167]
  ds_read_b128 v[192:195], v5 offset:0
  v_mfma_f32_16x16x32_bf16 v[168:171], v[204:207], v[120:123], v[168:171]
  s_waitcnt lgkmcnt(7)
  v_mfma_f32_16x16x32_bf16 v[172:175], v[204:207], v[124:127], v[172:175]
  ds_read_b128 v[196:199], v5 offset:1024
  s_waitcnt vmcnt(11)
  v_mfma_f32_16x16x32_bf16 v[160:163], v[208:211], v[128:131], v[160:163]
  s_waitcnt vmcnt(3)
  v_add_f32 v2, v176, v178
  s_waitcnt vmcnt(2)
  v_add_f32 v2, v2, v180
  v_mfma_f32_16x16x32_bf16 v[164:167], v[208:211], v[132:135], v[164:167]
  ds_read_b128 v[200:203], v5 offset:2048
  v_mov_b32 v7, v2
  v_mfma_f32_16x16x32_bf16 v[168:171], v[212:215], v[128:131], v[168:171]
  s_waitcnt lgkmcnt(7)
  s_nop 1
  v_mfma_f32_16x16x32_bf16 v[172:175], v[212:215], v[132:135], v[172:175]
  ds_read_b128 v[204:207], v5 offset:3072
  v_permlane16_swap_b32 v2, v7
  v_mfma_f32_16x16x32_bf16 v[160:163], v[216:219], v[136:139], v[160:163]
  v_add_f32 v2, v2, v7
  v_mov_b32 v7, v2
  v_mfma_f32_16x16x32_bf16 v[164:167], v[216:219], v[140:143], v[164:167]
  ds_read_b128 v[208:211], v5 offset:4096
  s_nop 1
  v_mfma_f32_16x16x32_bf16 v[168:171], v[220:223], v[136:139], v[168:171]
  s_waitcnt lgkmcnt(7)
  v_permlane32_swap_b32 v2, v7
  v_mfma_f32_16x16x32_bf16 v[172:175], v[220:223], v[140:143], v[172:175]
  ds_read_b128 v[212:215], v5 offset:5120
  v_add_f32 v2, v2, v7
  v_mfma_f32_16x16x32_bf16 v[160:163], v[224:227], v[144:147], v[160:163]
  v_mul_f32 v2, 0xbae38e39, v2
  s_waitcnt vmcnt(1)
  v_add_f32 v3, v182, v184
  v_mfma_f32_16x16x32_bf16 v[164:167], v[224:227], v[148:151], v[164:167]
  ds_read_b128 v[216:219], v5 offset:6144
  s_waitcnt vmcnt(0)
  v_add_f32 v3, v3, v186
  v_mfma_f32_16x16x32_bf16 v[168:171], v[228:231], v[144:147], v[168:171]
  s_waitcnt lgkmcnt(7)
  v_mov_b32 v7, v3
  v_mfma_f32_16x16x32_bf16 v[172:175], v[228:231], v[148:151], v[172:175]
  ds_read_b128 v[220:223], v5 offset:7168
  s_nop 1
  v_mfma_f32_16x16x32_bf16 v[160:163], v[232:235], v[152:155], v[160:163]
  v_permlane16_swap_b32 v3, v7
  v_add_f32 v3, v3, v7
  v_mfma_f32_16x16x32_bf16 v[164:167], v[232:235], v[156:159], v[164:167]
  ds_read_b128 v[224:227], v5 offset:8192
  v_mov_b32 v7, v3
  v_mfma_f32_16x16x32_bf16 v[168:171], v[236:239], v[152:155], v[168:171]
  s_waitcnt lgkmcnt(7)
  s_nop 1
  v_mfma_f32_16x16x32_bf16 v[172:175], v[236:239], v[156:159], v[172:175]
  ds_read_b128 v[228:231], v5 offset:9216
  v_permlane32_swap_b32 v3, v7
  v_add_f32 v3, v3, v7
  v_mul_f32 v3, 0xbae38e39, v3
  ds_read_b128 v[240:243], v6 offset:128
  ds_read_b128 v[244:247], v6 offset:192
  v_mfma_f32_16x16x32_bf16 v[176:179], v[192:195], v[16:19], 0
  v_mfma_f32_16x16x32_bf16 v[180:183], v[192:195], v[20:23], 0
  ds_read_b128 v[232:235], v5 offset:10240
  v_mfma_f32_16x16x32_bf16 v[184:187], v[196:199], v[16:19], 0
  s_waitcnt lgkmcnt(9)
  s_waitcnt lgkmcnt(2)
  v_fmac_f32 v160, v2, v240
  v_mfma_f32_16x16x32_bf16 v[188:191], v[196:199], v[20:23], 0
  ds_read_b128 v[236:239], v5 offset:11264
  v_fmac_f32 v161, v2, v241
  v_mfma_f32_16x16x32_bf16 v[176:179], v[200:203], v[24:27], v[176:179]
  v_fmac_f32 v162, v2, v242
  v_fmac_f32 v163, v2, v243
  v_mfma_f32_16x16x32_bf16 v[180:183], v[200:203], v[28:31], v[180:183]
  ds_read_b128 v[192:195], v5 offset:12288
  s_waitcnt lgkmcnt(3)
  v_fmac_f32 v168, v2, v244
  v_mfma_f32_16x16x32_bf16 v[184:187], v[204:207], v[24:27], v[184:187]
  v_fmac_f32 v169, v2, v245
  v_mfma_f32_16x16x32_bf16 v[188:191], v[204:207], v[28:31], v[188:191]
  ds_read_b128 v[196:199], v5 offset:13312
  v_fmac_f32 v170, v2, v246
  v_mfma_f32_16x16x32_bf16 v[176:179], v[208:211], v[32:35], v[176:179]
  v_fmac_f32 v171, v2, v247
  v_mul_f32 v160, v160, v168
  v_mfma_f32_16x16x32_bf16 v[180:183], v[208:211], v[36:39], v[180:183]
  ds_read_b128 v[200:203], v5 offset:14336
  v_mul_f32 v161, v161, v169
  v_mfma_f32_16x16x32_bf16 v[184:187], v[212:215], v[32:35], v[184:187]
  v_mul_f32 v162, v162, v170
  v_mfma_f32_16x16x32_bf16 v[188:191], v[212:215], v[36:39], v[188:191]
  ds_read_b128 v[204:207], v5 offset:15360
  v_mul_f32 v163, v163, v171
  v_mfma_f32_16x16x32_bf16 v[176:179], v[216:219], v[40:43], v[176:179]
  v_cvt_pk_bf16_f32 v248, v160, v161
  v_cvt_pk_bf16_f32 v249, v162, v163
  v_mfma_f32_16x16x32_bf16 v[180:183], v[216:219], v[44:47], v[180:183]
  ds_read_b128 v[208:211], v5 offset:16384
  v_fmac_f32 v164, v3, v240
  v_mfma_f32_16x16x32_bf16 v[184:187], v[220:223], v[40:43], v[184:187]
  v_fmac_f32 v165, v3, v241
  v_mfma_f32_16x16x32_bf16 v[188:191], v[220:223], v[44:47], v[188:191]
  ds_read_b128 v[212:215], v5 offset:17408
  v_fmac_f32 v166, v3, v242
  v_mfma_f32_16x16x32_bf16 v[176:179], v[224:227], v[48:51], v[176:179]
  v_fmac_f32 v167, v3, v243
  v_fmac_f32 v172, v3, v244
  v_mfma_f32_16x16x32_bf16 v[180:183], v[224:227], v[52:55], v[180:183]
  ds_read_b128 v[216:219], v5 offset:18432
  v_fmac_f32 v173, v3, v245
  v_mfma_f32_16x16x32_bf16 v[184:187], v[228:231], v[48:51], v[184:187]
  s_waitcnt lgkmcnt(7)
  v_fmac_f32 v174, v3, v246
  v_mfma_f32_16x16x32_bf16 v[188:191], v[228:231], v[52:55], v[188:191]
  ds_read_b128 v[220:223], v5 offset:19456
  v_fmac_f32 v175, v3, v247
  v_mfma_f32_16x16x32_bf16 v[176:179], v[232:235], v[56:59], v[176:179]
  v_mul_f32 v164, v164, v172
  v_mul_f32 v165, v165, v173
  v_mfma_f32_16x16x32_bf16 v[180:183], v[232:235], v[60:63], v[180:183]
  ds_read_b128 v[224:227], v5 offset:20480
  v_mul_f32 v166, v166, v174
  v_mfma_f32_16x16x32_bf16 v[184:187], v[236:239], v[56:59], v[184:187]
  s_waitcnt lgkmcnt(7)
  v_mul_f32 v167, v167, v175
  v_mfma_f32_16x16x32_bf16 v[188:191], v[236:239], v[60:63], v[188:191]
  ds_read_b128 v[228:231], v5 offset:21504
  v_cvt_pk_bf16_f32 v252, v164, v165
  v_mfma_f32_16x16x32_bf16 v[176:179], v[192:195], v[64:67], v[176:179]
  v_cvt_pk_bf16_f32 v253, v166, v167
  v_mfma_f32_16x16x32_bf16 v[180:183], v[192:195], v[68:71], v[180:183]
  ds_read_b128 v[232:235], v5 offset:22528
  v_mfma_f32_16x16x32_bf16 v[184:187], v[196:199], v[64:67], v[184:187]
  s_waitcnt lgkmcnt(7)
  v_mfma_f32_16x16x32_bf16 v[188:191], v[196:199], v[68:71], v[188:191]
  ds_read_b128 v[236:239], v5 offset:23552
  v_mfma_f32_16x16x32_bf16 v[176:179], v[200:203], v[72:75], v[176:179]
  v_mfma_f32_16x16x32_bf16 v[180:183], v[200:203], v[76:79], v[180:183]
  ds_read_b128 v[192:195], v5 offset:24576
  v_mfma_f32_16x16x32_bf16 v[184:187], v[204:207], v[72:75], v[184:187]
  s_waitcnt lgkmcnt(7)
  v_mfma_f32_16x16x32_bf16 v[188:191], v[204:207], v[76:79], v[188:191]
  ds_read_b128 v[196:199], v5 offset:25600
  v_mfma_f32_16x16x32_bf16 v[176:179], v[208:211], v[80:83], v[176:179]
  v_mfma_f32_16x16x32_bf16 v[180:183], v[208:211], v[84:87], v[180:183]
  ds_read_b128 v[200:203], v5 offset:26624
  v_mfma_f32_16x16x32_bf16 v[184:187], v[212:215], v[80:83], v[184:187]
  s_waitcnt lgkmcnt(7)
  v_mfma_f32_16x16x32_bf16 v[188:191], v[212:215], v[84:87], v[188:191]
  ds_read_b128 v[204:207], v5 offset:27648
  v_mfma_f32_16x16x32_bf16 v[176:179], v[216:219], v[88:91], v[176:179]
  v_mfma_f32_16x16x32_bf16 v[180:183], v[216:219], v[92:95], v[180:183]
  ds_read_b128 v[208:211], v5 offset:28672
  v_mfma_f32_16x16x32_bf16 v[184:187], v[220:223], v[88:91], v[184:187]
  s_waitcnt lgkmcnt(7)
  v_mfma_f32_16x16x32_bf16 v[188:191], v[220:223], v[92:95], v[188:191]
  ds_read_b128 v[212:215], v5 offset:29696
  v_mfma_f32_16x16x32_bf16 v[176:179], v[224:227], v[96:99], v[176:179]
  v_mfma_f32_16x16x32_bf16 v[180:183], v[224:227], v[100:103], v[180:183]
  ds_read_b128 v[216:219], v5 offset:30720
  v_mfma_f32_16x16x32_bf16 v[184:187], v[228:231], v[96:99], v[184:187]
  s_waitcnt lgkmcnt(7)
  v_mfma_f32_16x16x32_bf16 v[188:191], v[228:231], v[100:103], v[188:191]
  ds_read_b128 v[220:223], v5 offset:31744
  v_mfma_f32_16x16x32_bf16 v[176:179], v[232:235], v[104:107], v[176:179]
  v_mfma_f32_16x16x32_bf16 v[180:183], v[232:235], v[108:111], v[180:183]
  ds_read_b128 v[224:227], v5 offset:32768
  v_mfma_f32_16x16x32_bf16 v[184:187], v[236:239], v[104:107], v[184:187]
  s_waitcnt lgkmcnt(7)
  v_mfma_f32_16x16x32_bf16 v[188:191], v[236:239], v[108:111], v[188:191]
  ds_read_b128 v[228:231], v5 offset:33792
  v_mfma_f32_16x16x32_bf16 v[176:179], v[192:195], v[112:115], v[176:179]
  v_mfma_f32_16x16x32_bf16 v[180:183], v[192:195], v[116:119], v[180:183]
  ds_read_b128 v[232:235], v5 offset:34816
  v_mfma_f32_16x16x32_bf16 v[184:187], v[196:199], v[112:115], v[184:187]
  s_waitcnt lgkmcnt(7)
  v_mfma_f32_16x16x32_bf16 v[188:191], v[196:199], v[116:119], v[188:191]
  ds_read_b128 v[236:239], v5 offset:35840
  s_barrier
  v_mfma_f32_16x16x32_bf16 v[176:179], v[200:203], v[120:123], v[176:179]
  s_xor_b32 s22, s22, 73728
  v_add_u32 v4, s22, v1
  v_mfma_f32_16x16x32_bf16 v[180:183], v[200:203], v[124:127], v[180:183]
  ds_read_b128 v[192:195], v4 offset:0
  v_mfma_f32_16x16x32_bf16 v[184:187], v[204:207], v[120:123], v[184:187]
  s_waitcnt lgkmcnt(7)
  v_add_u32 v5, 36864, v4
  v_mfma_f32_16x16x32_bf16 v[188:191], v[204:207], v[124:127], v[188:191]
  ds_read_b128 v[196:199], v4 offset:1024
  v_add_u32 v6, 256, v6
  v_mfma_f32_16x16x32_bf16 v[176:179], v[208:211], v[128:131], v[176:179]
  ds_read_b128 v[240:243], v6 offset:0
  v_mfma_f32_16x16x32_bf16 v[180:183], v[208:211], v[132:135], v[180:183]
  ds_read_b128 v[200:203], v4 offset:2048
  v_mfma_f32_16x16x32_bf16 v[184:187], v[212:215], v[128:131], v[184:187]
  s_waitcnt lgkmcnt(8)
  v_mfma_f32_16x16x32_bf16 v[188:191], v[212:215], v[132:135], v[188:191]
  ds_read_b128 v[204:207], v4 offset:3072
  v_mfma_f32_16x16x32_bf16 v[176:179], v[216:219], v[136:139], v[176:179]
  ds_read_b128 v[244:247], v6 offset:64
  v_mfma_f32_16x16x32_bf16 v[180:183], v[216:219], v[140:143], v[180:183]
  ds_read_b128 v[208:211], v4 offset:4096
  v_mfma_f32_16x16x32_bf16 v[184:187], v[220:223], v[136:139], v[184:187]
  s_waitcnt lgkmcnt(9)
  v_mfma_f32_16x16x32_bf16 v[188:191], v[220:223], v[140:143], v[188:191]
  ds_read_b128 v[212:215], v4 offset:5120
  v_mfma_f32_16x16x32_bf16 v[176:179], v[224:227], v[144:147], v[176:179]
  v_mfma_f32_16x16x32_bf16 v[180:183], v[224:227], v[148:151], v[180:183]
  ds_read_b128 v[216:219], v4 offset:6144
  v_mfma_f32_16x16x32_bf16 v[184:187], v[228:231], v[144:147], v[184:187]
  s_waitcnt lgkmcnt(9)
  v_mfma_f32_16x16x32_bf16 v[188:191], v[228:231], v[148:151], v[188:191]
  ds_read_b128 v[220:223], v4 offset:7168
  v_mfma_f32_16x16x32_bf16 v[176:179], v[232:235], v[152:155], v[176:179]
  v_mfma_f32_16x16x32_bf16 v[180:183], v[232:235], v[156:159], v[180:183]
  ds_read_b128 v[224:227], v4 offset:8192
  v_mfma_f32_16x16x32_bf16 v[184:187], v[236:239], v[152:155], v[184:187]
  s_waitcnt lgkmcnt(9)
  v_mfma_f32_16x16x32_bf16 v[188:191], v[236:239], v[156:159], v[188:191]
  ds_read_b128 v[228:231], v4 offset:9216
  s_mov_b32 s49, 1
F1_LOOP:
  v_mfma_f32_16x16x32_bf16 v[160:163], v[192:195], v[16:19], 0
  v_mfma_f32_16x16x32_bf16 v[164:167], v[192:195], v[20:23], 0
  ds_read_b128 v[232:235], v4 offset:10240
  v_mfma_f32_16x16x32_bf16 v[168:171], v[196:199], v[16:19], 0
  s_waitcnt lgkmcnt(8)
  v_fmac_f32 v176, v2, v240
  v_mfma_f32_16x16x32_bf16 v[172:175], v[196:199], v[20:23], 0
  ds_read_b128 v[236:239], v4 offset:11264
  v_fmac_f32 v177, v2, v241
  v_mfma_f32_16x16x32_bf16 v[160:163], v[200:203], v[24:27], v[160:163]
  v_fmac_f32 v178, v2, v242
  v_fmac_f32 v179, v2, v243
  v_mfma_f32_16x16x32_bf16 v[164:167], v[200:203], v[28:31], v[164:167]
  ds_read_b128 v[192:195], v4 offset:12288
  s_waitcnt lgkmcnt(9)
  v_fmac_f32 v184, v2, v244
  v_mfma_f32_16x16x32_bf16 v[168:171], v[204:207], v[24:27], v[168:171]
  s_waitcnt lgkmcnt(7)
  v_fmac_f32 v185, v2, v245
  v_mfma_f32_16x16x32_bf16 v[172:175], v[204:207], v[28:31], v[172:175]
  ds_read_b128 v[196:199], v4 offset:13312
  v_fmac_f32 v186, v2, v246
  v_mfma_f32_16x16x32_bf16 v[160:163], v[208:211], v[32:35], v[160:163]
  v_fmac_f32 v187, v2, v247
  v_mul_f32 v176, v176, v184
  v_mfma_f32_16x16x32_bf16 v[164:167], v[208:211], v[36:39], v[164:167]
  ds_read_b128 v[200:203], v4 offset:14336
  v_mul_f32 v177, v177, v185
  v_mfma_f32_16x16x32_bf16 v[168:171], v[212:215], v[32:35], v[168:171]
  s_waitcnt lgkmcnt(7)
  v_mul_f32 v178, v178, v186
  v_mfma_f32_16x16x32_bf16 v[172:175], v[212:215], v[36:39], v[172:175]
  ds_read_b128 v[204:207], v4 offset:15360
  v_mul_f32 v179, v179, v187
  v_mfma_f32_16x16x32_bf16 v[160:163], v[216:219], v[40:43], v[160:163]
  v_cvt_pk_bf16_f32 v250, v176, v177
  v_cvt_pk_bf16_f32 v251, v178, v179
  v_mfma_f32_16x16x32_bf16 v[164:167], v[216:219], v[44:47], v[164:167]
  ds_read_b128 v[208:211], v4 offset:16384
  v_fmac_f32 v180, v3, v240
  v_mfma_f32_16x16x32_bf16 v[168:171], v[220:223], v[40:43], v[168:171]
  s_waitcnt lgkmcnt(7)
  v_fmac_f32 v181, v3, v241
  v_mfma_f32_16x16x32_bf16 v[172:175], v[220:223], v[44:47], v[172:175]
  ds_read_b128 v[212:215], v4 offset:17408
  v_fmac_f32 v182, v3, v242
  v_mfma_f32_16x16x32_bf16 v[160:163], v[224:227], v[48:51], v[160:163]
  v_fmac_f32 v183, v3, v243
  v_fmac_f32 v188, v3, v244
  v_mfma_f32_16x16x32_bf16 v[164:167], v[224:227], v[52:55], v[164:167]
  ds_read_b128 v[216:219], v4 offset:18432
  v_fmac_f32 v189, v3, v245
  v_mfma_f32_16x16x32_bf16 v[168:171], v[228:231], v[48:51], v[168:171]
  s_waitcnt lgkmcnt(7)
  v_fmac_f32 v190, v3, v246
  v_mfma_f32_16x16x32_bf16 v[172:175], v[228:231], v[52:55], v[172:175]
  ds_read_b128 v[220:223], v4 offset:19456
  v_fmac_f32 v191, v3, v247
  v_mfma_f32_16x16x32_bf16 v[160:163], v[232:235], v[56:59], v[160:163]
  v_mul_f32 v180, v180, v188
  v_mul_f32 v181, v181, v189
  v_mfma_f32_16x16x32_bf16 v[164:167], v[232:235], v[60:63], v[164:167]
  ds_read_b128 v[224:227], v4 offset:20480
  v_mul_f32 v182, v182, v190
  v_mfma_f32_16x16x32_bf16 v[168:171], v[236:239], v[56:59], v[168:171]
  s_waitcnt lgkmcnt(7)
  v_mul_f32 v183, v183, v191
  v_mfma_f32_16x16x32_bf16 v[172:175], v[236:239], v[60:63], v[172:175]
  ds_read_b128 v[228:231], v4 offset:21504
  v_cvt_pk_bf16_f32 v254, v180, v181
  v_mfma_f32_16x16x32_bf16 v[160:163], v[192:195], v[64:67], v[160:163]
  v_cvt_pk_bf16_f32 v255, v182, v183
  v_mfma_f32_16x16x32_bf16 v[164:167], v[192:195], v[68:71], v[164:167]
  ds_read_b128 v[232:235], v4 offset:22528
  v_mfma_f32_16x16x32_bf16 v[168:171], v[196:199], v[64:67], v[168:171]
  s_waitcnt lgkmcnt(7)
  v_mfma_f32_16x16x32_bf16 v[172:175], v[196:199], v[68:71], v[172:175]
  ds_read_b128 v[236:239], v4 offset:23552
  v_mfma_f32_16x16x32_bf16 v[160:163], v[200:203], v[72:75], v[160:163]
  v_mfma_f32_16x16x32_bf16 v[164:167], v[200:203], v[76:79], v[164:167]
  ds_read_b128 v[192:195], v4 offset:24576
  v_mfma_f32_16x16x32_bf16 v[168:171], v[204:207], v[72:75], v[168:171]
  s_waitcnt lgkmcnt(7)
  v_mfma_f32_16x16x32_bf16 v[172:175], v[204:207], v[76:79], v[172:175]
  ds_read_b128 v[196:199], v4 offset:25600
  v_mfma_f32_16x16x32_bf16 v[160:163], v[208:211], v[80:83], v[160:163]
  s_nop 0
  buffer_store_dwordx4 v[248:251], v1, s[40:43], s44 offen offset:0 sc0 sc1
  v_mfma_f32_16x16x32_bf16 v[164:167], v[208:211], v[84:87], v[164:167]
  ds_read_b128 v[200:203], v4 offset:26624
  v_mfma_f32_16x16x32_bf16 v[168:171], v[212:215], v[80:83], v[168:171]
  s_waitcnt lgkmcnt(7)
  v_mfma_f32_16x16x32_bf16 v[172:175], v[212:215], v[84:87], v[172:175]
  ds_read_b128 v[204:207], v4 offset:27648
  v_mfma_f32_16x16x32_bf16 v[160:163], v[216:219], v[88:91], v[160:163]
  s_nop 0
  buffer_store_dwordx4 v[252:255], v1, s[40:43], s44 offen offset:1024 sc0 sc1
  v_mfma_f32_16x16x32_bf16 v[164:167], v[216:219], v[92:95], v[164:167]
  ds_read_b128 v[208:211], v4 offset:28672
  s_add_u32 s44, s44, 8192
  v_mfma_f32_16x16x32_bf16 v[168:171], v[220:223], v[88:91], v[168:171]
  s_waitcnt lgkmcnt(7)
  v_mfma_f32_16x16x32_bf16 v[172:175], v[220:223], v[92:95], v[172:175]
  ds_read_b128 v[212:215], v4 offset:29696
  v_mfma_f32_16x16x32_bf16 v[160:163], v[224:227], v[96:99], v[160:163]
  v_mfma_f32_16x16x32_bf16 v[164:167], v[224:227], v[100:103], v[164:167]
  ds_read_b128 v[216:219], v4 offset:30720
  v_mfma_f32_16x16x32_bf16 v[168:171], v[228:231], v[96:99], v[168:171]
  s_waitcnt lgkmcnt(7)
  v_mfma_f32_16x16x32_bf16 v[172:175], v[228:231], v[100:103], v[172:175]
  ds_read_b128 v[220:223], v4 offset:31744
  v_mfma_f32_16x16x32_bf16 v[160:163], v[232:235], v[104:107], v[160:163]
  v_mfma_f32_16x16x32_bf16 v[164:167], v[232:235], v[108:111], v[164:167]
  ds_read_b128 v[224:227], v4 offset:32768
  v_mfma_f32_16x16x32_bf16 v[168:171], v[236:239], v[104:107], v[168:171]
  s_waitcnt lgkmcnt(7)
  v_mfma_f32_16x16x32_bf16 v[172:175], v[236:239], v[108:111], v[172:175]
  ds_read_b128 v[228:231], v4 offset:33792
  v_mfma_f32_16x16x32_bf16 v[160:163], v[192:195], v[112:115], v[160:163]
  v_mfma_f32_16x16x32_bf16 v[164:167], v[192:195], v[116:119], v[164:167]
  ds_read_b128 v[232:235], v4 offset:34816
  v_mfma_f32_16x16x32_bf16 v[168:171], v[196:199], v[112:115], v[168:171]
  s_waitcnt lgkmcnt(7)
  v_mfma_f32_16x16x32_bf16 v[172:175], v[196:199], v[116:119], v[172:175]
  ds_read_b128 v[236:239], v4 offset:35840
  s_barrier
  v_mfma_f32_16x16x32_bf16 v[160:163], v[200:203], v[120:123], v[160:163]
  v_mfma_f32_16x16x32_bf16 v[164:167], v[200:203], v[124:127], v[164:167]
  ds_read_b128 v[192:195], v5 offset:0
  v_mfma_f32_16x16x32_bf16 v[168:171], v[204:207], v[120:123], v[168:171]
  s_waitcnt lgkmcnt(7)
  v_mfma_f32_16x16x32_bf16 v[172:175], v[204:207], v[124:127], v[172:175]
  ds_read_b128 v[196:199], v5 offset:1024
  v_mfma_f32_16x16x32_bf16 v[160:163], v[208:211], v[128:131], v[160:163]
  ds_read_b128 v[240:243], v6 offset:128
  v_mfma_f32_16x16x32_bf16 v[164:167], v[208:211], v[132:135], v[164:167]
  ds_read_b128 v[200:203], v5 offset:2048
  v_mfma_f32_16x16x32_bf16 v[168:171], v[212:215], v[128:131], v[168:171]
  s_waitcnt lgkmcnt(8)
  v_mfma_f32_16x16x32_bf16 v[172:175], v[212:215], v[132:135], v[172:175]
  ds_read_b128 v[204:207], v5 offset:3072
  v_mfma_f32_16x16x32_bf16 v[160:163], v[216:219], v[136:139], v[160:163]
  ds_read_b128 v[244:247], v6 offset:192
  v_mfma_f32_16x16x32_bf16 v[164:167], v[216:219], v[140:143], v[164:167]
  ds_read_b128 v[208:211], v5 offset:4096
  v_mfma_f32_16x16x32_bf16 v[168:171], v[220:223], v[136:139], v[168:171]
  s_waitcnt lgkmcnt(9)
  v_mfma_f32_16x16x32_bf16 v[172:175], v[220:223], v[140:143], v[172:175]
  ds_read_b128 v[212:215], v5 offset:5120
  v_mfma_f32_16x16x32_bf16 v[160:163], v[224:227], v[144:147], v[160:163]
  v_mfma_f32_16x16x32_bf16 v[164:167], v[224:227], v[148:151], v[164:167]
  ds_read_b128 v[216:219], v5 offset:6144
  v_mfma_f32_16x16x32_bf16 v[168:171], v[228:231], v[144:147], v[168:171]
  s_waitcnt lgkmcnt(9)
  v_mfma_f32_16x16x32_bf16 v[172:175], v[228:231], v[148:151], v[172:175]
  ds_read_b128 v[220:223], v5 offset:7168
  v_mfma_f32_16x16x32_bf16 v[160:163], v[232:235], v[152:155], v[160:163]
  v_mfma_f32_16x16x32_bf16 v[164:167], v[232:235], v[156:159], v[164:167]
  ds_read_b128 v[224:227], v5 offset:8192
  v_mfma_f32_16x16x32_bf16 v[168:171], v[236:239], v[152:155], v[168:171]
  s_waitcnt lgkmcnt(9)
  v_mfma_f32_16x16x32_bf16 v[172:175], v[236:239], v[156:159], v[172:175]
  ds_read_b128 v[228:231], v5 offset:9216
  v_mfma_f32_16x16x32_bf16 v[176:179], v[192:195], v[16:19], 0
  v_mfma_f32_16x16x32_bf16 v[180:183], v[192:195], v[20:23], 0
  ds_read_b128 v[232:235], v5 offset:10240
  v_mfma_f32_16x16x32_bf16 v[184:187], v[196:199], v[16:19], 0
  s_waitcnt lgkmcnt(8)
  v_fmac_f32 v160, v2, v240
  v_mfma_f32_16x16x32_bf16 v[188:191], v[196:199], v[20:23], 0
  ds_read_b128 v[236:239], v5 offset:11264
  v_fmac_f32 v161, v2, v241
  v_mfma_f32_16x16x32_bf16 v[176:179], v[200:203], v[24:27], v[176:179]
  v_fmac_f32 v162, v2, v242
  v_fmac_f32 v163, v2, v243
  v_mfma_f32_16x16x32_bf16 v[180:183], v[200:203], v[28:31], v[180:183]
  ds_read_b128 v[192:195], v5 offset:12288
  s_waitcnt lgkmcnt(9)
  v_fmac_f32 v168, v2, v244
  v_mfma_f32_16x16x32_bf16 v[184:187], v[204:207], v[24:27], v[184:187]
  s_waitcnt lgkmcnt(7)
  v_fmac_f32 v169, v2, v245
  v_mfma_f32_16x16x32_bf16 v[188:191], v[204:207], v[28:31], v[188:191]
  ds_read_b128 v[196:199], v5 offset:13312
  v_fmac_f32 v170, v2, v246
  v_mfma_f32_16x16x32_bf16 v[176:179], v[208:211], v[32:35], v[176:179]
  v_fmac_f32 v171, v2, v247
  v_mul_f32 v160, v160, v168
  v_mfma_f32_16x16x32_bf16 v[180:183], v[208:211], v[36:39], v[180:183]
  ds_read_b128 v[200:203], v5 offset:14336
  v_mul_f32 v161, v161, v169
  v_mfma_f32_16x16x32_bf16 v[184:187], v[212:215], v[32:35], v[184:187]
  s_waitcnt lgkmcnt(7)
  v_mul_f32 v162, v162, v170
  v_mfma_f32_16x16x32_bf16 v[188:191], v[212:215], v[36:39], v[188:191]
  ds_read_b128 v[204:207], v5 offset:15360
  v_mul_f32 v163, v163, v171
  v_mfma_f32_16x16x32_bf16 v[176:179], v[216:219], v[40:43], v[176:179]
  v_cvt_pk_bf16_f32 v248, v160, v161
  v_cvt_pk_bf16_f32 v249, v162, v163
  v_mfma_f32_16x16x32_bf16 v[180:183], v[216:219], v[44:47], v[180:183]
  ds_read_b128 v[208:211], v5 offset:16384
  v_fmac_f32 v164, v3, v240
  v_mfma_f32_16x16x32_bf16 v[184:187], v[220:223], v[40:43], v[184:187]
  s_waitcnt lgkmcnt(7)
  v_fmac_f32 v165, v3, v241
  v_mfma_f32_16x16x32_bf16 v[188:191], v[220:223], v[44:47], v[188:191]
  ds_read_b128 v[212:215], v5 offset:17408
  v_fmac_f32 v166, v3, v242
  v_mfma_f32_16x16x32_bf16 v[176:179], v[224:227], v[48:51], v[176:179]
  v_fmac_f32 v167, v3, v243
  v_fmac_f32 v172, v3, v244
  v_mfma_f32_16x16x32_bf16 v[180:183], v[224:227], v[52:55], v[180:183]
  ds_read_b128 v[216:219], v5 offset:18432
  v_fmac_f32 v173, v3, v245
  v_mfma_f32_16x16x32_bf16 v[184:187], v[228:231], v[48:51], v[184:187]
  s_waitcnt lgkmcnt(7)
  v_fmac_f32 v174, v3, v246
  v_mfma_f32_16x16x32_bf16 v[188:191], v[228:231], v[52:55], v[188:191]
  ds_read_b128 v[220:223], v5 offset:19456
  v_fmac_f32 v175, v3, v247
  v_mfma_f32_16x16x32_bf16 v[176:179], v[232:235], v[56:59], v[176:179]
  v_mul_f32 v164, v164, v172
  v_mul_f32 v165, v165, v173
  v_mfma_f32_16x16x32_bf16 v[180:183], v[232:235], v[60:63], v[180:183]
  ds_read_b128 v[224:227], v5 offset:20480
  v_mul_f32 v166, v166, v174
  v_mfma_f32_16x16x32_bf16 v[184:187], v[236:239], v[56:59], v[184:187]
  s_waitcnt lgkmcnt(7)
  v_mul_f32 v167, v167, v175
  v_mfma_f32_16x16x32_bf16 v[188:191], v[236:239], v[60:63], v[188:191]
  ds_read_b128 v[228:231], v5 offset:21504
  v_cvt_pk_bf16_f32 v252, v164, v165
  v_mfma_f32_16x16x32_bf16 v[176:179], v[192:195], v[64:67], v[176:179]
  v_cvt_pk_bf16_f32 v253, v166, v167
  v_mfma_f32_16x16x32_bf16 v[180:183], v[192:195], v[68:71], v[180:183]
  ds_read_b128 v[232:235], v5 offset:22528
  v_mfma_f32_16x16x32_bf16 v[184:187], v[196:199], v[64:67], v[184:187]
  s_waitcnt lgkmcnt(7)
  v_mfma_f32_16x16x32_bf16 v[188:191], v[196:199], v[68:71], v[188:191]
  ds_read_b128 v[236:239], v5 offset:23552
  v_mfma_f32_16x16x32_bf16 v[176:179], v[200:203], v[72:75], v[176:179]
  v_mfma_f32_16x16x32_bf16 v[180:183], v[200:203], v[76:79], v[180:183]
  ds_read_b128 v[192:195], v5 offset:24576
  v_mfma_f32_16x16x32_bf16 v[184:187], v[204:207], v[72:75], v[184:187]
  s_waitcnt lgkmcnt(7)
  v_mfma_f32_16x16x32_bf16 v[188:191], v[204:207], v[76:79], v[188:191]
  ds_read_b128 v[196:199], v5 offset:25600
  v_mfma_f32_16x16x32_bf16 v[176:179], v[208:211], v[80:83], v[176:179]
  v_mfma_f32_16x16x32_bf16 v[180:183], v[208:211], v[84:87], v[180:183]
  ds_read_b128 v[200:203], v5 offset:26624
  v_mfma_f32_16x16x32_bf16 v[184:187], v[212:215], v[80:83], v[184:187]
  s_waitcnt lgkmcnt(7)
  v_mfma_f32_16x16x32_bf16 v[188:191], v[212:215], v[84:87], v[188:191]
  ds_read_b128 v[204:207], v5 offset:27648
  v_mfma_f32_16x16x32_bf16 v[176:179], v[216:219], v[88:91], v[176:179]
  v_mfma_f32_16x16x32_bf16 v[180:183], v[216:219], v[92:95], v[180:183]
  ds_read_b128 v[208:211], v5 offset:28672
  v_mfma_f32_16x16x32_bf16 v[184:187], v[220:223], v[88:91], v[184:187]
  s_waitcnt lgkmcnt(7)
  v_mfma_f32_16x16x32_bf16 v[188:191], v[220:223], v[92:95], v[188:191]
  ds_read_b128 v[212:215], v5 offset:29696
  v_mfma_f32_16x16x32_bf16 v[176:179], v[224:227], v[96:99], v[176:179]
  v_mfma_f32_16x16x32_bf16 v[180:183], v[224:227], v[100:103], v[180:183]
  ds_read_b128 v[216:219], v5 offset:30720
  v_mfma_f32_16x16x32_bf16 v[184:187], v[228:231], v[96:99], v[184:187]
  s_waitcnt lgkmcnt(7)
  v_mfma_f32_16x16x32_bf16 v[188:191], v[228:231], v[100:103], v[188:191]
  ds_read_b128 v[220:223], v5 offset:31744
  v_mfma_f32_16x16x32_bf16 v[176:179], v[232:235], v[104:107], v[176:179]
  v_mfma_f32_16x16x32_bf16 v[180:183], v[232:235], v[108:111], v[180:183]
  ds_read_b128 v[224:227], v5 offset:32768
  v_mfma_f32_16x16x32_bf16 v[184:187], v[236:239], v[104:107], v[184:187]
  s_waitcnt lgkmcnt(7)
  v_mfma_f32_16x16x32_bf16 v[188:191], v[236:239], v[108:111], v[188:191]
  ds_read_b128 v[228:231], v5 offset:33792
  v_mfma_f32_16x16x32_bf16 v[176:179], v[192:195], v[112:115], v[176:179]
  v_mfma_f32_16x16x32_bf16 v[180:183], v[192:195], v[116:119], v[180:183]
  ds_read_b128 v[232:235], v5 offset:34816
  v_mfma_f32_16x16x32_bf16 v[184:187], v[196:199], v[112:115], v[184:187]
  s_waitcnt lgkmcnt(7)
  v_mfma_f32_16x16x32_bf16 v[188:191], v[196:199], v[116:119], v[188:191]
  ds_read_b128 v[236:239], v5 offset:35840
  s_barrier
  v_mfma_f32_16x16x32_bf16 v[176:179], v[200:203], v[120:123], v[176:179]
  s_xor_b32 s22, s22, 73728
  v_add_u32 v4, s22, v1
  v_mfma_f32_16x16x32_bf16 v[180:183], v[200:203], v[124:127], v[180:183]
  ds_read_b128 v[192:195], v4 offset:0
  v_mfma_f32_16x16x32_bf16 v[184:187], v[204:207], v[120:123], v[184:187]
  s_waitcnt lgkmcnt(7)
  v_add_u32 v5, 36864, v4
  v_mfma_f32_16x16x32_bf16 v[188:191], v[204:207], v[124:127], v[188:191]
  ds_read_b128 v[196:199], v4 offset:1024
  v_add_u32 v6, 256, v6
  v_mfma_f32_16x16x32_bf16 v[176:179], v[208:211], v[128:131], v[176:179]
  ds_read_b128 v[240:243], v6 offset:0
  v_mfma_f32_16x16x32_bf16 v[180:183], v[208:211], v[132:135], v[180:183]
  ds_read_b128 v[200:203], v4 offset:2048
  v_mfma_f32_16x16x32_bf16 v[184:187], v[212:215], v[128:131], v[184:187]
  s_waitcnt lgkmcnt(8)
  v_mfma_f32_16x16x32_bf16 v[188:191], v[212:215], v[132:135], v[188:191]
  ds_read_b128 v[204:207], v4 offset:3072
  v_mfma_f32_16x16x32_bf16 v[176:179], v[216:219], v[136:139], v[176:179]
  ds_read_b128 v[244:247], v6 offset:64
  v_mfma_f32_16x16x32_bf16 v[180:183], v[216:219], v[140:143], v[180:183]
  ds_read_b128 v[208:211], v4 offset:4096
  v_mfma_f32_16x16x32_bf16 v[184:187], v[220:223], v[136:139], v[184:187]
  s_waitcnt lgkmcnt(9)
  v_mfma_f32_16x16x32_bf16 v[188:191], v[220:223], v[140:143], v[188:191]
  ds_read_b128 v[212:215], v4 offset:5120
  v_mfma_f32_16x16x32_bf16 v[176:179], v[224:227], v[144:147], v[176:179]
  v_mfma_f32_16x16x32_bf16 v[180:183], v[224:227], v[148:151], v[180:183]
  ds_read_b128 v[216:219], v4 offset:6144
  v_mfma_f32_16x16x32_bf16 v[184:187], v[228:231], v[144:147], v[184:187]
  s_waitcnt lgkmcnt(9)
  v_mfma_f32_16x16x32_bf16 v[188:191], v[228:231], v[148:151], v[188:191]
  ds_read_b128 v[220:223], v4 offset:7168
  v_mfma_f32_16x16x32_bf16 v[176:179], v[232:235], v[152:155], v[176:179]
  v_mfma_f32_16x16x32_bf16 v[180:183], v[232:235], v[156:159], v[180:183]
  ds_read_b128 v[224:227], v4 offset:8192
  v_mfma_f32_16x16x32_bf16 v[184:187], v[236:239], v[152:155], v[184:187]
  s_waitcnt lgkmcnt(9)
  v_mfma_f32_16x16x32_bf16 v[188:191], v[236:239], v[156:159], v[188:191]
  ds_read_b128 v[228:231], v4 offset:9216
  s_add_u32 s49, s49, 1
  s_cmp_le_u32 s49, 8
  s_cbranch_scc1 F1_LOOP
  s_waitcnt lgkmcnt(9)
  v_fmac_f32 v176, v2, v240
  v_fmac_f32 v177, v2, v241
  v_fmac_f32 v178, v2, v242
  v_fmac_f32 v179, v2, v243
  s_waitcnt lgkmcnt(6)
  v_fmac_f32 v184, v2, v244
  v_fmac_f32 v185, v2, v245
  v_fmac_f32 v186, v2, v246
  v_fmac_f32 v187, v2, v247
  v_mul_f32 v176, v176, v184
  v_mul_f32 v177, v177, v185
  v_mul_f32 v178, v178, v186
  v_mul_f32 v179, v179, v187
  v_cvt_pk_bf16_f32 v250, v176, v177
  v_cvt_pk_bf16_f32 v251, v178, v179
  v_fmac_f32 v180, v3, v240
  v_fmac_f32 v181, v3, v241
  v_fmac_f32 v182, v3, v242
  v_fmac_f32 v183, v3, v243
  v_fmac_f32 v188, v3, v244
  v_fmac_f32 v189, v3, v245
  v_fmac_f32 v190, v3, v246
  v_fmac_f32 v191, v3, v247
  v_mul_f32 v180, v180, v188
  v_mul_f32 v181, v181, v189
  v_mul_f32 v182, v182, v190
  v_mul_f32 v183, v183, v191
  v_cvt_pk_bf16_f32 v254, v180, v181
  v_cvt_pk_bf16_f32 v255, v182, v183
  buffer_store_dwordx4 v[248:251], v1, s[40:43], s44 offen offset:0 sc0 sc1
  buffer_store_dwordx4 v[252:255], v1, s[40:43], s44 offen offset:1024 sc0 sc1
  s_branch FB_NEXT
F1_PROD:
  s_mul_i32 s23, s16, 9216
  s_add_u32 s21, s21, s23
  s_add_u32 s40, s12, 0x6800000
  s_addc_u32 s41, s13, 0
  s_mov_b32 s42, 0x2400000
  s_mov_b32 s43, 0x00020000
  s_mov_b32 s50, 0x1200000
  s_mov_b32 s51, 0x2400000
  s_add_u32 s21, s21, 36864
  s_add_u32 s33, s23, 36864
  s_add_u32 m0, s33, 0
  s_add_u32 s34, s21, 0
  buffer_load_dwordx4 v1, s[24:27], s34 offen offset:0 sc0 sc1 lds
  buffer_load_dwordx4 v1, s[24:27], s34 offen offset:1024 sc0 sc1 lds
  buffer_load_dwordx4 v1, s[24:27], s34 offen offset:2048 sc0 sc1 lds
  buffer_load_dwordx4 v1, s[24:27], s34 offen offset:3072 sc0 sc1 lds
  s_add_u32 m0, s33, 4096
  s_add_u32 s34, s21, 4096
  buffer_load_dwordx4 v1, s[24:27], s34 offen offset:0 sc0 sc1 lds
  buffer_load_dwordx4 v1, s[24:27], s34 offen offset:1024 sc0 sc1 lds
  buffer_load_dwordx4 v1, s[24:27], s34 offen offset:2048 sc0 sc1 lds
  buffer_load_dwordx4 v1, s[24:27], s34 offen offset:3072 sc0 sc1 lds
  s_add_u32 m0, s33, 8192
  s_add_u32 s34, s21, 8192
  buffer_load_dwordx4 v1, s[24:27], s34 offen offset:0 sc0 sc1 lds
  s_waitcnt vmcnt(9)
  s_barrier
  s_add_u32 s21, s21, 36864
  s_add_u32 s33, s23, 73728
  s_add_u32 m0, s33, 0
  s_add_u32 s34, s21, 0
  buffer_load_dwordx4 v1, s[24:27], s34 offen offset:0 sc0 sc1 lds
  buffer_load_dwordx4 v1, s[24:27], s34 offen offset:1024 sc0 sc1 lds
  buffer_load_dwordx4 v1, s[24:27], s34 offen offset:2048 sc0 sc1 lds
  buffer_load_dwordx4 v1, s[24:27], s34 offen offset:3072 sc0 sc1 lds
  s_add_u32 m0, s33, 4096
  s_add_u32 s34, s21, 4096
  buffer_load_dwordx4 v1, s[24:27], s34 offen offset:0 sc0 sc1 lds
  buffer_load_dwordx4 v1, s[24:27], s34 offen offset:1024 sc0 sc1 lds
  buffer_load_dwordx4 v1, s[24:27], s34 offen offset:2048 sc0 sc1 lds
  buffer_load_dwordx4 v1, s[24:27], s34 offen offset:3072 sc0 sc1 lds
  s_add_u32 m0, s33, 8192
  s_add_u32 s34, s21, 8192
  buffer_load_dwordx4 v1, s[24:27], s34 offen offset:0 sc0 sc1 lds
  s_mov_b32 s22, 0
  s_mov_b32 s49, 0
F1_PLOOP:
  s_waitcnt vmcnt(9)
  s_barrier
  s_cmp_ge_u32 s49, 1
  s_cselect_b32 s42, s51, 0
  s_xor_b32 s22, s22, 73728
  s_add_u32 s33, s22, 36864
  s_add_u32 s33, s33, s23
  s_add_u32 s21, s21, 36864
  s_cmp_le_u32 s49, 7
  s_cselect_b32 s26, s50, 0
  s_add_u32 m0, s33, 0
  s_add_u32 s34, s21, 0
  buffer_load_dwordx4 v1, s[24:27], s34 offen offset:0 sc0 sc1 lds
  buffer_load_dwordx4 v1, s[24:27], s34 offen offset:1024 sc0 sc1 lds
  buffer_load_dwordx4 v1, s[24:27], s34 offen offset:2048 sc0 sc1 lds
  buffer_load_dwordx4 v1, s[24:27], s34 offen offset:3072 sc0 sc1 lds
  s_add_u32 m0, s33, 4096
  s_add_u32 s34, s21, 4096
  buffer_load_dwordx4 v1, s[24:27], s34 offen offset:0 sc0 sc1 lds
  buffer_load_dwordx4 v1, s[24:27], s34 offen offset:1024 sc0 sc1 lds
  buffer_load_dwordx4 v1, s[24:27], s34 offen offset:2048 sc0 sc1 lds
  buffer_load_dwordx4 v1, s[24:27], s34 offen offset:3072 sc0 sc1 lds
  s_add_u32 m0, s33, 8192
  s_add_u32 s34, s21, 8192
  buffer_load_dwordx4 v1, s[24:27], s34 offen offset:0 sc0 sc1 lds
  s_cmp_ge_u32 s49, 1
  s_cselect_b32 s34, 2048, 0
  s_add_u32 s44, s44, s34
  s_waitcnt lgkmcnt(0)
  s_waitcnt vmcnt(9)
  s_barrier
  s_xor_b32 s33, s22, 73728
  s_add_u32 s33, s33, s23
  s_add_u32 s21, s21, 36864
  s_cmp_le_u32 s49, 6
  s_cselect_b32 s26, s50, 0
  s_add_u32 m0, s33, 0
  s_add_u32 s34, s21, 0
  buffer_load_dwordx4 v1, s[24:27], s34 offen offset:0 sc0 sc1 lds
  buffer_load_dwordx4 v1, s[24:27], s34 offen offset:1024 sc0 sc1 lds
  buffer_load_dwordx4 v1, s[24:27], s34 offen offset:2048 sc0 sc1 lds
  buffer_load_dwordx4 v1, s[24:27], s34 offen offset:3072 sc0 sc1 lds
  s_add_u32 m0, s33, 4096
  s_add_u32 s34, s21, 4096
  buffer_load_dwordx4 v1, s[24:27], s34 offen offset:0 sc0 sc1 lds
  buffer_load_dwordx4 v1, s[24:27], s34 offen offset:1024 sc0 sc1 lds
  buffer_load_dwordx4 v1, s[24:27], s34 offen offset:2048 sc0 sc1 lds
  buffer_load_dwordx4 v1, s[24:27], s34 offen offset:3072 sc0 sc1 lds
  s_add_u32 m0, s33, 8192
  s_add_u32 s34, s21, 8192
  buffer_load_dwordx4 v1, s[24:27], s34 offen offset:0 sc0 sc1 lds
  s_waitcnt lgkmcnt(0)
  s_add_u32 s49, s49, 1
  s_cmp_le_u32 s49, 8
  s_cbranch_scc1 F1_PLOOP
  s_waitcnt vmcnt(0)
F1_END:
  s_branch FB_NEXT
FB_F2:
  s_load_dwordx2 s[12:13], s[0:1], 88
  s_load_dwordx2 s[4:5], s[0:1], 72
  s_cmp_ge_u32 s2, 256
  s_cbranch_scc1 F2_END
  v_and_b32 v6, 63, v0
  v_lshrrev_b32 v7, 6, v0
  s_nop 0
  v_readfirstlane_b32 s17, v7
  v_lshlrev_b32 v1, 4, v6
  s_and_b32 s16, s17, 3
  s_and_b32 s33, s2, 7
  s_lshr_b32 s34, s2, 3
  s_and_b32 s19, s33, 3
  s_lshr_b32 s33, s33, 2
  s_lshl_b32 s33, s33, 3
  s_lshr_b32 s20, s34, 2
  s_add_u32 s20, s20, s33
  s_and_b32 s18, s34, 3
  s_cmp_lt_u32 s17, 4
  s_cbranch_scc1 F2_CONS
  s_lshl_b32 s35, s20, 2
  s_add_u32 s35, s35, s16
  s_mul_i32 s35, s35, 144
  s_mul_i32 s33, s19, 36
  s_add_u32 s35, s35, s33
  s_lshl_b32 s35, s35, 11
  s_mul_i32 s47, s16, 5
  s_cmp_eq_u32 s16, 3
  s_cselect_b32 s33, 1, 0
  s_sub_u32 s47, s47, s33
  s_lshl_b32 s47, s47, 10
  s_lshl_b32 s48, s16, 12
  s_add_u32 s48, s48, 18432
  s_lshl_b32 s21, s19, 2
  s_add_u32 s21, s21, s18
  s_mul_i32 s21, s21, 331776
  s_add_u32 s21, s21, s47
  s_add_u32 s21, s21, 0xb00000
  s_waitcnt lgkmcnt(0)
  s_add_u32 s24, s12, 0x4000000
  s_addc_u32 s25, s13, 0
  s_mov_b32 s26, 0x1200000
  s_mov_b32 s27, 0x00020000
  s_add_u32 s36, s12, 0x6800000
  s_addc_u32 s37, s13, 0
  s_mov_b32 s38, 0x1200000
  s_mov_b32 s39, 0x00020000
  s_mov_b32 s50, 0x1200000
  s_mov_b32 s51, 0x1200000
  s_mov_b32 s33, 0
  s_add_u32 m0, s33, s47
  s_nop 0
  buffer_load_dwordx4 v1, s[24:27], s21 offen offset:0 sc0 sc1 lds
  buffer_load_dwordx4 v1, s[24:27], s21 offen offset:1024 sc0 sc1 lds
  buffer_load_dwordx4 v1, s[24:27], s21 offen offset:2048 sc0 sc1 lds
  buffer_load_dwordx4 v1, s[24:27], s21 offen offset:3072 sc0 sc1 lds
  s_add_u32 m0, s33, s48
  s_nop 0
  buffer_load_dwordx4 v1, s[36:39], s35 offen offset:0 sc0 sc1 lds
  buffer_load_dwordx4 v1, s[36:39], s35 offen offset:1024 sc0 sc1 lds
  buffer_load_dwordx4 v1, s[36:39], s35 offen offset:2048 sc0 sc1 lds
  buffer_load_dwordx4 v1, s[36:39], s35 offen offset:3072 sc0 sc1 lds
  s_cmp_ge_u32 s16, 2
  s_cbranch_scc1 F2_D0
  s_add_u32 s34, s33, s47
  s_add_u32 m0, s34, 4096
  s_add_u32 s34, s21, 4096
  buffer_load_dwordx4 v1, s[24:27], s34 offen sc0 sc1 lds
F2_D0:
  s_add_u32 s21, s21, 18432
  s_add_u32 s35, s35, 4096
  s_mov_b32 s33, 34816
  s_add_u32 m0, s33, s47
  s_nop 0
  buffer_load_dwordx4 v1, s[24:27], s21 offen offset:0 sc0 sc1 lds
  buffer_load_dwordx4 v1, s[24:27], s21 offen offset:1024 sc0 sc1 lds
  buffer_load_dwordx4 v1, s[24:27], s21 offen offset:2048 sc0 sc1 lds
  buffer_load_dwordx4 v1, s[24:27], s21 offen offset:3072 sc0 sc1 lds
  s_add_u32 m0, s33, s48
  s_nop 0
  buffer_load_dwordx4 v1, s[36:39], s35 offen offset:0 sc0 sc1 lds
  buffer_load_dwordx4 v1, s[36:39], s35 offen offset:1024 sc0 sc1 lds
  buffer_load_dwordx4 v1, s[36:39], s35 offen offset:2048 sc0 sc1 lds
  buffer_load_dwordx4 v1, s[36:39], s35 offen offset:3072 sc0 sc1 lds
  s_cmp_ge_u32 s16, 2
  s_cbranch_scc1 F2_D1
  s_add_u32 s34, s33, s47
  s_add_u32 m0, s34, 4096
  s_add_u32 s34, s21, 4096
  buffer_load_dwordx4 v1, s[24:27], s34 offen sc0 sc1 lds
F2_D1:
  s_add_u32 s21, s21, 18432
  s_add_u32 s35, s35, 4096
  s_waitcnt vmcnt(8)
  s_barrier
  s_mov_b32 s33, 69632
  s_add_u32 m0, s33, s47
  s_nop 0
  buffer_load_dwordx4 v1, s[24:27], s21 offen offset:0 sc0 sc1 lds
  buffer_load_dwordx4 v1, s[24:27], s21 offen offset:1024 sc0 sc1 lds
  buffer_load_dwordx4 v1, s[24:27], s21 offen offset:2048 sc0 sc1 lds
  buffer_load_dwordx4 v1, s[24:27], s21 offen offset:3072 sc0 sc1 lds
  s_add_u32 m0, s33, s48
  s_nop 0
  buffer_load_dwordx4 v1, s[36:39], s35 offen offset:0 sc0 sc1 lds
  buffer_load_dwordx4 v1, s[36:39], s35 offen offset:1024 sc0 sc1 lds
  buffer_load_dwordx4 v1, s[36:39], s35 offen offset:2048 sc0 sc1 lds
  buffer_load_dwordx4 v1, s[36:39], s35 offen offset:3072 sc0 sc1 lds
  s_cmp_ge_u32 s16, 2
  s_cbranch_scc1 F2_D2
  s_add_u32 s34, s33, s47
  s_add_u32 m0, s34, 4096
  s_add_u32 s34, s21, 4096
  buffer_load_dwordx4 v1, s[24:27], s34 offen sc0 sc1 lds
F2_D2:
  s_add_u32 s21, s21, 18432
  s_add_u32 s35, s35, 4096
  s_mov_b32 s33, 104448
  s_add_u32 m0, s33, s47
  s_nop 0
  buffer_load_dwordx4 v1, s[24:27], s21 offen offset:0 sc0 sc1 lds
  buffer_load_dwordx4 v1, s[24:27], s21 offen offset:1024 sc0 sc1 lds
  buffer_load_dwordx4 v1, s[24:27], s21 offen offset:2048 sc0 sc1 lds
  buffer_load_dwordx4 v1, s[24:27], s21 offen offset:3072 sc0 sc1 lds
  s_add_u32 m0, s33, s48
  s_nop 0
  buffer_load_dwordx4 v1, s[36:39], s35 offen offset:0 sc0 sc1 lds
  buffer_load_dwordx4 v1, s[36:39], s35 offen offset:1024 sc0 sc1 lds
  buffer_load_dwordx4 v1, s[36:39], s35 offen offset:2048 sc0 sc1 lds
  buffer_load_dwordx4 v1, s[36:39], s35 offen offset:3072 sc0 sc1 lds
  s_cmp_ge_u32 s16, 2
  s_cbranch_scc1 F2_D2B
  s_add_u32 s34, s33, s47
  s_add_u32 m0, s34, 4096
  s_add_u32 s34, s21, 4096
  buffer_load_dwordx4 v1, s[24:27], s34 offen sc0 sc1 lds
F2_D2B:
  s_add_u32 s21, s21, 18432
  s_add_u32 s35, s35, 4096
  s_mov_b32 s33, 0
  s_mov_b32 s49, 0
F2_PLOOP:
  s_waitcnt vmcnt(16)
  s_barrier
  s_cmp_le_u32 s49, 13
  s_cselect_b32 s26, s50, 0
  s_cselect_b32 s38, s51, 0
  s_add_u32 m0, s33, s47
  s_nop 0
  buffer_load_dwordx4 v1, s[24:27], s21 offen offset:0 sc0 sc1 lds
  buffer_load_dwordx4 v1, s[24:27], s21 offen offset:1024 sc0 sc1 lds
  buffer_load_dwordx4 v1, s[24:27], s21 offen offset:2048 sc0 sc1 lds
  buffer_load_dwordx4 v1, s[24:27], s21 offen offset:3072 sc0 sc1 lds
  s_add_u32 m0, s33, s48
  s_nop 0
  buffer_load_dwordx4 v1, s[36:39], s35 offen offset:0 sc0 sc1 lds
  buffer_load_dwordx4 v1, s[36:39], s35 offen offset:1024 sc0 sc1 lds
  buffer_load_dwordx4 v1, s[36:39], s35 offen offset:2048 sc0 sc1 lds
  buffer_load_dwordx4 v1, s[36:39], s35 offen offset:3072 sc0 sc1 lds
  s_cmp_ge_u32 s16, 2
  s_cbranch_scc1 F2_D3
  s_add_u32 s34, s33, s47
  s_add_u32 m0, s34, 4096
  s_add_u32 s34, s21, 4096
  buffer_load_dwordx4 v1, s[24:27], s34 offen sc0 sc1 lds
F2_D3:
  s_add_u32 s21, s21, 18432
  s_add_u32 s35, s35, 4096
  s_add_u32 s33, s33, 34816
  s_cmp_eq_u32 s33, 139264
  s_cselect_b32 s33, 0, s33
  s_add_u32 s49, s49, 1
  s_cmp_le_u32 s49, 17
  s_cbranch_scc1 F2_PLOOP
  s_waitcnt vmcnt(0)
F2_END:
  s_branch FB_NEXT
F2_CONS:
  v_mov_b32 v2, v1
  v_add_u32 v3, 34816, v1
  s_lshl_b32 s23, s16, 12
  s_add_u32 s23, s23, 18432
  v_add_u32 v4, s23, v1
  v_add_u32 v5, 34816, v4
  v_mov_b32 v16, 0
  v_mov_b32 v17, 0
  v_mov_b32 v18, 0
  v_mov_b32 v19, 0
  v_mov_b32 v20, 0
  v_mov_b32 v21, 0
  v_mov_b32 v22, 0
  v_mov_b32 v23, 0
  v_mov_b32 v24, 0
  v_mov_b32 v25, 0
  v_mov_b32 v26, 0
  v_mov_b32 v27, 0
  v_mov_b32 v28, 0
  v_mov_b32 v29, 0
  v_mov_b32 v30, 0
  v_mov_b32 v31, 0
  v_mov_b32 v32, 0
  v_mov_b32 v33, 0
  v_mov_b32 v34, 0
  v_mov_b32 v35, 0
  v_mov_b32 v36, 0
  v_mov_b32 v37, 0
  v_mov_b32 v38, 0
  v_mov_b32 v39, 0
  v_mov_b32 v40, 0
  v_mov_b32 v41, 0
  v_mov_b32 v42, 0
  v_mov_b32 v43, 0
  v_mov_b32 v44, 0
  v_mov_b32 v45, 0
  v_mov_b32 v46, 0
  v_mov_b32 v47, 0
  v_mov_b32 v48, 0
  v_mov_b32 v49, 0
  v_mov_b32 v50, 0
  v_mov_b32 v51, 0
  v_mov_b32 v52, 0
  v_mov_b32 v53, 0
  v_mov_b32 v54, 0
  v_mov_b32 v55, 0
  v_mov_b32 v56, 0
  v_mov_b32 v57, 0
  v_mov_b32 v58, 0
  v_mov_b32 v59, 0
  v_mov_b32 v60, 0
  v_mov_b32 v61, 0
  v_mov_b32 v62, 0
  v_mov_b32 v63, 0
  v_mov_b32 v64, 0
  v_mov_b32 v65, 0
  v_mov_b32 v66, 0
  v_mov_b32 v67, 0
  v_mov_b32 v68, 0
  v_mov_b32 v69, 0
  v_mov_b32 v70, 0
  v_mov_b32 v71, 0
  v_mov_b32 v72, 0
  v_mov_b32 v73, 0
  v_mov_b32 v74, 0
  v_mov_b32 v75, 0
  v_mov_b32 v76, 0
  v_mov_b32 v77, 0
  v_mov_b32 v78, 0
  v_mov_b32 v79, 0
  v_mov_b32 v80, 0
  v_mov_b32 v81, 0
  v_mov_b32 v82, 0
  v_mov_b32 v83, 0
  v_mov_b32 v84, 0
  v_mov_b32 v85, 0
  v_mov_b32 v86, 0
  v_mov_b32 v87, 0
  s_mov_b32 s22, 0
  s_waitcnt lgkmcnt(0)
  s_add_u32 s40, s12, 0x7a00000
  s_addc_u32 s41, s13, 0
  s_mov_b32 s42, 0x1200000
  s_mov_b32 s43, 0x00020000
  s_add_u32 s56, s12, 0x64c0000
  s_addc_u32 s57, s13, 0
  s_mov_b32 s58, 0x340000
  s_mov_b32 s59, 0x00020000
  s_mov_b32 s52, s4
  s_mov_b32 s53, s5
  s_mov_b32 s54, 0x240000
  s_mov_b32 s55, 0x00020000
  s_add_u32 s60, s12, 0x8c00000
  s_addc_u32 s61, s13, 0
  s_mov_b32 s62, 0x8000
  s_mov_b32 s63, 0x00020000
  v_and_b32 v13, 15, v6
  v_lshrrev_b32 v14, 4, v6
  s_lshl_b32 s46, s20, 2
  s_add_u32 s46, s46, s16
  s_lshl_b32 s33, s46, 5
  v_add_u32 v15, s33, v13
  v_mul_u32_u24 v180, 96, v15
  v_mul_u32_u24 v181, 24, v14
  v_add_u32 v180, v180, v181
  s_mov_b32 s33, 0x240000
  buffer_load_dwordx4 v[184:187], v180, s[56:59], s33 offen offset:0 sc0 sc1
  buffer_load_dwordx2 v[188:189], v180, s[56:59], s33 offen offset:16 sc0 sc1
  buffer_load_dwordx4 v[190:193], v180, s[56:59], s33 offen offset:1536 sc0 sc1
  buffer_load_dwordx2 v[194:195], v180, s[56:59], s33 offen offset:1552 sc0 sc1
  v_lshrrev_b32 v10, 1, v14
  v_lshlrev_b32 v10, 8, v10
  v_lshl_add_u32 v10, v13, 4, v10
  v_and_b32 v181, 1, v14
  v_lshl_add_u32 v10, v181, 3, v10
  v_mul_u32_u24 v11, 1152, v15
  v_lshl_add_u32 v11, v14, 3, v11
  s_lshl_b32 s45, s19, 1
  s_add_u32 s45, s45, 1
  s_cmp_eq_u32 s19, 0
  s_cselect_b32 s45, 0, s45
  s_mul_i32 s44, s46, 36864
  s_mul_i32 s33, s18, 9
  s_lshl_b32 s33, s33, 9
  s_add_u32 s44, s44, s33
  s_lshl_b32 s33, s45, 9
  s_add_u32 s33, s33, s44
  s_add_u32 s34, s33, 18432
  buffer_load_dwordx2 v[168:169], v10, s[56:59], s33 offen offset:0 sc0 sc1
  buffer_load_dwordx2 v[170:171], v10, s[56:59], s34 offen offset:0 sc0 sc1
  buffer_load_dwordx2 v[172:173], v10, s[56:59], s33 offen offset:512 sc0 sc1
  buffer_load_dwordx2 v[174:175], v10, s[56:59], s34 offen offset:512 sc0 sc1
  buffer_load_dwordx2 v[176:177], v10, s[56:59], s33 offen offset:1024 sc0 sc1
  buffer_load_dwordx2 v[178:179], v10, s[56:59], s34 offen offset:1024 sc0 sc1
  s_waitcnt vmcnt(9)
  v_add_f32 v184, v184, v186
  v_add_f32 v185, v185, v187
  s_waitcnt vmcnt(8)
  v_add_f32 v184, v184, v188
  v_add_f32 v185, v185, v189
  v_mov_b32 v181, v184
  s_nop 1
  v_permlane16_swap_b32 v184, v181
  v_add_f32 v184, v184, v181
  v_mov_b32 v181, v184
  s_nop 1
  v_permlane32_swap_b32 v184, v181
  v_add_f32 v184, v184, v181
  v_mov_b32 v181, v185
  s_nop 1
  v_permlane16_swap_b32 v185, v181
  v_add_f32 v185, v185, v181
  v_mov_b32 v181, v185
  s_nop 1
  v_permlane32_swap_b32 v185, v181
  v_add_f32 v185, v185, v181
  v_mul_f32 v184, 0x3ae38e39, v184
  v_mul_f32 v185, 0x3ae38e39, v185
  v_fma_f32 v185, -v184, v184, v185
  v_max_f32 v185, 0, v185
  v_add_f32 v185, 0x3727c5ac, v185
  v_rcp_f32 v184, v185
  s_nop 0
  v_mov_b32 v8, v184
  s_waitcnt vmcnt(7)
  v_add_f32 v190, v190, v192
  v_add_f32 v191, v191, v193
  s_waitcnt vmcnt(6)
  v_add_f32 v190, v190, v194
  v_add_f32 v191, v191, v195
  v_mov_b32 v181, v190
  s_nop 1
  v_permlane16_swap_b32 v190, v181
  v_add_f32 v190, v190, v181
  v_mov_b32 v181, v190
  s_nop 1
  v_permlane32_swap_b32 v190, v181
  v_add_f32 v190, v190, v181
  v_mov_b32 v181, v191
  s_nop 1
  v_permlane16_swap_b32 v191, v181
  v_add_f32 v191, v191, v181
  v_mov_b32 v181, v191
  s_nop 1
  v_permlane32_swap_b32 v191, v181
  v_add_f32 v191, v191, v181
  v_mul_f32 v190, 0x3ae38e39, v190
  v_mul_f32 v191, 0x3ae38e39, v191
  v_fma_f32 v191, -v190, v190, v191
  v_max_f32 v191, 0, v191
  v_add_f32 v191, 0x3727c5ac, v191
  v_rcp_f32 v190, v191
  s_nop 0
  v_mov_b32 v9, v190
  s_barrier
  ds_read_b128 v[88:91], v4 offset:0
  ds_read_b128 v[92:95], v4 offset:1024
  ds_read_b128 v[96:99], v4 offset:2048
  ds_read_b128 v[100:103], v4 offset:3072
  ds_read_b128 v[120:123], v2 offset:0
  ds_read_b128 v[124:127], v2 offset:1024
  ds_read_b128 v[128:131], v2 offset:2048
  ds_read_b128 v[132:135], v2 offset:3072
  ds_read_b128 v[136:139], v2 offset:4096
  ds_read_b128 v[140:143], v2 offset:5120
  ds_read_b128 v[144:147], v2 offset:6144
  ds_read_b128 v[148:151], v2 offset:7168
  s_mov_b32 s49, 0
F2_LOOP:
  s_waitcnt lgkmcnt(7)
  v_mfma_f32_16x16x32_bf16 v[16:19], v[120:123], v[88:91], v[16:19]
  ds_read_b128 v[152:155], v2 offset:8192
  s_waitcnt lgkmcnt(8)
  v_mfma_f32_16x16x32_bf16 v[20:23], v[120:123], v[92:95], v[20:23]
  ds_read_b128 v[156:159], v2 offset:9216
  s_waitcnt lgkmcnt(8)
  v_mfma_f32_16x16x32_bf16 v[24:27], v[124:127], v[88:91], v[24:27]
  ds_read_b128 v[160:163], v2 offset:10240
  v_mfma_f32_16x16x32_bf16 v[28:31], v[124:127], v[92:95], v[28:31]
  ds_read_b128 v[164:167], v2 offset:11264
  s_waitcnt lgkmcnt(9)
  v_mfma_f32_16x16x32_bf16 v[32:35], v[128:131], v[88:91], v[32:35]
  ds_read_b128 v[120:123], v2 offset:12288
  v_mfma_f32_16x16x32_bf16 v[36:39], v[128:131], v[92:95], v[36:39]
  ds_read_b128 v[124:127], v2 offset:13312
  s_waitcnt lgkmcnt(10)
  v_mfma_f32_16x16x32_bf16 v[40:43], v[132:135], v[88:91], v[40:43]
  s_waitcnt lgkmcnt(8)
  v_mfma_f32_16x16x32_bf16 v[44:47], v[132:135], v[92:95], v[44:47]
  ds_read_b128 v[128:131], v2 offset:14336
  v_mfma_f32_16x16x32_bf16 v[48:51], v[136:139], v[88:91], v[48:51]
  v_mfma_f32_16x16x32_bf16 v[52:55], v[136:139], v[92:95], v[52:55]
  ds_read_b128 v[132:135], v2 offset:15360
  v_mfma_f32_16x16x32_bf16 v[56:59], v[140:143], v[88:91], v[56:59]
  s_waitcnt lgkmcnt(8)
  v_mfma_f32_16x16x32_bf16 v[60:63], v[140:143], v[92:95], v[60:63]
  ds_read_b128 v[136:139], v2 offset:16384
  v_mfma_f32_16x16x32_bf16 v[64:67], v[144:147], v[88:91], v[64:67]
  v_mfma_f32_16x16x32_bf16 v[68:71], v[144:147], v[92:95], v[68:71]
  ds_read_b128 v[140:143], v2 offset:17408
  v_mfma_f32_16x16x32_bf16 v[72:75], v[148:151], v[88:91], v[72:75]
  s_waitcnt lgkmcnt(8)
  v_mfma_f32_16x16x32_bf16 v[76:79], v[148:151], v[92:95], v[76:79]
  v_mfma_f32_16x16x32_bf16 v[80:83], v[152:155], v[88:91], v[80:83]
  v_mfma_f32_16x16x32_bf16 v[84:87], v[152:155], v[92:95], v[84:87]
  v_mfma_f32_16x16x32_bf16 v[16:19], v[156:159], v[96:99], v[16:19]
  s_waitcnt lgkmcnt(6)
  v_mfma_f32_16x16x32_bf16 v[20:23], v[156:159], v[100:103], v[20:23]
  v_mfma_f32_16x16x32_bf16 v[24:27], v[160:163], v[96:99], v[24:27]
  v_mfma_f32_16x16x32_bf16 v[28:31], v[160:163], v[100:103], v[28:31]
  v_add_u32 v3, 34816, v2
  v_mfma_f32_16x16x32_bf16 v[32:35], v[164:167], v[96:99], v[32:35]
  v_mfma_f32_16x16x32_bf16 v[36:39], v[164:167], v[100:103], v[36:39]
  v_add_u32 v5, 34816, v4
  s_waitcnt lgkmcnt(0)
  s_barrier
  v_mfma_f32_16x16x32_bf16 v[40:43], v[120:123], v[96:99], v[40:43]
  ds_read_b128 v[144:147], v3 offset:0
  v_mfma_f32_16x16x32_bf16 v[44:47], v[120:123], v[100:103], v[44:47]
  ds_read_b128 v[148:151], v3 offset:1024
  v_mfma_f32_16x16x32_bf16 v[48:51], v[124:127], v[96:99], v[48:51]
  ds_read_b128 v[104:107], v5 offset:0
  v_mfma_f32_16x16x32_bf16 v[52:55], v[124:127], v[100:103], v[52:55]
  ds_read_b128 v[152:155], v3 offset:2048
  v_mfma_f32_16x16x32_bf16 v[56:59], v[128:131], v[96:99], v[56:59]
  ds_read_b128 v[108:111], v5 offset:1024
  v_mfma_f32_16x16x32_bf16 v[60:63], v[128:131], v[100:103], v[60:63]
  ds_read_b128 v[156:159], v3 offset:3072
  v_mfma_f32_16x16x32_bf16 v[64:67], v[132:135], v[96:99], v[64:67]
  ds_read_b128 v[160:163], v3 offset:4096
  v_mfma_f32_16x16x32_bf16 v[68:71], v[132:135], v[100:103], v[68:71]
  ds_read_b128 v[164:167], v3 offset:5120
  v_mfma_f32_16x16x32_bf16 v[72:75], v[136:139], v[96:99], v[72:75]
  ds_read_b128 v[112:115], v5 offset:2048
  v_mfma_f32_16x16x32_bf16 v[76:79], v[136:139], v[100:103], v[76:79]
  ds_read_b128 v[120:123], v3 offset:6144
  v_mfma_f32_16x16x32_bf16 v[80:83], v[140:143], v[96:99], v[80:83]
  ds_read_b128 v[116:119], v5 offset:3072
  v_mfma_f32_16x16x32_bf16 v[84:87], v[140:143], v[100:103], v[84:87]
  ds_read_b128 v[124:127], v3 offset:7168
  s_waitcnt lgkmcnt(9)
  v_mfma_f32_16x16x32_bf16 v[16:19], v[144:147], v[104:107], v[16:19]
  ds_read_b128 v[128:131], v3 offset:8192
  s_waitcnt lgkmcnt(8)
  v_mfma_f32_16x16x32_bf16 v[20:23], v[144:147], v[108:111], v[20:23]
  ds_read_b128 v[132:135], v3 offset:9216
  v_mfma_f32_16x16x32_bf16 v[24:27], v[148:151], v[104:107], v[24:27]
  ds_read_b128 v[136:139], v3 offset:10240
  v_mfma_f32_16x16x32_bf16 v[28:31], v[148:151], v[108:111], v[28:31]
  ds_read_b128 v[140:143], v3 offset:11264
  v_mfma_f32_16x16x32_bf16 v[32:35], v[152:155], v[104:107], v[32:35]
  ds_read_b128 v[144:147], v3 offset:12288
  v_mfma_f32_16x16x32_bf16 v[36:39], v[152:155], v[108:111], v[36:39]
  ds_read_b128 v[148:151], v3 offset:13312
  s_waitcnt lgkmcnt(12)
  v_mfma_f32_16x16x32_bf16 v[40:43], v[156:159], v[104:107], v[40:43]
  s_waitcnt lgkmcnt(10)
  v_mfma_f32_16x16x32_bf16 v[44:47], v[156:159], v[108:111], v[44:47]
  ds_read_b128 v[152:155], v3 offset:14336
  v_mfma_f32_16x16x32_bf16 v[48:51], v[160:163], v[104:107], v[48:51]
  v_mfma_f32_16x16x32_bf16 v[52:55], v[160:163], v[108:111], v[52:55]
  ds_read_b128 v[156:159], v3 offset:15360
  v_mfma_f32_16x16x32_bf16 v[56:59], v[164:167], v[104:107], v[56:59]
  s_waitcnt lgkmcnt(8)
  v_mfma_f32_16x16x32_bf16 v[60:63], v[164:167], v[108:111], v[60:63]
  ds_read_b128 v[160:163], v3 offset:16384
  v_mfma_f32_16x16x32_bf16 v[64:67], v[120:123], v[104:107], v[64:67]
  v_mfma_f32_16x16x32_bf16 v[68:71], v[120:123], v[108:111], v[68:71]
  ds_read_b128 v[164:167], v3 offset:17408
  v_mfma_f32_16x16x32_bf16 v[72:75], v[124:127], v[104:107], v[72:75]
  s_waitcnt lgkmcnt(8)
  v_mfma_f32_16x16x32_bf16 v[76:79], v[124:127], v[108:111], v[76:79]
  v_mfma_f32_16x16x32_bf16 v[80:83], v[128:131], v[104:107], v[80:83]
  v_mfma_f32_16x16x32_bf16 v[84:87], v[128:131], v[108:111], v[84:87]
  v_mfma_f32_16x16x32_bf16 v[16:19], v[132:135], v[112:115], v[16:19]
  s_waitcnt lgkmcnt(6)
  v_mfma_f32_16x16x32_bf16 v[20:23], v[132:135], v[116:119], v[20:23]
  s_xor_b32 s22, s22, 69632
  v_mfma_f32_16x16x32_bf16 v[24:27], v[136:139], v[112:115], v[24:27]
  v_mfma_f32_16x16x32_bf16 v[28:31], v[136:139], v[116:119], v[28:31]
  v_add_u32 v2, s22, v1
  v_mfma_f32_16x16x32_bf16 v[32:35], v[140:143], v[112:115], v[32:35]
  v_mfma_f32_16x16x32_bf16 v[36:39], v[140:143], v[116:119], v[36:39]
  v_add_u32 v4, s23, v2
  s_waitcnt lgkmcnt(0)
  s_barrier
  v_mfma_f32_16x16x32_bf16 v[40:43], v[144:147], v[112:115], v[40:43]
  ds_read_b128 v[120:123], v2 offset:0
  v_mfma_f32_16x16x32_bf16 v[44:47], v[144:147], v[116:119], v[44:47]
  ds_read_b128 v[124:127], v2 offset:1024
  v_mfma_f32_16x16x32_bf16 v[48:51], v[148:151], v[112:115], v[48:51]
  ds_read_b128 v[88:91], v4 offset:0
  v_mfma_f32_16x16x32_bf16 v[52:55], v[148:151], v[116:119], v[52:55]
  ds_read_b128 v[128:131], v2 offset:2048
  v_mfma_f32_16x16x32_bf16 v[56:59], v[152:155], v[112:115], v[56:59]
  ds_read_b128 v[92:95], v4 offset:1024
  v_mfma_f32_16x16x32_bf16 v[60:63], v[152:155], v[116:119], v[60:63]
  ds_read_b128 v[132:135], v2 offset:3072
  v_mfma_f32_16x16x32_bf16 v[64:67], v[156:159], v[112:115], v[64:67]
  ds_read_b128 v[136:139], v2 offset:4096
  v_mfma_f32_16x16x32_bf16 v[68:71], v[156:159], v[116:119], v[68:71]
  ds_read_b128 v[140:143], v2 offset:5120
  v_mfma_f32_16x16x32_bf16 v[72:75], v[160:163], v[112:115], v[72:75]
  ds_read_b128 v[96:99], v4 offset:2048
  v_mfma_f32_16x16x32_bf16 v[76:79], v[160:163], v[116:119], v[76:79]
  ds_read_b128 v[144:147], v2 offset:6144
  v_mfma_f32_16x16x32_bf16 v[80:83], v[164:167], v[112:115], v[80:83]
  ds_read_b128 v[100:103], v4 offset:3072
  v_mfma_f32_16x16x32_bf16 v[84:87], v[164:167], v[116:119], v[84:87]
  ds_read_b128 v[148:151], v2 offset:7168
  s_add_u32 s49, s49, 1
  s_cmp_le_u32 s49, 8
  s_cbranch_scc1 F2_LOOP
  s_nop 7
  s_lshl_b32 s35, s20, 2
  s_add_u32 s35, s35, s18
  s_lshl_b32 s35, s35, 2
  s_add_u32 s35, s35, s16
  s_mul_i32 s34, s35, 36864
  s_lshl_b32 s35, s35, 7
  s_mul_i32 s47, s18, 288
  v_mov_b32 v12, 0
  s_cmp_eq_u32 s19, 1
  s_cbranch_scc1 F2_EPI1
  s_cmp_eq_u32 s19, 2
  s_cbranch_scc1 F2_EPI2
  s_cmp_eq_u32 s19, 3
  s_cbranch_scc1 F2_EPI3
F2_EPI0:
  v_cvt_pk_bf16_f32 v88, v40, v41
  v_cvt_pk_bf16_f32 v89, v42, v43
  v_cvt_pk_bf16_f32 v90, v44, v45
  v_cvt_pk_bf16_f32 v91, v46, v47
  s_add_u32 s33, s34, 0
  buffer_store_dwordx4 v[88:91], v1, s[40:43], s33 offen offset:3072 sc0 sc1
  v_cvt_pk_bf16_f32 v92, v48, v49
  v_cvt_pk_bf16_f32 v93, v50, v51
  v_cvt_pk_bf16_f32 v94, v52, v53
  v_cvt_pk_bf16_f32 v95, v54, v55
  s_add_u32 s33, s34, 4096
  buffer_store_dwordx4 v[92:95], v1, s[40:43], s33 offen offset:0 sc0 sc1
  v_cvt_pk_bf16_f32 v96, v56, v57
  v_cvt_pk_bf16_f32 v97, v58, v59
  v_cvt_pk_bf16_f32 v98, v60, v61
  v_cvt_pk_bf16_f32 v99, v62, v63
  s_add_u32 s33, s34, 4096
  buffer_store_dwordx4 v[96:99], v1, s[40:43], s33 offen offset:1024 sc0 sc1
  v_cvt_pk_bf16_f32 v100, v64, v65
  v_cvt_pk_bf16_f32 v101, v66, v67
  v_cvt_pk_bf16_f32 v102, v68, v69
  v_cvt_pk_bf16_f32 v103, v70, v71
  s_add_u32 s33, s34, 4096
  buffer_store_dwordx4 v[100:103], v1, s[40:43], s33 offen offset:2048 sc0 sc1
  v_cvt_pk_bf16_f32 v104, v72, v73
  v_cvt_pk_bf16_f32 v105, v74, v75
  v_cvt_pk_bf16_f32 v106, v76, v77
  v_cvt_pk_bf16_f32 v107, v78, v79
  s_add_u32 s33, s34, 4096
  buffer_store_dwordx4 v[104:107], v1, s[40:43], s33 offen offset:3072 sc0 sc1
  v_cvt_pk_bf16_f32 v108, v80, v81
  v_cvt_pk_bf16_f32 v109, v82, v83
  v_cvt_pk_bf16_f32 v110, v84, v85
  v_cvt_pk_bf16_f32 v111, v86, v87
  s_add_u32 s33, s34, 8192
  buffer_store_dwordx4 v[108:111], v1, s[40:43], s33 offen offset:0 sc0 sc1
  s_waitcnt vmcnt(0)
  v_mov_b32 v13, 1
  s_mov_b64 exec, 1
  buffer_atomic_add v13, v12, s[60:63], s35 offen sc0 sc1
  s_waitcnt vmcnt(0)
  s_mov_b64 exec, -1
  v_readfirstlane_b32 s36, v13
  s_mov_b32 s38, 0
  s_and_b32 s37, s36, 7
  s_cmp_eq_u32 s37, 3
  s_cbranch_scc0 F2_POLL0
  s_lshr_b32 s38, s36, 4
  s_branch F2_GO0
F2_POLL0:
  s_mov_b32 s39, 0
F2_PL0:
  s_cmp_eq_u32 s39, 0
  s_cbranch_scc1 F2_TMO0
  s_sub_u32 s39, s39, 1
  buffer_load_dword v13, v12, s[60:63], s35 offen sc0 sc1
  s_waitcnt vmcnt(0)
  v_readfirstlane_b32 s36, v13
  s_and_b32 s37, s36, 7
  s_cmp_eq_u32 s37, 4
  s_cbranch_scc0 F2_PL0
  s_branch F2_GO0
F2_TMO0:
  v_cvt_pk_bf16_f32 v88, v16, v17
  v_cvt_pk_bf16_f32 v89, v18, v19
  v_cvt_pk_bf16_f32 v90, v20, v21
  v_cvt_pk_bf16_f32 v91, v22, v23
  s_add_u32 s33, s34, 0
  buffer_store_dwordx4 v[88:91], v1, s[40:43], s33 offen offset:0 sc0 sc1
  v_cvt_pk_bf16_f32 v92, v24, v25
  v_cvt_pk_bf16_f32 v93, v26, v27
  v_cvt_pk_bf16_f32 v94, v28, v29
  v_cvt_pk_bf16_f32 v95, v30, v31
  s_add_u32 s33, s34, 0
  buffer_store_dwordx4 v[92:95], v1, s[40:43], s33 offen offset:1024 sc0 sc1
  v_cvt_pk_bf16_f32 v96, v32, v33
  v_cvt_pk_bf16_f32 v97, v34, v35
  v_cvt_pk_bf16_f32 v98, v36, v37
  v_cvt_pk_bf16_f32 v99, v38, v39
  s_add_u32 s33, s34, 0
  buffer_store_dwordx4 v[96:99], v1, s[40:43], s33 offen offset:2048 sc0 sc1
  s_waitcnt vmcnt(0)
  v_mov_b32 v13, 16
  s_mov_b64 exec, 1
  buffer_atomic_or v13, v12, s[60:63], s35 offen sc0 sc1
  s_waitcnt vmcnt(0)
  s_mov_b64 exec, -1
  v_readfirstlane_b32 s36, v13
  s_and_b32 s37, s36, 7
  s_cmp_eq_u32 s37, 4
  s_cbranch_scc1 F2_GO0
  s_branch FB_NEXT
F2_GO0:
  s_add_u32 s33, s34, 8192
  buffer_load_dwordx4 v[88:91], v1, s[40:43], s33 offen offset:1024 sc0 sc1
  s_add_u32 s33, s34, 16384
  buffer_load_dwordx4 v[92:95], v1, s[40:43], s33 offen offset:2048 sc0 sc1
  s_add_u32 s33, s34, 24576
  buffer_load_dwordx4 v[96:99], v1, s[40:43], s33 offen offset:3072 sc0 sc1
  s_add_u32 s33, s34, 8192
  buffer_load_dwordx4 v[100:103], v1, s[40:43], s33 offen offset:2048 sc0 sc1
  s_add_u32 s33, s34, 16384
  buffer_load_dwordx4 v[104:107], v1, s[40:43], s33 offen offset:3072 sc0 sc1
  s_add_u32 s33, s34, 28672
  buffer_load_dwordx4 v[108:111], v1, s[40:43], s33 offen offset:0 sc0 sc1
  s_add_u32 s33, s34, 8192
  buffer_load_dwordx4 v[112:115], v1, s[40:43], s33 offen offset:3072 sc0 sc1
  s_add_u32 s33, s34, 20480
  buffer_load_dwordx4 v[116:119], v1, s[40:43], s33 offen offset:0 sc0 sc1
  s_add_u32 s33, s34, 28672
  buffer_load_dwordx4 v[120:123], v1, s[40:43], s33 offen offset:1024 sc0 sc1
  s_waitcnt vmcnt(8)
  v_lshlrev_b32 v128, 16, v88
  v_and_b32 v129, 0xffff0000, v88
  v_lshlrev_b32 v130, 16, v89
  v_and_b32 v131, 0xffff0000, v89
  v_add_f32 v16, v16, v128
  v_add_f32 v17, v17, v129
  v_add_f32 v18, v18, v130
  v_add_f32 v19, v19, v131
  s_waitcnt vmcnt(7)
  v_lshlrev_b32 v128, 16, v92
  v_and_b32 v129, 0xffff0000, v92
  v_lshlrev_b32 v130, 16, v93
  v_and_b32 v131, 0xffff0000, v93
  v_add_f32 v16, v16, v128
  v_add_f32 v17, v17, v129
  v_add_f32 v18, v18, v130
  v_add_f32 v19, v19, v131
  s_waitcnt vmcnt(6)
  v_lshlrev_b32 v128, 16, v96
  v_and_b32 v129, 0xffff0000, v96
  v_lshlrev_b32 v130, 16, v97
  v_and_b32 v131, 0xffff0000, v97
  v_add_f32 v16, v16, v128
  v_add_f32 v17, v17, v129
  v_add_f32 v18, v18, v130
  v_add_f32 v19, v19, v131
  v_lshlrev_b32 v128, 16, v168
  v_and_b32 v129, 0xffff0000, v168
  v_lshlrev_b32 v130, 16, v169
  v_and_b32 v131, 0xffff0000, v169
  v_fma_f32 v128, v16, v8, v128
  v_fma_f32 v129, v17, v8, v129
  v_fma_f32 v130, v18, v8, v130
  v_fma_f32 v131, v19, v8, v131
  v_cvt_pk_bf16_f32 v128, v128, v129
  v_cvt_pk_bf16_f32 v129, v130, v131
  s_add_u32 s33, s47, 0
  buffer_store_dwordx2 v[128:129], v11, s[52:55], s33 offen sc0 sc1
  v_lshlrev_b32 v136, 16, v90
  v_and_b32 v137, 0xffff0000, v90
  v_lshlrev_b32 v138, 16, v91
  v_and_b32 v139, 0xffff0000, v91
  v_add_f32 v20, v20, v136
  v_add_f32 v21, v21, v137
  v_add_f32 v22, v22, v138
  v_add_f32 v23, v23, v139
  v_lshlrev_b32 v136, 16, v94
  v_and_b32 v137, 0xffff0000, v94
  v_lshlrev_b32 v138, 16, v95
  v_and_b32 v139, 0xffff0000, v95
  v_add_f32 v20, v20, v136
  v_add_f32 v21, v21, v137
  v_add_f32 v22, v22, v138
  v_add_f32 v23, v23, v139
  v_lshlrev_b32 v136, 16, v98
  v_and_b32 v137, 0xffff0000, v98
  v_lshlrev_b32 v138, 16, v99
  v_and_b32 v139, 0xffff0000, v99
  v_add_f32 v20, v20, v136
  v_add_f32 v21, v21, v137
  v_add_f32 v22, v22, v138
  v_add_f32 v23, v23, v139
  v_lshlrev_b32 v136, 16, v170
  v_and_b32 v137, 0xffff0000, v170
  v_lshlrev_b32 v138, 16, v171
  v_and_b32 v139, 0xffff0000, v171
  v_fma_f32 v136, v20, v9, v136
  v_fma_f32 v137, v21, v9, v137
  v_fma_f32 v138, v22, v9, v138
  v_fma_f32 v139, v23, v9, v139
  v_cvt_pk_bf16_f32 v136, v136, v137
  v_cvt_pk_bf16_f32 v137, v138, v139
  s_add_u32 s33, s47, 18432
  buffer_store_dwordx2 v[136:137], v11, s[52:55], s33 offen sc0 sc1
  s_waitcnt vmcnt(7)
  v_lshlrev_b32 v144, 16, v100
  v_and_b32 v145, 0xffff0000, v100
  v_lshlrev_b32 v146, 16, v101
  v_and_b32 v147, 0xffff0000, v101
  v_add_f32 v24, v24, v144
  v_add_f32 v25, v25, v145
  v_add_f32 v26, v26, v146
  v_add_f32 v27, v27, v147
  s_waitcnt vmcnt(6)
  v_lshlrev_b32 v144, 16, v104
  v_and_b32 v145, 0xffff0000, v104
  v_lshlrev_b32 v146, 16, v105
  v_and_b32 v147, 0xffff0000, v105
  v_add_f32 v24, v24, v144
  v_add_f32 v25, v25, v145
  v_add_f32 v26, v26, v146
  v_add_f32 v27, v27, v147
  s_waitcnt vmcnt(5)
  v_lshlrev_b32 v144, 16, v108
  v_and_b32 v145, 0xffff0000, v108
  v_lshlrev_b32 v146, 16, v109
  v_and_b32 v147, 0xffff0000, v109
  v_add_f32 v24, v24, v144
  v_add_f32 v25, v25, v145
  v_add_f32 v26, v26, v146
  v_add_f32 v27, v27, v147
  v_lshlrev_b32 v144, 16, v172
  v_and_b32 v145, 0xffff0000, v172
  v_lshlrev_b32 v146, 16, v173
  v_and_b32 v147, 0xffff0000, v173
  v_fma_f32 v144, v24, v8, v144
  v_fma_f32 v145, v25, v8, v145
  v_fma_f32 v146, v26, v8, v146
  v_fma_f32 v147, v27, v8, v147
  v_cvt_pk_bf16_f32 v144, v144, v145
  v_cvt_pk_bf16_f32 v145, v146, v147
  s_add_u32 s33, s47, 32
  buffer_store_dwordx2 v[144:145], v11, s[52:55], s33 offen sc0 sc1
  v_lshlrev_b32 v152, 16, v102
  v_and_b32 v153, 0xffff0000, v102
  v_lshlrev_b32 v154, 16, v103
  v_and_b32 v155, 0xffff0000, v103
  v_add_f32 v28, v28, v152
  v_add_f32 v29, v29, v153
  v_add_f32 v30, v30, v154
  v_add_f32 v31, v31, v155
  v_lshlrev_b32 v152, 16, v106
  v_and_b32 v153, 0xffff0000, v106
  v_lshlrev_b32 v154, 16, v107
  v_and_b32 v155, 0xffff0000, v107
  v_add_f32 v28, v28, v152
  v_add_f32 v29, v29, v153
  v_add_f32 v30, v30, v154
  v_add_f32 v31, v31, v155
  v_lshlrev_b32 v152, 16, v110
  v_and_b32 v153, 0xffff0000, v110
  v_lshlrev_b32 v154, 16, v111
  v_and_b32 v155, 0xffff0000, v111
  v_add_f32 v28, v28, v152
  v_add_f32 v29, v29, v153
  v_add_f32 v30, v30, v154
  v_add_f32 v31, v31, v155
  v_lshlrev_b32 v152, 16, v174
  v_and_b32 v153, 0xffff0000, v174
  v_lshlrev_b32 v154, 16, v175
  v_and_b32 v155, 0xffff0000, v175
  v_fma_f32 v152, v28, v9, v152
  v_fma_f32 v153, v29, v9, v153
  v_fma_f32 v154, v30, v9, v154
  v_fma_f32 v155, v31, v9, v155
  v_cvt_pk_bf16_f32 v152, v152, v153
  v_cvt_pk_bf16_f32 v153, v154, v155
  s_add_u32 s33, s47, 18464
  buffer_store_dwordx2 v[152:153], v11, s[52:55], s33 offen sc0 sc1
  s_waitcnt vmcnt(6)
  v_lshlrev_b32 v128, 16, v112
  v_and_b32 v129, 0xffff0000, v112
  v_lshlrev_b32 v130, 16, v113
  v_and_b32 v131, 0xffff0000, v113
  v_add_f32 v32, v32, v128
  v_add_f32 v33, v33, v129
  v_add_f32 v34, v34, v130
  v_add_f32 v35, v35, v131
  s_waitcnt vmcnt(5)
  v_lshlrev_b32 v128, 16, v116
  v_and_b32 v129, 0xffff0000, v116
  v_lshlrev_b32 v130, 16, v117
  v_and_b32 v131, 0xffff0000, v117
  v_add_f32 v32, v32, v128
  v_add_f32 v33, v33, v129
  v_add_f32 v34, v34, v130
  v_add_f32 v35, v35, v131
  s_waitcnt vmcnt(4)
  v_lshlrev_b32 v128, 16, v120
  v_and_b32 v129, 0xffff0000, v120
  v_lshlrev_b32 v130, 16, v121
  v_and_b32 v131, 0xffff0000, v121
  v_add_f32 v32, v32, v128
  v_add_f32 v33, v33, v129
  v_add_f32 v34, v34, v130
  v_add_f32 v35, v35, v131
  v_lshlrev_b32 v128, 16, v176
  v_and_b32 v129, 0xffff0000, v176
  v_lshlrev_b32 v130, 16, v177
  v_and_b32 v131, 0xffff0000, v177
  v_fma_f32 v128, v32, v8, v128
  v_fma_f32 v129, v33, v8, v129
  v_fma_f32 v130, v34, v8, v130
  v_fma_f32 v131, v35, v8, v131
  v_cvt_pk_bf16_f32 v128, v128, v129
  v_cvt_pk_bf16_f32 v129, v130, v131
  s_add_u32 s33, s47, 64
  buffer_store_dwordx2 v[128:129], v11, s[52:55], s33 offen sc0 sc1
  v_lshlrev_b32 v136, 16, v114
  v_and_b32 v137, 0xffff0000, v114
  v_lshlrev_b32 v138, 16, v115
  v_and_b32 v139, 0xffff0000, v115
  v_add_f32 v36, v36, v136
  v_add_f32 v37, v37, v137
  v_add_f32 v38, v38, v138
  v_add_f32 v39, v39, v139
  v_lshlrev_b32 v136, 16, v118
  v_and_b32 v137, 0xffff0000, v118
  v_lshlrev_b32 v138, 16, v119
  v_and_b32 v139, 0xffff0000, v119
  v_add_f32 v36, v36, v136
  v_add_f32 v37, v37, v137
  v_add_f32 v38, v38, v138
  v_add_f32 v39, v39, v139
  v_lshlrev_b32 v136, 16, v122
  v_and_b32 v137, 0xffff0000, v122
  v_lshlrev_b32 v138, 16, v123
  v_and_b32 v139, 0xffff0000, v123
  v_add_f32 v36, v36, v136
  v_add_f32 v37, v37, v137
  v_add_f32 v38, v38, v138
  v_add_f32 v39, v39, v139
  v_lshlrev_b32 v136, 16, v178
  v_and_b32 v137, 0xffff0000, v178
  v_lshlrev_b32 v138, 16, v179
  v_and_b32 v139, 0xffff0000, v179
  v_fma_f32 v136, v36, v9, v136
  v_fma_f32 v137, v37, v9, v137
  v_fma_f32 v138, v38, v9, v138
  v_fma_f32 v139, v39, v9, v139
  v_cvt_pk_bf16_f32 v136, v136, v137
  v_cvt_pk_bf16_f32 v137, v138, v139
  s_add_u32 s33, s47, 18496
  buffer_store_dwordx2 v[136:137], v11, s[52:55], s33 offen sc0 sc1
  s_cmp_lg_u32 s38, 0
  s_cbranch_scc1 F2_RESCUE
  s_branch FB_NEXT
F2_EPI1:
  v_cvt_pk_bf16_f32 v88, v16, v17
  v_cvt_pk_bf16_f32 v89, v18, v19
  v_cvt_pk_bf16_f32 v90, v20, v21
  v_cvt_pk_bf16_f32 v91, v22, v23
  s_add_u32 s33, s34, 8192
  buffer_store_dwordx4 v[88:91], v1, s[40:43], s33 offen offset:1024 sc0 sc1
  v_cvt_pk_bf16_f32 v92, v24, v25
  v_cvt_pk_bf16_f32 v93, v26, v27
  v_cvt_pk_bf16_f32 v94, v28, v29
  v_cvt_pk_bf16_f32 v95, v30, v31
  s_add_u32 s33, s34, 8192
  buffer_store_dwordx4 v[92:95], v1, s[40:43], s33 offen offset:2048 sc0 sc1
  v_cvt_pk_bf16_f32 v96, v32, v33
  v_cvt_pk_bf16_f32 v97, v34, v35
  v_cvt_pk_bf16_f32 v98, v36, v37
  v_cvt_pk_bf16_f32 v99, v38, v39
  s_add_u32 s33, s34, 8192
  buffer_store_dwordx4 v[96:99], v1, s[40:43], s33 offen offset:3072 sc0 sc1
  v_cvt_pk_bf16_f32 v100, v56, v57
  v_cvt_pk_bf16_f32 v101, v58, v59
  v_cvt_pk_bf16_f32 v102, v60, v61
  v_cvt_pk_bf16_f32 v103, v62, v63
  s_add_u32 s33, s34, 12288
  buffer_store_dwordx4 v[100:103], v1, s[40:43], s33 offen offset:2048 sc0 sc1
  v_cvt_pk_bf16_f32 v104, v64, v65
  v_cvt_pk_bf16_f32 v105, v66, v67
  v_cvt_pk_bf16_f32 v106, v68, v69
  v_cvt_pk_bf16_f32 v107, v70, v71
  s_add_u32 s33, s34, 12288
  buffer_store_dwordx4 v[104:107], v1, s[40:43], s33 offen offset:3072 sc0 sc1
  v_cvt_pk_bf16_f32 v108, v72, v73
  v_cvt_pk_bf16_f32 v109, v74, v75
  v_cvt_pk_bf16_f32 v110, v76, v77
  v_cvt_pk_bf16_f32 v111, v78, v79
  s_add_u32 s33, s34, 16384
  buffer_store_dwordx4 v[108:111], v1, s[40:43], s33 offen offset:0 sc0 sc1
  v_cvt_pk_bf16_f32 v112, v80, v81
  v_cvt_pk_bf16_f32 v113, v82, v83
  v_cvt_pk_bf16_f32 v114, v84, v85
  v_cvt_pk_bf16_f32 v115, v86, v87
  s_add_u32 s33, s34, 16384
  buffer_store_dwordx4 v[112:115], v1, s[40:43], s33 offen offset:1024 sc0 sc1
  s_waitcnt vmcnt(0)
  v_mov_b32 v13, 1
  s_mov_b64 exec, 1
  buffer_atomic_add v13, v12, s[60:63], s35 offen sc0 sc1
  s_waitcnt vmcnt(0)
  s_mov_b64 exec, -1
  v_readfirstlane_b32 s36, v13
  s_mov_b32 s38, 0
  s_and_b32 s37, s36, 7
  s_cmp_eq_u32 s37, 3
  s_cbranch_scc0 F2_POLL1
  s_lshr_b32 s38, s36, 4
  s_branch F2_GO1
F2_POLL1:
  s_mov_b32 s39, 0
F2_PL1:
  s_cmp_eq_u32 s39, 0
  s_cbranch_scc1 F2_TMO1
  s_sub_u32 s39, s39, 1
  buffer_load_dword v13, v12, s[60:63], s35 offen sc0 sc1
  s_waitcnt vmcnt(0)
  v_readfirstlane_b32 s36, v13
  s_and_b32 s37, s36, 7
  s_cmp_eq_u32 s37, 4
  s_cbranch_scc0 F2_PL1
  s_branch F2_GO1
F2_TMO1:
  v_cvt_pk_bf16_f32 v88, v40, v41
  v_cvt_pk_bf16_f32 v89, v42, v43
  v_cvt_pk_bf16_f32 v90, v44, v45
  v_cvt_pk_bf16_f32 v91, v46, v47
  s_add_u32 s33, s34, 12288
  buffer_store_dwordx4 v[88:91], v1, s[40:43], s33 offen offset:0 sc0 sc1
  v_cvt_pk_bf16_f32 v92, v48, v49
  v_cvt_pk_bf16_f32 v93, v50, v51
  v_cvt_pk_bf16_f32 v94, v52, v53
  v_cvt_pk_bf16_f32 v95, v54, v55
  s_add_u32 s33, s34, 12288
  buffer_store_dwordx4 v[92:95], v1, s[40:43], s33 offen offset:1024 sc0 sc1
  s_waitcnt vmcnt(0)
  v_mov_b32 v13, 32
  s_mov_b64 exec, 1
  buffer_atomic_or v13, v12, s[60:63], s35 offen sc0 sc1
  s_waitcnt vmcnt(0)
  s_mov_b64 exec, -1
  v_readfirstlane_b32 s36, v13
  s_and_b32 s37, s36, 7
  s_cmp_eq_u32 s37, 4
  s_cbranch_scc1 F2_GO1
  s_branch FB_NEXT
F2_GO1:
  s_add_u32 s33, s34, 0
  buffer_load_dwordx4 v[88:91], v1, s[40:43], s33 offen offset:3072 sc0 sc1
  s_add_u32 s33, s34, 20480
  buffer_load_dwordx4 v[92:95], v1, s[40:43], s33 offen offset:1024 sc0 sc1
  s_add_u32 s33, s34, 28672
  buffer_load_dwordx4 v[96:99], v1, s[40:43], s33 offen offset:2048 sc0 sc1
  s_add_u32 s33, s34, 4096
  buffer_load_dwordx4 v[100:103], v1, s[40:43], s33 offen offset:0 sc0 sc1
  s_add_u32 s33, s34, 20480
  buffer_load_dwordx4 v[104:107], v1, s[40:43], s33 offen offset:2048 sc0 sc1
  s_add_u32 s33, s34, 28672
  buffer_load_dwordx4 v[108:111], v1, s[40:43], s33 offen offset:3072 sc0 sc1
  s_waitcnt vmcnt(5)
  v_lshlrev_b32 v128, 16, v88
  v_and_b32 v129, 0xffff0000, v88
  v_lshlrev_b32 v130, 16, v89
  v_and_b32 v131, 0xffff0000, v89
  v_add_f32 v40, v40, v128
  v_add_f32 v41, v41, v129
  v_add_f32 v42, v42, v130
  v_add_f32 v43, v43, v131
  s_waitcnt vmcnt(4)
  v_lshlrev_b32 v128, 16, v92
  v_and_b32 v129, 0xffff0000, v92
  v_lshlrev_b32 v130, 16, v93
  v_and_b32 v131, 0xffff0000, v93
  v_add_f32 v40, v40, v128
  v_add_f32 v41, v41, v129
  v_add_f32 v42, v42, v130
  v_add_f32 v43, v43, v131
  s_waitcnt vmcnt(3)
  v_lshlrev_b32 v128, 16, v96
  v_and_b32 v129, 0xffff0000, v96
  v_lshlrev_b32 v130, 16, v97
  v_and_b32 v131, 0xffff0000, v97
  v_add_f32 v40, v40, v128
  v_add_f32 v41, v41, v129
  v_add_f32 v42, v42, v130
  v_add_f32 v43, v43, v131
  v_lshlrev_b32 v128, 16, v168
  v_and_b32 v129, 0xffff0000, v168
  v_lshlrev_b32 v130, 16, v169
  v_and_b32 v131, 0xffff0000, v169
  v_fma_f32 v128, v40, v8, v128
  v_fma_f32 v129, v41, v8, v129
  v_fma_f32 v130, v42, v8, v130
  v_fma_f32 v131, v43, v8, v131
  v_cvt_pk_bf16_f32 v128, v128, v129
  v_cvt_pk_bf16_f32 v129, v130, v131
  s_add_u32 s33, s47, 96
  buffer_store_dwordx2 v[128:129], v11, s[52:55], s33 offen sc0 sc1
  v_lshlrev_b32 v136, 16, v90
  v_and_b32 v137, 0xffff0000, v90
  v_lshlrev_b32 v138, 16, v91
  v_and_b32 v139, 0xffff0000, v91
  v_add_f32 v44, v44, v136
  v_add_f32 v45, v45, v137
  v_add_f32 v46, v46, v138
  v_add_f32 v47, v47, v139
  v_lshlrev_b32 v136, 16, v94
  v_and_b32 v137, 0xffff0000, v94
  v_lshlrev_b32 v138, 16, v95
  v_and_b32 v139, 0xffff0000, v95
  v_add_f32 v44, v44, v136
  v_add_f32 v45, v45, v137
  v_add_f32 v46, v46, v138
  v_add_f32 v47, v47, v139
  v_lshlrev_b32 v136, 16, v98
  v_and_b32 v137, 0xffff0000, v98
  v_lshlrev_b32 v138, 16, v99
  v_and_b32 v139, 0xffff0000, v99
  v_add_f32 v44, v44, v136
  v_add_f32 v45, v45, v137
  v_add_f32 v46, v46, v138
  v_add_f32 v47, v47, v139
  v_lshlrev_b32 v136, 16, v170
  v_and_b32 v137, 0xffff0000, v170
  v_lshlrev_b32 v138, 16, v171
  v_and_b32 v139, 0xffff0000, v171
  v_fma_f32 v136, v44, v9, v136
  v_fma_f32 v137, v45, v9, v137
  v_fma_f32 v138, v46, v9, v138
  v_fma_f32 v139, v47, v9, v139
  v_cvt_pk_bf16_f32 v136, v136, v137
  v_cvt_pk_bf16_f32 v137, v138, v139
  s_add_u32 s33, s47, 18528
  buffer_store_dwordx2 v[136:137], v11, s[52:55], s33 offen sc0 sc1
  s_waitcnt vmcnt(4)
  v_lshlrev_b32 v144, 16, v100
  v_and_b32 v145, 0xffff0000, v100
  v_lshlrev_b32 v146, 16, v101
  v_and_b32 v147, 0xffff0000, v101
  v_add_f32 v48, v48, v144
  v_add_f32 v49, v49, v145
  v_add_f32 v50, v50, v146
  v_add_f32 v51, v51, v147
  s_waitcnt vmcnt(3)
  v_lshlrev_b32 v144, 16, v104
  v_and_b32 v145, 0xffff0000, v104
  v_lshlrev_b32 v146, 16, v105
  v_and_b32 v147, 0xffff0000, v105
  v_add_f32 v48, v48, v144
  v_add_f32 v49, v49, v145
  v_add_f32 v50, v50, v146
  v_add_f32 v51, v51, v147
  s_waitcnt vmcnt(2)
  v_lshlrev_b32 v144, 16, v108
  v_and_b32 v145, 0xffff0000, v108
  v_lshlrev_b32 v146, 16, v109
  v_and_b32 v147, 0xffff0000, v109
  v_add_f32 v48, v48, v144
  v_add_f32 v49, v49, v145
  v_add_f32 v50, v50, v146
  v_add_f32 v51, v51, v147
  v_lshlrev_b32 v144, 16, v172
  v_and_b32 v145, 0xffff0000, v172
  v_lshlrev_b32 v146, 16, v173
  v_and_b32 v147, 0xffff0000, v173
  v_fma_f32 v144, v48, v8, v144
  v_fma_f32 v145, v49, v8, v145
  v_fma_f32 v146, v50, v8, v146
  v_fma_f32 v147, v51, v8, v147
  v_cvt_pk_bf16_f32 v144, v144, v145
  v_cvt_pk_bf16_f32 v145, v146, v147
  s_add_u32 s33, s47, 128
  buffer_store_dwordx2 v[144:145], v11, s[52:55], s33 offen sc0 sc1
  v_lshlrev_b32 v152, 16, v102
  v_and_b32 v153, 0xffff0000, v102
  v_lshlrev_b32 v154, 16, v103
  v_and_b32 v155, 0xffff0000, v103
  v_add_f32 v52, v52, v152
  v_add_f32 v53, v53, v153
  v_add_f32 v54, v54, v154
  v_add_f32 v55, v55, v155
  v_lshlrev_b32 v152, 16, v106
  v_and_b32 v153, 0xffff0000, v106
  v_lshlrev_b32 v154, 16, v107
  v_and_b32 v155, 0xffff0000, v107
  v_add_f32 v52, v52, v152
  v_add_f32 v53, v53, v153
  v_add_f32 v54, v54, v154
  v_add_f32 v55, v55, v155
  v_lshlrev_b32 v152, 16, v110
  v_and_b32 v153, 0xffff0000, v110
  v_lshlrev_b32 v154, 16, v111
  v_and_b32 v155, 0xffff0000, v111
  v_add_f32 v52, v52, v152
  v_add_f32 v53, v53, v153
  v_add_f32 v54, v54, v154
  v_add_f32 v55, v55, v155
  v_lshlrev_b32 v152, 16, v174
  v_and_b32 v153, 0xffff0000, v174
  v_lshlrev_b32 v154, 16, v175
  v_and_b32 v155, 0xffff0000, v175
  v_fma_f32 v152, v52, v9, v152
  v_fma_f32 v153, v53, v9, v153
  v_fma_f32 v154, v54, v9, v154
  v_fma_f32 v155, v55, v9, v155
  v_cvt_pk_bf16_f32 v152, v152, v153
  v_cvt_pk_bf16_f32 v153, v154, v155
  s_add_u32 s33, s47, 18560
  buffer_store_dwordx2 v[152:153], v11, s[52:55], s33 offen sc0 sc1
  s_cmp_lg_u32 s38, 0
  s_cbranch_scc1 F2_RESCUE
  s_branch FB_NEXT
F2_EPI2:
  v_cvt_pk_bf16_f32 v88, v16, v17
  v_cvt_pk_bf16_f32 v89, v18, v19
  v_cvt_pk_bf16_f32 v90, v20, v21
  v_cvt_pk_bf16_f32 v91, v22, v23
  s_add_u32 s33, s34, 16384
  buffer_store_dwordx4 v[88:91], v1, s[40:43], s33 offen offset:2048 sc0 sc1
  v_cvt_pk_bf16_f32 v92, v24, v25
  v_cvt_pk_bf16_f32 v93, v26, v27
  v_cvt_pk_bf16_f32 v94, v28, v29
  v_cvt_pk_bf16_f32 v95, v30, v31
  s_add_u32 s33, s34, 16384
  buffer_store_dwordx4 v[92:95], v1, s[40:43], s33 offen offset:3072 sc0 sc1
  v_cvt_pk_bf16_f32 v96, v32, v33
  v_cvt_pk_bf16_f32 v97, v34, v35
  v_cvt_pk_bf16_f32 v98, v36, v37
  v_cvt_pk_bf16_f32 v99, v38, v39
  s_add_u32 s33, s34, 20480
  buffer_store_dwordx4 v[96:99], v1, s[40:43], s33 offen offset:0 sc0 sc1
  v_cvt_pk_bf16_f32 v100, v40, v41
  v_cvt_pk_bf16_f32 v101, v42, v43
  v_cvt_pk_bf16_f32 v102, v44, v45
  v_cvt_pk_bf16_f32 v103, v46, v47
  s_add_u32 s33, s34, 20480
  buffer_store_dwordx4 v[100:103], v1, s[40:43], s33 offen offset:1024 sc0 sc1
  v_cvt_pk_bf16_f32 v104, v48, v49
  v_cvt_pk_bf16_f32 v105, v50, v51
  v_cvt_pk_bf16_f32 v106, v52, v53
  v_cvt_pk_bf16_f32 v107, v54, v55
  s_add_u32 s33, s34, 20480
  buffer_store_dwordx4 v[104:107], v1, s[40:43], s33 offen offset:2048 sc0 sc1
  v_cvt_pk_bf16_f32 v108, v72, v73
  v_cvt_pk_bf16_f32 v109, v74, v75
  v_cvt_pk_bf16_f32 v110, v76, v77
  v_cvt_pk_bf16_f32 v111, v78, v79
  s_add_u32 s33, s34, 24576
  buffer_store_dwordx4 v[108:111], v1, s[40:43], s33 offen offset:1024 sc0 sc1
  v_cvt_pk_bf16_f32 v112, v80, v81
  v_cvt_pk_bf16_f32 v113, v82, v83
  v_cvt_pk_bf16_f32 v114, v84, v85
  v_cvt_pk_bf16_f32 v115, v86, v87
  s_add_u32 s33, s34, 24576
  buffer_store_dwordx4 v[112:115], v1, s[40:43], s33 offen offset:2048 sc0 sc1
  s_waitcnt vmcnt(0)
  v_mov_b32 v13, 1
  s_mov_b64 exec, 1
  buffer_atomic_add v13, v12, s[60:63], s35 offen sc0 sc1
  s_waitcnt vmcnt(0)
  s_mov_b64 exec, -1
  v_readfirstlane_b32 s36, v13
  s_mov_b32 s38, 0
  s_and_b32 s37, s36, 7
  s_cmp_eq_u32 s37, 3
  s_cbranch_scc0 F2_POLL2
  s_lshr_b32 s38, s36, 4
  s_branch F2_GO2
F2_POLL2:
  s_mov_b32 s39, 0
F2_PL2:
  s_cmp_eq_u32 s39, 0
  s_cbranch_scc1 F2_TMO2
  s_sub_u32 s39, s39, 1
  buffer_load_dword v13, v12, s[60:63], s35 offen sc0 sc1
  s_waitcnt vmcnt(0)
  v_readfirstlane_b32 s36, v13
  s_and_b32 s37, s36, 7
  s_cmp_eq_u32 s37, 4
  s_cbranch_scc0 F2_PL2
  s_branch F2_GO2
F2_TMO2:
  v_cvt_pk_bf16_f32 v88, v56, v57
  v_cvt_pk_bf16_f32 v89, v58, v59
  v_cvt_pk_bf16_f32 v90, v60, v61
  v_cvt_pk_bf16_f32 v91, v62, v63
  s_add_u32 s33, s34, 20480
  buffer_store_dwordx4 v[88:91], v1, s[40:43], s33 offen offset:3072 sc0 sc1
  v_cvt_pk_bf16_f32 v92, v64, v65
  v_cvt_pk_bf16_f32 v93, v66, v67
  v_cvt_pk_bf16_f32 v94, v68, v69
  v_cvt_pk_bf16_f32 v95, v70, v71
  s_add_u32 s33, s34, 24576
  buffer_store_dwordx4 v[92:95], v1, s[40:43], s33 offen offset:0 sc0 sc1
  s_waitcnt vmcnt(0)
  v_mov_b32 v13, 64
  s_mov_b64 exec, 1
  buffer_atomic_or v13, v12, s[60:63], s35 offen sc0 sc1
  s_waitcnt vmcnt(0)
  s_mov_b64 exec, -1
  v_readfirstlane_b32 s36, v13
  s_and_b32 s37, s36, 7
  s_cmp_eq_u32 s37, 4
  s_cbranch_scc1 F2_GO2
  s_branch FB_NEXT
F2_GO2:
  s_add_u32 s33, s34, 4096
  buffer_load_dwordx4 v[88:91], v1, s[40:43], s33 offen offset:1024 sc0 sc1
  s_add_u32 s33, s34, 12288
  buffer_load_dwordx4 v[92:95], v1, s[40:43], s33 offen offset:2048 sc0 sc1
  s_add_u32 s33, s34, 32768
  buffer_load_dwordx4 v[96:99], v1, s[40:43], s33 offen offset:0 sc0 sc1
  s_add_u32 s33, s34, 4096
  buffer_load_dwordx4 v[100:103], v1, s[40:43], s33 offen offset:2048 sc0 sc1
  s_add_u32 s33, s34, 12288
  buffer_load_dwordx4 v[104:107], v1, s[40:43], s33 offen offset:3072 sc0 sc1
  s_add_u32 s33, s34, 32768
  buffer_load_dwordx4 v[108:111], v1, s[40:43], s33 offen offset:1024 sc0 sc1
  s_waitcnt vmcnt(5)
  v_lshlrev_b32 v128, 16, v88
  v_and_b32 v129, 0xffff0000, v88
  v_lshlrev_b32 v130, 16, v89
  v_and_b32 v131, 0xffff0000, v89
  v_add_f32 v56, v56, v128
  v_add_f32 v57, v57, v129
  v_add_f32 v58, v58, v130
  v_add_f32 v59, v59, v131
  s_waitcnt vmcnt(4)
  v_lshlrev_b32 v128, 16, v92
  v_and_b32 v129, 0xffff0000, v92
  v_lshlrev_b32 v130, 16, v93
  v_and_b32 v131, 0xffff0000, v93
  v_add_f32 v56, v56, v128
  v_add_f32 v57, v57, v129
  v_add_f32 v58, v58, v130
  v_add_f32 v59, v59, v131
  s_waitcnt vmcnt(3)
  v_lshlrev_b32 v128, 16, v96
  v_and_b32 v129, 0xffff0000, v96
  v_lshlrev_b32 v130, 16, v97
  v_and_b32 v131, 0xffff0000, v97
  v_add_f32 v56, v56, v128
  v_add_f32 v57, v57, v129
  v_add_f32 v58, v58, v130
  v_add_f32 v59, v59, v131
  v_lshlrev_b32 v128, 16, v168
  v_and_b32 v129, 0xffff0000, v168
  v_lshlrev_b32 v130, 16, v169
  v_and_b32 v131, 0xffff0000, v169
  v_fma_f32 v128, v56, v8, v128
  v_fma_f32 v129, v57, v8, v129
  v_fma_f32 v130, v58, v8, v130
  v_fma_f32 v131, v59, v8, v131
  v_cvt_pk_bf16_f32 v128, v128, v129
  v_cvt_pk_bf16_f32 v129, v130, v131
  s_add_u32 s33, s47, 160
  buffer_store_dwordx2 v[128:129], v11, s[52:55], s33 offen sc0 sc1
  v_lshlrev_b32 v136, 16, v90
  v_and_b32 v137, 0xffff0000, v90
  v_lshlrev_b32 v138, 16, v91
  v_and_b32 v139, 0xffff0000, v91
  v_add_f32 v60, v60, v136
  v_add_f32 v61, v61, v137
  v_add_f32 v62, v62, v138
  v_add_f32 v63, v63, v139
  v_lshlrev_b32 v136, 16, v94
  v_and_b32 v137, 0xffff0000, v94
  v_lshlrev_b32 v138, 16, v95
  v_and_b32 v139, 0xffff0000, v95
  v_add_f32 v60, v60, v136
  v_add_f32 v61, v61, v137
  v_add_f32 v62, v62, v138
  v_add_f32 v63, v63, v139
  v_lshlrev_b32 v136, 16, v98
  v_and_b32 v137, 0xffff0000, v98
  v_lshlrev_b32 v138, 16, v99
  v_and_b32 v139, 0xffff0000, v99
  v_add_f32 v60, v60, v136
  v_add_f32 v61, v61, v137
  v_add_f32 v62, v62, v138
  v_add_f32 v63, v63, v139
  v_lshlrev_b32 v136, 16, v170
  v_and_b32 v137, 0xffff0000, v170
  v_lshlrev_b32 v138, 16, v171
  v_and_b32 v139, 0xffff0000, v171
  v_fma_f32 v136, v60, v9, v136
  v_fma_f32 v137, v61, v9, v137
  v_fma_f32 v138, v62, v9, v138
  v_fma_f32 v139, v63, v9, v139
  v_cvt_pk_bf16_f32 v136, v136, v137
  v_cvt_pk_bf16_f32 v137, v138, v139
  s_add_u32 s33, s47, 18592
  buffer_store_dwordx2 v[136:137], v11, s[52:55], s33 offen sc0 sc1
  s_waitcnt vmcnt(4)
  v_lshlrev_b32 v144, 16, v100
  v_and_b32 v145, 0xffff0000, v100
  v_lshlrev_b32 v146, 16, v101
  v_and_b32 v147, 0xffff0000, v101
  v_add_f32 v64, v64, v144
  v_add_f32 v65, v65, v145
  v_add_f32 v66, v66, v146
  v_add_f32 v67, v67, v147
  s_waitcnt vmcnt(3)
  v_lshlrev_b32 v144, 16, v104
  v_and_b32 v145, 0xffff0000, v104
  v_lshlrev_b32 v146, 16, v105
  v_and_b32 v147, 0xffff0000, v105
  v_add_f32 v64, v64, v144
  v_add_f32 v65, v65, v145
  v_add_f32 v66, v66, v146
  v_add_f32 v67, v67, v147
  s_waitcnt vmcnt(2)
  v_lshlrev_b32 v144, 16, v108
  v_and_b32 v145, 0xffff0000, v108
  v_lshlrev_b32 v146, 16, v109
  v_and_b32 v147, 0xffff0000, v109
  v_add_f32 v64, v64, v144
  v_add_f32 v65, v65, v145
  v_add_f32 v66, v66, v146
  v_add_f32 v67, v67, v147
  v_lshlrev_b32 v144, 16, v172
  v_and_b32 v145, 0xffff0000, v172
  v_lshlrev_b32 v146, 16, v173
  v_and_b32 v147, 0xffff0000, v173
  v_fma_f32 v144, v64, v8, v144
  v_fma_f32 v145, v65, v8, v145
  v_fma_f32 v146, v66, v8, v146
  v_fma_f32 v147, v67, v8, v147
  v_cvt_pk_bf16_f32 v144, v144, v145
  v_cvt_pk_bf16_f32 v145, v146, v147
  s_add_u32 s33, s47, 192
  buffer_store_dwordx2 v[144:145], v11, s[52:55], s33 offen sc0 sc1
  v_lshlrev_b32 v152, 16, v102
  v_and_b32 v153, 0xffff0000, v102
  v_lshlrev_b32 v154, 16, v103
  v_and_b32 v155, 0xffff0000, v103
  v_add_f32 v68, v68, v152
  v_add_f32 v69, v69, v153
  v_add_f32 v70, v70, v154
  v_add_f32 v71, v71, v155
  v_lshlrev_b32 v152, 16, v106
  v_and_b32 v153, 0xffff0000, v106
  v_lshlrev_b32 v154, 16, v107
  v_and_b32 v155, 0xffff0000, v107
  v_add_f32 v68, v68, v152
  v_add_f32 v69, v69, v153
  v_add_f32 v70, v70, v154
  v_add_f32 v71, v71, v155
  v_lshlrev_b32 v152, 16, v110
  v_and_b32 v153, 0xffff0000, v110
  v_lshlrev_b32 v154, 16, v111
  v_and_b32 v155, 0xffff0000, v111
  v_add_f32 v68, v68, v152
  v_add_f32 v69, v69, v153
  v_add_f32 v70, v70, v154
  v_add_f32 v71, v71, v155
  v_lshlrev_b32 v152, 16, v174
  v_and_b32 v153, 0xffff0000, v174
  v_lshlrev_b32 v154, 16, v175
  v_and_b32 v155, 0xffff0000, v175
  v_fma_f32 v152, v68, v9, v152
  v_fma_f32 v153, v69, v9, v153
  v_fma_f32 v154, v70, v9, v154
  v_fma_f32 v155, v71, v9, v155
  v_cvt_pk_bf16_f32 v152, v152, v153
  v_cvt_pk_bf16_f32 v153, v154, v155
  s_add_u32 s33, s47, 18624
  buffer_store_dwordx2 v[152:153], v11, s[52:55], s33 offen sc0 sc1
  s_cmp_lg_u32 s38, 0
  s_cbranch_scc1 F2_RESCUE
  s_branch FB_NEXT
F2_EPI3:
  v_cvt_pk_bf16_f32 v88, v16, v17
  v_cvt_pk_bf16_f32 v89, v18, v19
  v_cvt_pk_bf16_f32 v90, v20, v21
  v_cvt_pk_bf16_f32 v91, v22, v23
  s_add_u32 s33, s34, 24576
  buffer_store_dwordx4 v[88:91], v1, s[40:43], s33 offen offset:3072 sc0 sc1
  v_cvt_pk_bf16_f32 v92, v24, v25
  v_cvt_pk_bf16_f32 v93, v26, v27
  v_cvt_pk_bf16_f32 v94, v28, v29
  v_cvt_pk_bf16_f32 v95, v30, v31
  s_add_u32 s33, s34, 28672
  buffer_store_dwordx4 v[92:95], v1, s[40:43], s33 offen offset:0 sc0 sc1
  v_cvt_pk_bf16_f32 v96, v32, v33
  v_cvt_pk_bf16_f32 v97, v34, v35
  v_cvt_pk_bf16_f32 v98, v36, v37
  v_cvt_pk_bf16_f32 v99, v38, v39
  s_add_u32 s33, s34, 28672
  buffer_store_dwordx4 v[96:99], v1, s[40:43], s33 offen offset:1024 sc0 sc1
  v_cvt_pk_bf16_f32 v100, v40, v41
  v_cvt_pk_bf16_f32 v101, v42, v43
  v_cvt_pk_bf16_f32 v102, v44, v45
  v_cvt_pk_bf16_f32 v103, v46, v47
  s_add_u32 s33, s34, 28672
  buffer_store_dwordx4 v[100:103], v1, s[40:43], s33 offen offset:2048 sc0 sc1
  v_cvt_pk_bf16_f32 v104, v48, v49
  v_cvt_pk_bf16_f32 v105, v50, v51
  v_cvt_pk_bf16_f32 v106, v52, v53
  v_cvt_pk_bf16_f32 v107, v54, v55
  s_add_u32 s33, s34, 28672
  buffer_store_dwordx4 v[104:107], v1, s[40:43], s33 offen offset:3072 sc0 sc1
  v_cvt_pk_bf16_f32 v108, v56, v57
  v_cvt_pk_bf16_f32 v109, v58, v59
  v_cvt_pk_bf16_f32 v110, v60, v61
  v_cvt_pk_bf16_f32 v111, v62, v63
  s_add_u32 s33, s34, 32768
  buffer_store_dwordx4 v[108:111], v1, s[40:43], s33 offen offset:0 sc0 sc1
  v_cvt_pk_bf16_f32 v112, v64, v65
  v_cvt_pk_bf16_f32 v113, v66, v67
  v_cvt_pk_bf16_f32 v114, v68, v69
  v_cvt_pk_bf16_f32 v115, v70, v71
  s_add_u32 s33, s34, 32768
  buffer_store_dwordx4 v[112:115], v1, s[40:43], s33 offen offset:1024 sc0 sc1
  s_waitcnt vmcnt(0)
  v_mov_b32 v13, 1
  s_mov_b64 exec, 1
  buffer_atomic_add v13, v12, s[60:63], s35 offen sc0 sc1
  s_waitcnt vmcnt(0)
  s_mov_b64 exec, -1
  v_readfirstlane_b32 s36, v13
  s_mov_b32 s38, 0
  s_and_b32 s37, s36, 7
  s_cmp_eq_u32 s37, 3
  s_cbranch_scc0 F2_POLL3
  s_lshr_b32 s38, s36, 4
  s_branch F2_GO3
F2_POLL3:
  s_mov_b32 s39, 0
F2_PL3:
  s_cmp_eq_u32 s39, 0
  s_cbranch_scc1 F2_TMO3
  s_sub_u32 s39, s39, 1
  buffer_load_dword v13, v12, s[60:63], s35 offen sc0 sc1
  s_waitcnt vmcnt(0)
  v_readfirstlane_b32 s36, v13
  s_and_b32 s37, s36, 7
  s_cmp_eq_u32 s37, 4
  s_cbranch_scc0 F2_PL3
  s_branch F2_GO3
F2_TMO3:
  v_cvt_pk_bf16_f32 v88, v72, v73
  v_cvt_pk_bf16_f32 v89, v74, v75
  v_cvt_pk_bf16_f32 v90, v76, v77
  v_cvt_pk_bf16_f32 v91, v78, v79
  s_add_u32 s33, s34, 32768
  buffer_store_dwordx4 v[88:91], v1, s[40:43], s33 offen offset:2048 sc0 sc1
  v_cvt_pk_bf16_f32 v92, v80, v81
  v_cvt_pk_bf16_f32 v93, v82, v83
  v_cvt_pk_bf16_f32 v94, v84, v85
  v_cvt_pk_bf16_f32 v95, v86, v87
  s_add_u32 s33, s34, 32768
  buffer_store_dwordx4 v[92:95], v1, s[40:43], s33 offen offset:3072 sc0 sc1
  s_waitcnt vmcnt(0)
  v_mov_b32 v13, 128
  s_mov_b64 exec, 1
  buffer_atomic_or v13, v12, s[60:63], s35 offen sc0 sc1
  s_waitcnt vmcnt(0)
  s_mov_b64 exec, -1
  v_readfirstlane_b32 s36, v13
  s_and_b32 s37, s36, 7
  s_cmp_eq_u32 s37, 4
  s_cbranch_scc1 F2_GO3
  s_branch FB_NEXT
F2_GO3:
  s_add_u32 s33, s34, 4096
  buffer_load_dwordx4 v[88:91], v1, s[40:43], s33 offen offset:3072 sc0 sc1
  s_add_u32 s33, s34, 16384
  buffer_load_dwordx4 v[92:95], v1, s[40:43], s33 offen offset:0 sc0 sc1
  s_add_u32 s33, s34, 24576
  buffer_load_dwordx4 v[96:99], v1, s[40:43], s33 offen offset:1024 sc0 sc1
  s_add_u32 s33, s34, 8192
  buffer_load_dwordx4 v[100:103], v1, s[40:43], s33 offen offset:0 sc0 sc1
  s_add_u32 s33, s34, 16384
  buffer_load_dwordx4 v[104:107], v1, s[40:43], s33 offen offset:1024 sc0 sc1
  s_add_u32 s33, s34, 24576
  buffer_load_dwordx4 v[108:111], v1, s[40:43], s33 offen offset:2048 sc0 sc1
  s_waitcnt vmcnt(5)
  v_lshlrev_b32 v128, 16, v88
  v_and_b32 v129, 0xffff0000, v88
  v_lshlrev_b32 v130, 16, v89
  v_and_b32 v131, 0xffff0000, v89
  v_add_f32 v72, v72, v128
  v_add_f32 v73, v73, v129
  v_add_f32 v74, v74, v130
  v_add_f32 v75, v75, v131
  s_waitcnt vmcnt(4)
  v_lshlrev_b32 v128, 16, v92
  v_and_b32 v129, 0xffff0000, v92
  v_lshlrev_b32 v130, 16, v93
  v_and_b32 v131, 0xffff0000, v93
  v_add_f32 v72, v72, v128
  v_add_f32 v73, v73, v129
  v_add_f32 v74, v74, v130
  v_add_f32 v75, v75, v131
  s_waitcnt vmcnt(3)
  v_lshlrev_b32 v128, 16, v96
  v_and_b32 v129, 0xffff0000, v96
  v_lshlrev_b32 v130, 16, v97
  v_and_b32 v131, 0xffff0000, v97
  v_add_f32 v72, v72, v128
  v_add_f32 v73, v73, v129
  v_add_f32 v74, v74, v130
  v_add_f32 v75, v75, v131
  v_lshlrev_b32 v128, 16, v168
  v_and_b32 v129, 0xffff0000, v168
  v_lshlrev_b32 v130, 16, v169
  v_and_b32 v131, 0xffff0000, v169
  v_fma_f32 v128, v72, v8, v128
  v_fma_f32 v129, v73, v8, v129
  v_fma_f32 v130, v74, v8, v130
  v_fma_f32 v131, v75, v8, v131
  v_cvt_pk_bf16_f32 v128, v128, v129
  v_cvt_pk_bf16_f32 v129, v130, v131
  s_add_u32 s33, s47, 224
  buffer_store_dwordx2 v[128:129], v11, s[52:55], s33 offen sc0 sc1
  v_lshlrev_b32 v136, 16, v90
  v_and_b32 v137, 0xffff0000, v90
  v_lshlrev_b32 v138, 16, v91
  v_and_b32 v139, 0xffff0000, v91
  v_add_f32 v76, v76, v136
  v_add_f32 v77, v77, v137
  v_add_f32 v78, v78, v138
  v_add_f32 v79, v79, v139
  v_lshlrev_b32 v136, 16, v94
  v_and_b32 v137, 0xffff0000, v94
  v_lshlrev_b32 v138, 16, v95
  v_and_b32 v139, 0xffff0000, v95
  v_add_f32 v76, v76, v136
  v_add_f32 v77, v77, v137
  v_add_f32 v78, v78, v138
  v_add_f32 v79, v79, v139
  v_lshlrev_b32 v136, 16, v98
  v_and_b32 v137, 0xffff0000, v98
  v_lshlrev_b32 v138, 16, v99
  v_and_b32 v139, 0xffff0000, v99
  v_add_f32 v76, v76, v136
  v_add_f32 v77, v77, v137
  v_add_f32 v78, v78, v138
  v_add_f32 v79, v79, v139
  v_lshlrev_b32 v136, 16, v170
  v_and_b32 v137, 0xffff0000, v170
  v_lshlrev_b32 v138, 16, v171
  v_and_b32 v139, 0xffff0000, v171
  v_fma_f32 v136, v76, v9, v136
  v_fma_f32 v137, v77, v9, v137
  v_fma_f32 v138, v78, v9, v138
  v_fma_f32 v139, v79, v9, v139
  v_cvt_pk_bf16_f32 v136, v136, v137
  v_cvt_pk_bf16_f32 v137, v138, v139
  s_add_u32 s33, s47, 18656
  buffer_store_dwordx2 v[136:137], v11, s[52:55], s33 offen sc0 sc1
  s_waitcnt vmcnt(4)
  v_lshlrev_b32 v144, 16, v100
  v_and_b32 v145, 0xffff0000, v100
  v_lshlrev_b32 v146, 16, v101
  v_and_b32 v147, 0xffff0000, v101
  v_add_f32 v80, v80, v144
  v_add_f32 v81, v81, v145
  v_add_f32 v82, v82, v146
  v_add_f32 v83, v83, v147
  s_waitcnt vmcnt(3)
  v_lshlrev_b32 v144, 16, v104
  v_and_b32 v145, 0xffff0000, v104
  v_lshlrev_b32 v146, 16, v105
  v_and_b32 v147, 0xffff0000, v105
  v_add_f32 v80, v80, v144
  v_add_f32 v81, v81, v145
  v_add_f32 v82, v82, v146
  v_add_f32 v83, v83, v147
  s_waitcnt vmcnt(2)
  v_lshlrev_b32 v144, 16, v108
  v_and_b32 v145, 0xffff0000, v108
  v_lshlrev_b32 v146, 16, v109
  v_and_b32 v147, 0xffff0000, v109
  v_add_f32 v80, v80, v144
  v_add_f32 v81, v81, v145
  v_add_f32 v82, v82, v146
  v_add_f32 v83, v83, v147
  v_lshlrev_b32 v144, 16, v172
  v_and_b32 v145, 0xffff0000, v172
  v_lshlrev_b32 v146, 16, v173
  v_and_b32 v147, 0xffff0000, v173
  v_fma_f32 v144, v80, v8, v144
  v_fma_f32 v145, v81, v8, v145
  v_fma_f32 v146, v82, v8, v146
  v_fma_f32 v147, v83, v8, v147
  v_cvt_pk_bf16_f32 v144, v144, v145
  v_cvt_pk_bf16_f32 v145, v146, v147
  s_add_u32 s33, s47, 256
  buffer_store_dwordx2 v[144:145], v11, s[52:55], s33 offen sc0 sc1
  v_lshlrev_b32 v152, 16, v102
  v_and_b32 v153, 0xffff0000, v102
  v_lshlrev_b32 v154, 16, v103
  v_and_b32 v155, 0xffff0000, v103
  v_add_f32 v84, v84, v152
  v_add_f32 v85, v85, v153
  v_add_f32 v86, v86, v154
  v_add_f32 v87, v87, v155
  v_lshlrev_b32 v152, 16, v106
  v_and_b32 v153, 0xffff0000, v106
  v_lshlrev_b32 v154, 16, v107
  v_and_b32 v155, 0xffff0000, v107
  v_add_f32 v84, v84, v152
  v_add_f32 v85, v85, v153
  v_add_f32 v86, v86, v154
  v_add_f32 v87, v87, v155
  v_lshlrev_b32 v152, 16, v110
  v_and_b32 v153, 0xffff0000, v110
  v_lshlrev_b32 v154, 16, v111
  v_and_b32 v155, 0xffff0000, v111
  v_add_f32 v84, v84, v152
  v_add_f32 v85, v85, v153
  v_add_f32 v86, v86, v154
  v_add_f32 v87, v87, v155
  v_lshlrev_b32 v152, 16, v174
  v_and_b32 v153, 0xffff0000, v174
  v_lshlrev_b32 v154, 16, v175
  v_and_b32 v155, 0xffff0000, v175
  v_fma_f32 v152, v84, v9, v152
  v_fma_f32 v153, v85, v9, v153
  v_fma_f32 v154, v86, v9, v154
  v_fma_f32 v155, v87, v9, v155
  v_cvt_pk_bf16_f32 v152, v152, v153
  v_cvt_pk_bf16_f32 v153, v154, v155
  s_add_u32 s33, s47, 18688
  buffer_store_dwordx2 v[152:153], v11, s[52:55], s33 offen sc0 sc1
  s_cmp_lg_u32 s38, 0
  s_cbranch_scc1 F2_RESCUE
  s_branch FB_NEXT
F2_RESCUE:
  s_mov_b32 s39, 0
  s_bitcmp1_b32 s38, 0
  s_cselect_b32 s37, 7, 0
  s_or_b32 s39, s39, s37
  s_bitcmp1_b32 s38, 1
  s_cselect_b32 s37, 24, 0
  s_or_b32 s39, s39, s37
  s_bitcmp1_b32 s38, 2
  s_cselect_b32 s37, 96, 0
  s_or_b32 s39, s39, s37
  s_bitcmp1_b32 s38, 3
  s_cselect_b32 s37, 384, 0
  s_or_b32 s39, s39, s37
  s_mov_b32 s48, 0
F2_RL:
  s_bitcmp1_b32 s39, s48
  s_cbranch_scc0 F2_RN
  s_lshl_b32 s33, s48, 10
  s_add_u32 s33, s33, s34
  buffer_load_dwordx4 v[88:91], v1, s[40:43], s33 offen sc0 sc1
  s_add_u32 s33, s33, 9216
  buffer_load_dwordx4 v[92:95], v1, s[40:43], s33 offen sc0 sc1
  s_add_u32 s33, s33, 9216
  buffer_load_dwordx4 v[96:99], v1, s[40:43], s33 offen sc0 sc1
  s_add_u32 s33, s33, 9216
  buffer_load_dwordx4 v[100:103], v1, s[40:43], s33 offen sc0 sc1
  s_add_u32 s33, s33, 9216
  s_lshl_b32 s33, s48, 9
  s_add_u32 s33, s33, s44
  buffer_load_dwordx2 v[104:105], v10, s[56:59], s33 offen sc0 sc1
  s_add_u32 s33, s33, 18432
  buffer_load_dwordx2 v[106:107], v10, s[56:59], s33 offen sc0 sc1
  s_waitcnt vmcnt(0)
  v_lshlrev_b32 v128, 16, v88
  v_and_b32 v129, 0xffff0000, v88
  v_lshlrev_b32 v130, 16, v89
  v_and_b32 v131, 0xffff0000, v89
  v_mov_b32 v132, v128
  v_mov_b32 v133, v129
  v_mov_b32 v134, v130
  v_mov_b32 v135, v131
  v_lshlrev_b32 v128, 16, v92
  v_and_b32 v129, 0xffff0000, v92
  v_lshlrev_b32 v130, 16, v93
  v_and_b32 v131, 0xffff0000, v93
  v_add_f32 v132, v132, v128
  v_add_f32 v133, v133, v129
  v_add_f32 v134, v134, v130
  v_add_f32 v135, v135, v131
  v_lshlrev_b32 v128, 16, v96
  v_and_b32 v129, 0xffff0000, v96
  v_lshlrev_b32 v130, 16, v97
  v_and_b32 v131, 0xffff0000, v97
  v_add_f32 v132, v132, v128
  v_add_f32 v133, v133, v129
  v_add_f32 v134, v134, v130
  v_add_f32 v135, v135, v131
  v_lshlrev_b32 v128, 16, v100
  v_and_b32 v129, 0xffff0000, v100
  v_lshlrev_b32 v130, 16, v101
  v_and_b32 v131, 0xffff0000, v101
  v_add_f32 v132, v132, v128
  v_add_f32 v133, v133, v129
  v_add_f32 v134, v134, v130
  v_add_f32 v135, v135, v131
  v_lshlrev_b32 v128, 16, v104
  v_and_b32 v129, 0xffff0000, v104
  v_lshlrev_b32 v130, 16, v105
  v_and_b32 v131, 0xffff0000, v105
  v_fma_f32 v128, v132, v8, v128
  v_fma_f32 v129, v133, v8, v129
  v_fma_f32 v130, v134, v8, v130
  v_fma_f32 v131, v135, v8, v131
  v_cvt_pk_bf16_f32 v128, v128, v129
  v_cvt_pk_bf16_f32 v129, v130, v131
  s_lshl_b32 s33, s48, 5
  s_add_u32 s33, s33, s47
  s_add_u32 s33, s33, 0
  buffer_store_dwordx2 v[128:129], v11, s[52:55], s33 offen sc0 sc1
  v_lshlrev_b32 v136, 16, v90
  v_and_b32 v137, 0xffff0000, v90
  v_lshlrev_b32 v138, 16, v91
  v_and_b32 v139, 0xffff0000, v91
  v_mov_b32 v140, v136
  v_mov_b32 v141, v137
  v_mov_b32 v142, v138
  v_mov_b32 v143, v139
  v_lshlrev_b32 v136, 16, v94
  v_and_b32 v137, 0xffff0000, v94
  v_lshlrev_b32 v138, 16, v95
  v_and_b32 v139, 0xffff0000, v95
  v_add_f32 v140, v140, v136
  v_add_f32 v141, v141, v137
  v_add_f32 v142, v142, v138
  v_add_f32 v143, v143, v139
  v_lshlrev_b32 v136, 16, v98
  v_and_b32 v137, 0xffff0000, v98
  v_lshlrev_b32 v138, 16, v99
  v_and_b32 v139, 0xffff0000, v99
  v_add_f32 v140, v140, v136
  v_add_f32 v141, v141, v137
  v_add_f32 v142, v142, v138
  v_add_f32 v143, v143, v139
  v_lshlrev_b32 v136, 16, v102
  v_and_b32 v137, 0xffff0000, v102
  v_lshlrev_b32 v138, 16, v103
  v_and_b32 v139, 0xffff0000, v103
  v_add_f32 v140, v140, v136
  v_add_f32 v141, v141, v137
  v_add_f32 v142, v142, v138
  v_add_f32 v143, v143, v139
  v_lshlrev_b32 v136, 16, v106
  v_and_b32 v137, 0xffff0000, v106
  v_lshlrev_b32 v138, 16, v107
  v_and_b32 v139, 0xffff0000, v107
  v_fma_f32 v136, v140, v9, v136
  v_fma_f32 v137, v141, v9, v137
  v_fma_f32 v138, v142, v9, v138
  v_fma_f32 v139, v143, v9, v139
  v_cvt_pk_bf16_f32 v136, v136, v137
  v_cvt_pk_bf16_f32 v137, v138, v139
  s_lshl_b32 s33, s48, 5
  s_add_u32 s33, s33, s47
  s_add_u32 s33, s33, 18432
  buffer_store_dwordx2 v[136:137], v11, s[52:55], s33 offen sc0 sc1
  s_waitcnt vmcnt(0)
F2_RN:
  s_add_u32 s48, s48, 1
  s_cmp_lt_u32 s48, 9
  s_cbranch_scc1 F2_RL
  s_branch FB_NEXT
.section .rodata,"a"
.p2align 6
.amdhsa_kernel k1_kernel
  .amdhsa_next_free_vgpr 192
  .amdhsa_next_free_sgpr 102
  .amdhsa_accum_offset 192
  .amdhsa_group_segment_fixed_size 0
  .amdhsa_kernarg_size 96
  .amdhsa_user_sgpr_count 2
  .amdhsa_user_sgpr_kernarg_segment_ptr 1
  .amdhsa_system_sgpr_workgroup_id_x 1
.end_amdhsa_kernel
.p2align 6
.amdhsa_kernel m_kernel
  .amdhsa_next_free_vgpr 256
  .amdhsa_next_free_sgpr 102
  .amdhsa_accum_offset 256
  .amdhsa_group_segment_fixed_size 0
  .amdhsa_kernarg_size 96
  .amdhsa_user_sgpr_count 2
  .amdhsa_user_sgpr_kernarg_segment_ptr 1
  .amdhsa_system_sgpr_workgroup_id_x 1
.end_amdhsa_kernel
```
